```python
import torch

def _softmax(x, axis=-1):
    return torch.softmax(x, dim=axis)
def _gelu(x):
    return torch.nn.functional.gelu(x, approximate="tanh")
def _silu(x):
    return torch.nn.functional.silu(x)
def _sigmoid(x):
    return torch.sigmoid(x)
def _layernorm(x, axis=-1, eps=1e-5):
    m = x.mean(dim=axis, keepdim=True)
    v = x.var(dim=axis, keepdim=True, unbiased=False)
    return (x - m) / torch.sqrt(v + eps)
def _scatter_add(tgt, idx, src, axis=0):
    return tgt.clone().index_add_(axis, idx, src)
def _segment_sum(src, seg, n):
    out = torch.zeros((n,) + src.shape[1:], dtype=src.dtype)
    return out.index_add_(0, seg, src)
def _pad(x, pw):
    flat = tuple(v for pair in reversed(pw) for v in pair)
    return torch.nn.functional.pad(x, flat)

kernel_name = 'sequential_preLN__ssm_conv_h3__mixer_channel_mlp__prompt'

def setup_inputs():

    _w = (lambda a: (lambda t: t.to(torch.bfloat16) if t.is_floating_point() else t)(torch.as_tensor(a)))
    def _A_setup():
        B, S, D = 1, 2048, 512
        ks = 4
        return {
            "q": _w((lambda *s: torch.randn(*s, dtype=torch.bfloat16) * 0.05)(B, S, D)),
            "k": _w((lambda *s: torch.randn(*s, dtype=torch.bfloat16) * 0.2)(B, S, D)),
            "v": _w((lambda *s: torch.randn(*s, dtype=torch.bfloat16) * 0.2)(B, S, D)),
            "shift_k": _w((lambda *s: torch.randn(*s, dtype=torch.bfloat16) * 0.2)(D, ks) * 0.5),
            "ssm_k": _w((lambda *s: torch.randn(*s, dtype=torch.bfloat16) * 0.8)(D, S) * (1.0 / S ** 0.5)),
            "ssm_D": _w((lambda *s: torch.randn(*s, dtype=torch.bfloat16) * 0.2)(D)),
        }
    _A_in = _A_setup()

    def _B_setup():
        B, S, D, F = 1, 2048, 512, 1792
        return {
            "x": _w((lambda *s: torch.randn(*s, dtype=torch.bfloat16) * 0.05)(B, S, D)),
            "w1": _w((lambda *s: torch.randn(*s, dtype=torch.bfloat16) * 0.8)(D, F) * (D ** -0.5)),
            "b1": _w((lambda *s: torch.randn(*s, dtype=torch.bfloat16) * 0.4)(F)),
            "w2": _w((lambda *s: torch.randn(*s, dtype=torch.bfloat16) * 0.05)(F, D) * (F ** -0.5)),
            "b2": _w((lambda *s: torch.randn(*s, dtype=torch.bfloat16) * 0.05)(D)),
        }
    _B_in = _B_setup()

    return {
        "A_q": _A_in["q"],
        "A_k": _A_in["k"],
        "A_v": _A_in["v"],
        "A_shift_k": _A_in["shift_k"],
        "A_ssm_k": _A_in["ssm_k"],
        "A_ssm_D": _A_in["ssm_D"],
        "B_x": _B_in["x"],
        "B_w1": _B_in["w1"],
        "B_b1": _B_in["b1"],
        "B_w2": _B_in["w2"],
        "B_b2": _B_in["b2"],
    }

def reference(A_q, A_k, A_v, A_shift_k, A_ssm_k, A_ssm_D, B_x, B_w1, B_b1, B_w2, B_b2):
    def _A_ref(q, k, v, shift_k, ssm_k, ssm_D):
        B, S, D = q.shape
        ks = shift_k.shape[-1]
        k_pad = _pad(k, ((0, 0), (ks - 1, 0), (0, 0)))
        k_shift = torch.zeros_like(k)
        for t in range(ks):
            k_shift = k_shift + k_pad[:, t:t + S, :] * shift_k[:, ks - 1 - t][None, None, :]
        kv = k_shift * v
        L = 2 * S
        kv_pad = _pad(kv, ((0, 0), (0, S), (0, 0)))
        kf_pad = _pad(ssm_k, ((0, 0), (0, S)))
        kv_f = (lambda x, axes=(-2,-1): torch.fft.rfft2(x.float(), dim=axes))(kv_pad[:, None, :, :], axes=(1, 2))
        kf_f = (lambda x, axes=(-2,-1): torch.fft.rfft2(x.float(), dim=axes))(kf_pad[:, None, :], axes=(1, 2))
        kf_f = (lambda x, *d: x.permute(*d))(kf_f, 1, 2, 0)
        y_f = kv_f * kf_f[None, :, :, :]
        y = (lambda x, s, axes=(-2,-1): torch.fft.irfft2(x, s=s, dim=axes).to(torch.bfloat16))(y_f, (1, L), axes=(1, 2))[:, 0, :S, :]
        y = y + kv * ssm_D[None, None, :]
        return q * y

    def _B_ref(x, w1, b1, w2, b2):
        y = _layernorm(x, axis=-1)
        h = _gelu(torch.einsum("bsd,df->bsf", y, w1) + b1)
        return torch.einsum("bsf,fd->bsd", h, w2) + b2

    x = A_q
    h = x + _A_ref(_layernorm(x, axis=-1), A_k, A_v, A_shift_k, A_ssm_k, A_ssm_D)
    h2 = h + _B_ref(_layernorm(h, axis=-1), B_w1, B_b1, B_w2, B_b2)
    return h2
```

```asm
; @launch grid=(256,1,1) block=(256,1,1) lds=163840
.amdgcn_target "amdgcn-amd-amdhsa--gfx950"
.text
.globl sequential_preLN__ssm_conv_h3__mixer_channel_mlp__prompt_kernel
.type sequential_preLN__ssm_conv_h3__mixer_channel_mlp__prompt_kernel,@function
.p2align 8
sequential_preLN__ssm_conv_h3__mixer_channel_mlp__prompt_kernel:
    s_cmp_ge_u32 s2, 256
    s_cbranch_scc1 KEND
    s_load_dwordx4 s[28:31], s[0:1], 96
    s_load_dwordx16 s[4:19], s[0:1], 0
    s_load_dwordx8 s[20:27], s[0:1], 64
    v_lshrrev_b32 v1, 6, v0
    s_nop 0
    v_readfirstlane_b32 s3, v1
    v_and_b32 v0, 63, v0
    v_and_b32 v1, 15, v0
    v_lshrrev_b32 v2, 4, v0
    v_lshlrev_b32 v3, 4, v0
    s_and_b32 s48, s2, 7
    s_lshr_b32 s49, s2, 3
    s_mov_b32 s65, 0xffff0000
    s_mov_b32 s64, 30000
    s_lshr_b32 s57, s49, 1
    s_lshl_b32 s53, s48, 4
    s_add_u32 s53, s53, s57
    s_cmp_eq_u32 s3, 2
    s_cbranch_scc1 ROLE_X
    s_cmp_eq_u32 s3, 3
    s_cbranch_scc1 ROLE_F
    s_lshl_b32 s57, s49, 6
    s_lshl_b32 s58, s3, 5
    s_add_u32 s57, s57, s58
    v_lshlrev_b32 v4, 3, v2
    v_add_u32 v4, s57, v4
    v_sub_u32 v7, 2040, v4
    v_lshlrev_b32 v4, 10, v4
    v_lshl_add_u32 v4, v1, 3, v4
    s_lshl_b32 s58, s48, 7
    v_add_u32 v4, s58, v4
    v_subrev_u32 v5, 3072, v4
    v_add_u32 v6, 4096, v4
    s_lshl_b32 s58, s48, 9
    v_lshlrev_b32 v61, 5, v1
    v_add_u32 v61, s58, v61
    v_lshlrev_b32 v7, 1, v7
    v_lshl_add_u32 v7, v1, 14, v7
    s_lshl_b32 s58, s48, 18
    v_add_u32 v7, s58, v7
    s_waitcnt lgkmcnt(0)
    s_mov_b32 s36, s6
    s_mov_b32 s37, s7
    s_mov_b32 s38, 2097152
    s_mov_b32 s39, 0x00020000
    s_mov_b32 s44, s10
    s_mov_b32 s45, s11
    s_mov_b32 s46, 4096
    s_mov_b32 s47, 0x00020000
    s_barrier
    buffer_load_dwordx2 v[128:129], v5, s[36:39], 0 offen offset:0 nt
    buffer_load_dwordx2 v[130:131], v5, s[36:39], 0 offen offset:1024 nt
    buffer_load_dwordx2 v[132:133], v5, s[36:39], 0 offen offset:2048 nt
    buffer_load_dwordx4 v[166:169], v61, s[44:47], 0 offen offset:0
    buffer_load_dwordx4 v[170:173], v61, s[44:47], 0 offen offset:16
    s_mov_b32 s40, s8
    s_mov_b32 s41, s9
    s_mov_b32 s42, 2097152
    s_mov_b32 s43, 0x00020000
    buffer_load_dwordx2 v[134:135], v4, s[36:39], 0 offen offset:0 nt
    buffer_load_dwordx2 v[136:137], v4, s[36:39], 0 offen offset:1024 nt
    buffer_load_dwordx2 v[138:139], v4, s[36:39], 0 offen offset:2048 nt
    buffer_load_dwordx2 v[140:141], v4, s[36:39], 0 offen offset:3072 nt
    buffer_load_dwordx2 v[142:143], v6, s[36:39], 0 offen offset:0 nt
    buffer_load_dwordx2 v[144:145], v6, s[36:39], 0 offen offset:1024 nt
    buffer_load_dwordx2 v[146:147], v6, s[36:39], 0 offen offset:2048 nt
    buffer_load_dwordx2 v[148:149], v6, s[36:39], 0 offen offset:3072 nt
    buffer_load_dwordx2 v[150:151], v4, s[40:43], 0 offen offset:0 nt
    buffer_load_dwordx2 v[152:153], v4, s[40:43], 0 offen offset:1024 nt
    buffer_load_dwordx2 v[154:155], v4, s[40:43], 0 offen offset:2048 nt
    buffer_load_dwordx2 v[156:157], v4, s[40:43], 0 offen offset:3072 nt
    buffer_load_dwordx2 v[158:159], v6, s[40:43], 0 offen offset:0 nt
    buffer_load_dwordx2 v[160:161], v6, s[40:43], 0 offen offset:1024 nt
    buffer_load_dwordx2 v[162:163], v6, s[40:43], 0 offen offset:2048 nt
    buffer_load_dwordx2 v[164:165], v6, s[40:43], 0 offen offset:3072 nt
    s_barrier
    s_lshl_b32 s57, s53, 2
    s_add_u32 s57, s57, s3
    s_lshl_b32 s58, s57, 12
    s_add_u32 s44, s12, s58
    s_addc_u32 s45, s13, 0
    s_mov_b32 s46, 4096
    s_mov_b32 s47, 0x00020000
    buffer_load_dwordx4 v[32:35], v3, s[44:47], 0 offen offset:0 nt
    buffer_load_dwordx4 v[38:41], v3, s[44:47], 0 offen offset:1024 nt
    buffer_load_dwordx4 v[44:47], v3, s[44:47], 0 offen offset:2048 nt
    buffer_load_dwordx4 v[50:53], v3, s[44:47], 0 offen offset:3072 nt
    s_lshr_b32 s57, s57, 1
    s_lshl_b32 s57, s57, 2
    s_load_dword s16, s[14:15], s57
    s_mov_b32 s32, s30
    s_mov_b32 s33, s31
    s_mov_b32 s34, 18874368
    s_mov_b32 s35, 0x00020000
    s_mul_i32 s57, s3, 16640
    v_add_u32 v59, s57, v3
    v_add_u32 v60, 1, v1
    v_and_b32 v29, 3, v60
    v_sub_u32 v60, v60, v29
    v_lshlrev_b32 v60, 1, v60
    v_mul_u32_u24 v29, 4160, v29
    v_add_u32 v60, v60, v29
    v_lshl_add_u32 v60, v2, 4, v60
    v_add_u32 v60, s57, v60
    s_lshr_b32 s57, s49, 1
    s_xor_b32 s52, s57, s49
    s_and_b32 s52, s52, 1
    s_and_b32 s56, s57, 1
    s_lshr_b32 s55, s49, 2
    s_and_b32 s57, s49, 3
    s_lshl_b32 s57, s57, 2
    s_lshr_b32 s58, s48, 1
    s_add_u32 s50, s57, s58
    s_and_b32 s57, s48, 1
    s_lshl_b32 s57, s57, 3
    s_add_u32 s51, s57, s55
    s_lshr_b32 s57, s48, 2
    s_mul_i32 s57, s57, 3
    s_xor_b32 s57, s57, s52
    s_lshl_b32 s57, s57, 2
    s_and_b32 s58, s48, 3
    s_add_u32 s54, s57, s58
    s_mov_b32 s40, s20
    s_mov_b32 s41, s21
    s_mov_b32 s42, 3584
    s_mov_b32 s43, 0x00020000
    s_mul_i32 s57, s51, 224
    v_lshlrev_b32 v29, 2, v0
    buffer_load_dword v28, v29, s[40:43], s57 offen
    s_lshr_b32 s57, s2, 2
    s_min_u32 s57, s57, 55
    s_mul_i32 s58, s57, 37
    s_lshr_b32 s58, s58, 8
    s_mul_i32 s59, s58, 7
    s_sub_u32 s59, s57, s59
    s_mul_i32 s58, s58, 224
    s_lshl_b32 s60, s59, 5
    s_add_u32 s61, s60, 16
    s_cmp_lt_u32 s59, 3
    s_cselect_b32 s60, s60, s61
    s_cmp_eq_u32 s59, 6
    s_cselect_b32 s60, 96, s60
    s_cselect_b32 s62, 111, 15
    s_lshl_b32 s62, s62, 10
    s_add_u32 s60, s60, s58
    s_lshl_b32 s60, s60, 10
    s_and_b32 s61, s2, 3
    s_lshl_b32 s61, s61, 2
    s_add_u32 s61, s61, s3
    s_lshl_b32 s58, s61, 6
    s_add_u32 s100, s60, s58
    s_add_u32 s101, s100, s62
    s_lshr_b32 s61, s61, 1
    s_mul_i32 s61, s61, 229376
    s_lshl_b32 s57, s57, 12
    s_add_u32 s61, s61, s57
    s_and_b32 s58, s3, 1
    s_lshl_b32 s58, s58, 11
    s_add_u32 s61, s61, s58
    s_add_u32 s94, s61, 4325376
    v_bfe_u32 v29, v0, 1, 1
    v_xor_b32 v29, v29, v2
    v_and_b32 v29, 1, v29
    v_and_b32 v58, 1, v0
    v_lshl_or_b32 v29, v29, 1, v58
    v_lshrrev_b32 v58, 2, v0
    v_lshlrev_b32 v56, 6, v58
    v_lshlrev_b32 v58, 10, v58
    v_lshl_add_u32 v58, v29, 4, v58
    s_lshl_b32 s58, s3, 11
    s_add_u32 s58, s58, 148480
    s_mov_b32 m0, s58
    s_mov_b32 s36, s22
    s_mov_b32 s37, s23
    s_mov_b32 s38, 1835008
    s_mov_b32 s39, 0x00020000
    buffer_load_dwordx4 v58, s[36:39], s100 offen nt lds
    buffer_load_dwordx4 v58, s[36:39], s101 offen offset:1024 nt lds
    v_and_b32 v29, 1, v2
    v_lshl_add_u32 v56, v29, 5, v56
    v_and_b32 v29, 3, v0
    v_lshl_add_u32 v56, v29, 3, v56
    v_add_u32 v56, s58, v56
    v_xor_b32 v57, 32, v56
    v_mov_b32 v16, -1
    v_mov_b32 v17, -1
    v_mov_b32 v18, -1
    v_mov_b32 v19, -1
    s_waitcnt vmcnt(27)
    v_lshlrev_b32 v174, 16, v128
    v_and_b32 v175, s65, v128
    v_lshlrev_b32 v176, 16, v129
    v_and_b32 v177, s65, v129
    s_waitcnt vmcnt(26)
    v_lshlrev_b32 v178, 16, v130
    v_and_b32 v179, s65, v130
    v_lshlrev_b32 v180, 16, v131
    v_and_b32 v181, s65, v131
    s_waitcnt vmcnt(25)
    v_lshlrev_b32 v182, 16, v132
    v_and_b32 v183, s65, v132
    v_lshlrev_b32 v184, 16, v133
    v_and_b32 v185, s65, v133
    s_barrier
    s_waitcnt vmcnt(23)
    v_lshlrev_b32 v218, 16, v166
    v_and_b32 v222, s65, v166
    v_lshlrev_b32 v226, 16, v167
    v_and_b32 v230, s65, v167
    v_lshlrev_b32 v219, 16, v168
    v_and_b32 v223, s65, v168
    v_lshlrev_b32 v227, 16, v169
    v_and_b32 v231, s65, v169
    v_lshlrev_b32 v220, 16, v170
    v_and_b32 v224, s65, v170
    v_lshlrev_b32 v228, 16, v171
    v_and_b32 v232, s65, v171
    v_lshlrev_b32 v221, 16, v172
    v_and_b32 v225, s65, v172
    v_lshlrev_b32 v229, 16, v173
    v_and_b32 v233, s65, v173
    s_waitcnt vmcnt(22)
    v_lshlrev_b32 v186, 16, v134
    v_and_b32 v187, s65, v134
    v_lshlrev_b32 v188, 16, v135
    v_and_b32 v189, s65, v135
    v_pk_mul_f32 v[96:97], v[186:187], v[218:219]
    v_pk_mul_f32 v[98:99], v[188:189], v[220:221]
    v_pk_fma_f32 v[96:97], v[182:183], v[222:223], v[96:97]
    v_pk_fma_f32 v[98:99], v[184:185], v[224:225], v[98:99]
    v_pk_fma_f32 v[96:97], v[178:179], v[226:227], v[96:97]
    v_pk_fma_f32 v[98:99], v[180:181], v[228:229], v[98:99]
    v_pk_fma_f32 v[96:97], v[174:175], v[230:231], v[96:97]
    v_pk_fma_f32 v[98:99], v[176:177], v[232:233], v[98:99]
    s_waitcnt vmcnt(21)
    v_lshlrev_b32 v190, 16, v136
    v_and_b32 v191, s65, v136
    v_lshlrev_b32 v192, 16, v137
    v_and_b32 v193, s65, v137
    v_pk_mul_f32 v[100:101], v[190:191], v[218:219]
    v_pk_mul_f32 v[102:103], v[192:193], v[220:221]
    v_pk_fma_f32 v[100:101], v[186:187], v[222:223], v[100:101]
    v_pk_fma_f32 v[102:103], v[188:189], v[224:225], v[102:103]
    v_pk_fma_f32 v[100:101], v[182:183], v[226:227], v[100:101]
    v_pk_fma_f32 v[102:103], v[184:185], v[228:229], v[102:103]
    v_pk_fma_f32 v[100:101], v[178:179], v[230:231], v[100:101]
    v_pk_fma_f32 v[102:103], v[180:181], v[232:233], v[102:103]
    s_waitcnt vmcnt(20)
    v_lshlrev_b32 v194, 16, v138
    v_and_b32 v195, s65, v138
    v_lshlrev_b32 v196, 16, v139
    v_and_b32 v197, s65, v139
    v_pk_mul_f32 v[104:105], v[194:195], v[218:219]
    v_pk_mul_f32 v[106:107], v[196:197], v[220:221]
    v_pk_fma_f32 v[104:105], v[190:191], v[222:223], v[104:105]
    v_pk_fma_f32 v[106:107], v[192:193], v[224:225], v[106:107]
    v_pk_fma_f32 v[104:105], v[186:187], v[226:227], v[104:105]
    v_pk_fma_f32 v[106:107], v[188:189], v[228:229], v[106:107]
    v_pk_fma_f32 v[104:105], v[182:183], v[230:231], v[104:105]
    v_pk_fma_f32 v[106:107], v[184:185], v[232:233], v[106:107]
    s_waitcnt vmcnt(19)
    v_lshlrev_b32 v198, 16, v140
    v_and_b32 v199, s65, v140
    v_lshlrev_b32 v200, 16, v141
    v_and_b32 v201, s65, v141
    v_pk_mul_f32 v[108:109], v[198:199], v[218:219]
    v_pk_mul_f32 v[110:111], v[200:201], v[220:221]
    v_pk_fma_f32 v[108:109], v[194:195], v[222:223], v[108:109]
    v_pk_fma_f32 v[110:111], v[196:197], v[224:225], v[110:111]
    v_pk_fma_f32 v[108:109], v[190:191], v[226:227], v[108:109]
    v_pk_fma_f32 v[110:111], v[192:193], v[228:229], v[110:111]
    v_pk_fma_f32 v[108:109], v[186:187], v[230:231], v[108:109]
    v_pk_fma_f32 v[110:111], v[188:189], v[232:233], v[110:111]
    s_waitcnt vmcnt(18)
    v_lshlrev_b32 v202, 16, v142
    v_and_b32 v203, s65, v142
    v_lshlrev_b32 v204, 16, v143
    v_and_b32 v205, s65, v143
    v_pk_mul_f32 v[112:113], v[202:203], v[218:219]
    v_pk_mul_f32 v[114:115], v[204:205], v[220:221]
    v_pk_fma_f32 v[112:113], v[198:199], v[222:223], v[112:113]
    v_pk_fma_f32 v[114:115], v[200:201], v[224:225], v[114:115]
    v_pk_fma_f32 v[112:113], v[194:195], v[226:227], v[112:113]
    v_pk_fma_f32 v[114:115], v[196:197], v[228:229], v[114:115]
    v_pk_fma_f32 v[112:113], v[190:191], v[230:231], v[112:113]
    v_pk_fma_f32 v[114:115], v[192:193], v[232:233], v[114:115]
    s_waitcnt vmcnt(17)
    v_lshlrev_b32 v206, 16, v144
    v_and_b32 v207, s65, v144
    v_lshlrev_b32 v208, 16, v145
    v_and_b32 v209, s65, v145
    v_pk_mul_f32 v[116:117], v[206:207], v[218:219]
    v_pk_mul_f32 v[118:119], v[208:209], v[220:221]
    v_pk_fma_f32 v[116:117], v[202:203], v[222:223], v[116:117]
    v_pk_fma_f32 v[118:119], v[204:205], v[224:225], v[118:119]
    v_pk_fma_f32 v[116:117], v[198:199], v[226:227], v[116:117]
    v_pk_fma_f32 v[118:119], v[200:201], v[228:229], v[118:119]
    v_pk_fma_f32 v[116:117], v[194:195], v[230:231], v[116:117]
    v_pk_fma_f32 v[118:119], v[196:197], v[232:233], v[118:119]
    s_waitcnt vmcnt(16)
    v_lshlrev_b32 v210, 16, v146
    v_and_b32 v211, s65, v146
    v_lshlrev_b32 v212, 16, v147
    v_and_b32 v213, s65, v147
    v_pk_mul_f32 v[120:121], v[210:211], v[218:219]
    v_pk_mul_f32 v[122:123], v[212:213], v[220:221]
    v_pk_fma_f32 v[120:121], v[206:207], v[222:223], v[120:121]
    v_pk_fma_f32 v[122:123], v[208:209], v[224:225], v[122:123]
    v_pk_fma_f32 v[120:121], v[202:203], v[226:227], v[120:121]
    v_pk_fma_f32 v[122:123], v[204:205], v[228:229], v[122:123]
    v_pk_fma_f32 v[120:121], v[198:199], v[230:231], v[120:121]
    v_pk_fma_f32 v[122:123], v[200:201], v[232:233], v[122:123]
    s_waitcnt vmcnt(15)
    v_lshlrev_b32 v214, 16, v148
    v_and_b32 v215, s65, v148
    v_lshlrev_b32 v216, 16, v149
    v_and_b32 v217, s65, v149
    v_pk_mul_f32 v[124:125], v[214:215], v[218:219]
    v_pk_mul_f32 v[126:127], v[216:217], v[220:221]
    v_pk_fma_f32 v[124:125], v[210:211], v[222:223], v[124:125]
    v_pk_fma_f32 v[126:127], v[212:213], v[224:225], v[126:127]
    v_pk_fma_f32 v[124:125], v[206:207], v[226:227], v[124:125]
    v_pk_fma_f32 v[126:127], v[208:209], v[228:229], v[126:127]
    v_pk_fma_f32 v[124:125], v[202:203], v[230:231], v[124:125]
    v_pk_fma_f32 v[126:127], v[204:205], v[232:233], v[126:127]
    s_waitcnt vmcnt(14)
    v_lshlrev_b32 v62, 16, v150
    v_and_b32 v63, s65, v150
    v_lshlrev_b32 v64, 16, v151
    v_and_b32 v65, s65, v151
    v_pk_mul_f32 v[96:97], v[96:97], v[62:63]
    v_pk_mul_f32 v[98:99], v[98:99], v[64:65]
    s_waitcnt vmcnt(13)
    v_lshlrev_b32 v66, 16, v152
    v_and_b32 v67, s65, v152
    v_lshlrev_b32 v68, 16, v153
    v_and_b32 v69, s65, v153
    v_pk_mul_f32 v[100:101], v[100:101], v[66:67]
    v_pk_mul_f32 v[102:103], v[102:103], v[68:69]
    s_waitcnt vmcnt(12)
    v_lshlrev_b32 v62, 16, v154
    v_and_b32 v63, s65, v154
    v_lshlrev_b32 v64, 16, v155
    v_and_b32 v65, s65, v155
    v_pk_mul_f32 v[104:105], v[104:105], v[62:63]
    v_pk_mul_f32 v[106:107], v[106:107], v[64:65]
    s_waitcnt vmcnt(11)
    v_lshlrev_b32 v66, 16, v156
    v_and_b32 v67, s65, v156
    v_lshlrev_b32 v68, 16, v157
    v_and_b32 v69, s65, v157
    v_pk_mul_f32 v[108:109], v[108:109], v[66:67]
    v_pk_mul_f32 v[110:111], v[110:111], v[68:69]
    s_waitcnt vmcnt(10)
    v_lshlrev_b32 v62, 16, v158
    v_and_b32 v63, s65, v158
    v_lshlrev_b32 v64, 16, v159
    v_and_b32 v65, s65, v159
    v_pk_mul_f32 v[112:113], v[112:113], v[62:63]
    v_pk_mul_f32 v[114:115], v[114:115], v[64:65]
    s_waitcnt vmcnt(9)
    v_lshlrev_b32 v66, 16, v160
    v_and_b32 v67, s65, v160
    v_lshlrev_b32 v68, 16, v161
    v_and_b32 v69, s65, v161
    v_pk_mul_f32 v[116:117], v[116:117], v[66:67]
    v_pk_mul_f32 v[118:119], v[118:119], v[68:69]
    s_waitcnt vmcnt(8)
    v_lshlrev_b32 v62, 16, v162
    v_and_b32 v63, s65, v162
    v_lshlrev_b32 v64, 16, v163
    v_and_b32 v65, s65, v163
    v_pk_mul_f32 v[120:121], v[120:121], v[62:63]
    v_pk_mul_f32 v[122:123], v[122:123], v[64:65]
    s_waitcnt vmcnt(7)
    v_lshlrev_b32 v66, 16, v164
    v_and_b32 v67, s65, v164
    v_lshlrev_b32 v68, 16, v165
    v_and_b32 v69, s65, v165
    v_pk_mul_f32 v[124:125], v[124:125], v[66:67]
    v_pk_mul_f32 v[126:127], v[126:127], v[68:69]
    v_cvt_pk_bf16_f32 v234, v124, v120
    v_cvt_pk_bf16_f32 v235, v116, v112
    v_cvt_pk_bf16_f32 v236, v108, v104
    v_cvt_pk_bf16_f32 v237, v100, v96
    s_mov_b32 s57, 0
    buffer_store_dwordx4 v[234:237], v7, s[32:35], s57 offen sc1
    v_cvt_pk_bf16_f32 v238, v125, v121
    v_cvt_pk_bf16_f32 v239, v117, v113
    v_cvt_pk_bf16_f32 v240, v109, v105
    v_cvt_pk_bf16_f32 v241, v101, v97
    s_mov_b32 s57, 4096
    buffer_store_dwordx4 v[238:241], v7, s[32:35], s57 offen sc1
    v_cvt_pk_bf16_f32 v242, v126, v122
    v_cvt_pk_bf16_f32 v243, v118, v114
    v_cvt_pk_bf16_f32 v244, v110, v106
    v_cvt_pk_bf16_f32 v245, v102, v98
    s_mov_b32 s57, 8192
    buffer_store_dwordx4 v[242:245], v7, s[32:35], s57 offen sc1
    v_cvt_pk_bf16_f32 v246, v127, v123
    v_cvt_pk_bf16_f32 v247, v119, v115
    v_cvt_pk_bf16_f32 v248, v111, v107
    v_cvt_pk_bf16_f32 v249, v103, v99
    s_mov_b32 s57, 12288
    buffer_store_dwordx4 v[246:249], v7, s[32:35], s57 offen sc1
    s_waitcnt vmcnt(4)
    ds_read_b64_tr_b16 v[70:71], v56 offset:0
    ds_read_b64_tr_b16 v[72:73], v56 offset:1024
    ds_read_b64_tr_b16 v[74:75], v57 offset:0
    ds_read_b64_tr_b16 v[76:77], v57 offset:1024
    v_lshl_add_u32 v29, v2, 3, v1
    v_sub_u32 v29, 15, v29
    v_and_b32 v23, 1, v29
    v_lshlrev_b32 v23, 4, v23
    v_lshrrev_b32 v29, 1, v29
    s_and_b32 s58, s3, 1
    s_lshl_b32 s58, s58, 4
    s_waitcnt lgkmcnt(0)
    s_lshr_b32 s59, s16, s58
    s_and_b32 s59, s59, 0xffff
    v_lshlrev_b32 v23, v23, s59
    v_cmp_eq_u32 vcc, 0, v29
    s_nop 1
    v_cndmask_b32 v20, 0, v23, vcc
    v_cmp_eq_u32 vcc, 1, v29
    s_nop 1
    v_cndmask_b32 v21, 0, v23, vcc
    v_cmp_eq_u32 vcc, 2, v29
    s_nop 1
    v_cndmask_b32 v22, 0, v23, vcc
    v_cmp_eq_u32 vcc, 3, v29
    s_nop 1
    v_cndmask_b32 v23, 0, v23, vcc
    buffer_store_dwordx4 v[70:73], v3, s[32:35], s94 offen offset:0 sc1
    buffer_store_dwordx4 v[74:77], v3, s[32:35], s94 offen offset:1024 sc1
    v_mov_b32 v86, 0
    v_mov_b32 v87, 0
    v_mov_b32 v88, 0
    v_mov_b32 v89, 0
    v_mov_b32 v90, 0
    v_mov_b32 v91, 0
    v_mov_b32 v92, 0
    v_mov_b32 v93, 0
    v_mov_b32 v94, 0
    v_mov_b32 v95, 0
    v_mov_b32 v96, 0
    v_mov_b32 v97, 0
    v_mov_b32 v98, 0
    v_mov_b32 v99, 0
    v_mov_b32_dpp v97, v32 wave_shr:1 row_mask:0xf bank_mask:0xf bound_ctrl:0
    v_mov_b32_dpp v101, v33 wave_shr:1 row_mask:0xf bank_mask:0xf bound_ctrl:0
    v_lshlrev_b32 v93, 16, v97
    v_lshlrev_b32 v100, 16, v97
    v_alignbit_b32 v101, v101, v97, 16
    s_mov_b64 exec, 3
    ds_write_b128 v59, v[86:89] offset:0
    ds_write_b128 v59, v[90:93] offset:4160
    ds_write_b128 v59, v[94:97] offset:8320
    ds_write_b128 v59, v[98:101] offset:12480
    s_mov_b64 exec, -1
    v_mov_b32_dpp v36, v38 wave_rol:1 row_mask:0xf bank_mask:0xf
    v_mov_b32_dpp v37, v39 wave_rol:1 row_mask:0xf bank_mask:0xf
    s_nop 0
    v_mov_b32_dpp v36, v32 wave_shl:1 row_mask:0xf bank_mask:0xf
    v_mov_b32_dpp v37, v33 wave_shl:1 row_mask:0xf bank_mask:0xf
    v_alignbit_b32 v62, v33, v32, 16
    v_alignbit_b32 v63, v34, v33, 16
    v_alignbit_b32 v64, v35, v34, 16
    v_alignbit_b32 v65, v36, v35, 16
    v_mov_b32 v66, v33
    v_mov_b32 v67, v34
    v_mov_b32 v68, v35
    v_mov_b32 v69, v36
    v_alignbit_b32 v70, v34, v33, 16
    v_alignbit_b32 v71, v35, v34, 16
    v_alignbit_b32 v72, v36, v35, 16
    v_alignbit_b32 v73, v37, v36, 16
    ds_write_b128 v59, v[32:35] offset:32
    ds_write_b128 v59, v[62:65] offset:4192
    ds_write_b128 v59, v[66:69] offset:8352
    ds_write_b128 v59, v[70:73] offset:12512
    ds_read_b64 v[128:129], v60 offset:0
    ds_read_b64 v[130:131], v60 offset:8
    ds_read_b64 v[132:133], v60 offset:64
    ds_read_b64 v[134:135], v60 offset:72
    ds_read_b64 v[136:137], v60 offset:128
    ds_read_b64 v[138:139], v60 offset:136
    ds_read_b64 v[140:141], v60 offset:192
    ds_read_b64 v[142:143], v60 offset:200
    ds_read_b64 v[144:145], v60 offset:256
    ds_read_b64 v[146:147], v60 offset:264
    ds_read_b64 v[148:149], v60 offset:320
    ds_read_b64 v[150:151], v60 offset:328
    ds_read_b64 v[152:153], v60 offset:384
    ds_read_b64 v[154:155], v60 offset:392
    ds_read_b64 v[156:157], v60 offset:448
    ds_read_b64 v[158:159], v60 offset:456
    v_add_u32 v29, 0, v0
    v_mul_u32_u24 v8, 4682, v29
    v_lshrrev_b32 v8, 16, v8
    v_mul_u32_u24 v8, 3360, v8
    v_add_u32 v8, v8, v3
    s_movk_i32 s59, 4096
    v_add_u32 v29, 64, v0
    v_mul_u32_u24 v9, 4682, v29
    v_lshrrev_b32 v9, 16, v9
    v_mul_u32_u24 v9, 3360, v9
    v_add_u32 v9, v9, v3
    v_add_u32 v29, 128, v0
    v_mul_u32_u24 v10, 4682, v29
    v_lshrrev_b32 v10, 16, v10
    v_mul_u32_u24 v10, 3360, v10
    v_add_u32 v10, v10, v3
    v_add_u32 v29, 192, v0
    v_mul_u32_u24 v11, 4682, v29
    v_lshrrev_b32 v11, 16, v11
    v_mul_u32_u24 v11, 3360, v11
    v_add_u32 v11, v11, v3
    v_add_u32 v29, 256, v0
    v_mul_u32_u24 v12, 4682, v29
    v_lshrrev_b32 v12, 16, v12
    v_mul_u32_u24 v12, 3360, v12
    v_add3_u32 v12, v12, v3, s59
    v_add_u32 v29, 320, v0
    v_mul_u32_u24 v13, 4682, v29
    v_lshrrev_b32 v13, 16, v13
    v_mul_u32_u24 v13, 3360, v13
    v_add3_u32 v13, v13, v3, s59
    v_add_u32 v29, 384, v0
    v_mul_u32_u24 v14, 4682, v29
    v_lshrrev_b32 v14, 16, v14
    v_mul_u32_u24 v14, 3360, v14
    v_add3_u32 v14, v14, v3, s59
    s_mul_i32 s57, s3, 8448
    s_add_u32 s57, s57, 114688
    v_lshlrev_b32 v29, 1, v1
    v_sub_u32 v29, v2, v29
    v_add_u32 v29, 30, v29
    v_lshl_add_u32 v15, v29, 4, s57
    v_mul_u32_u24 v29, 288, v2
    v_lshl_add_u32 v29, v1, 4, v29
    v_add_u32 v24, s57, v29
    v_add_u32 v27, s57, v3
    v_bfe_u32 v29, v0, 2, 2
    v_mul_u32_u24 v29, 288, v29
    v_lshl_add_u32 v29, v2, 4, v29
    v_and_b32 v25, 3, v0
    v_lshl_add_u32 v29, v25, 2, v29
    s_lshl_b32 s58, s3, 6
    s_add_u32 s57, s58, 114688
    v_add_u32 v25, s57, v29
    v_and_b32 v29, 7, v1
    v_and_b32 v26, 8, v1
    v_lshl_add_u32 v26, v29, 4, v26
    v_lshl_add_u32 v26, v2, 14, v26
    v_mov_b32_dpp v42, v44 wave_rol:1 row_mask:0xf bank_mask:0xf
    v_mov_b32_dpp v43, v45 wave_rol:1 row_mask:0xf bank_mask:0xf
    s_nop 0
    v_mov_b32_dpp v42, v38 wave_shl:1 row_mask:0xf bank_mask:0xf
    v_mov_b32_dpp v43, v39 wave_shl:1 row_mask:0xf bank_mask:0xf
    v_alignbit_b32 v74, v39, v38, 16
    v_alignbit_b32 v75, v40, v39, 16
    v_alignbit_b32 v76, v41, v40, 16
    v_alignbit_b32 v77, v42, v41, 16
    v_mov_b32 v78, v39
    v_mov_b32 v79, v40
    v_mov_b32 v80, v41
    v_mov_b32 v81, v42
    v_alignbit_b32 v82, v40, v39, 16
    v_alignbit_b32 v83, v41, v40, 16
    v_alignbit_b32 v84, v42, v41, 16
    v_alignbit_b32 v85, v43, v42, 16
    ds_read_b64 v[160:161], v60 offset:512
    ds_read_b64 v[162:163], v60 offset:520
    ds_read_b64 v[164:165], v60 offset:576
    ds_read_b64 v[166:167], v60 offset:584
    ds_read_b64 v[168:169], v60 offset:640
    ds_read_b64 v[170:171], v60 offset:648
    ds_read_b64 v[172:173], v60 offset:704
    ds_read_b64 v[174:175], v60 offset:712
    ds_read_b64 v[176:177], v60 offset:768
    ds_read_b64 v[178:179], v60 offset:776
    ds_read_b64 v[180:181], v60 offset:832
    ds_read_b64 v[182:183], v60 offset:840
    ds_read_b64 v[184:185], v60 offset:896
    ds_read_b64 v[186:187], v60 offset:904
    ds_read_b64 v[188:189], v60 offset:960
    ds_read_b64 v[190:191], v60 offset:968
    s_mov_b32 s44, s18
    s_mov_b32 s45, s19
    s_mov_b32 s46, 1835008
    s_mov_b32 s47, 0x00020000
    s_mul_i32 s4, s3, 8448
    s_add_u32 s4, s4, 114688
    s_lshl_b32 s59, s3, 10
    s_lshr_b32 s57, s53, 1
    s_lshl_b32 s57, s57, 15
    s_and_b32 s58, s53, 1
    s_lshl_b32 s58, s58, 3
    s_add_u32 s57, s57, s58
    s_add_u32 s57, s57, s59
    s_add_u32 s5, s57, 2097152
    s_lshl_b32 s57, s3, 9
    s_add_u32 s100, s57, 4194304
    s_lshl_b32 s57, s53, 2
    s_add_u32 s57, s57, s3
    s_lshl_b32 s101, s57, 12
    s_lshl_b32 s57, s53, 7
    s_lshl_b32 s59, s3, 16
    s_add_u32 s57, s57, s59
    s_add_u32 s6, s57, 6291456
    s_mul_i32 s58, s51, 224
    s_mul_i32 s59, s3, 458752
    s_add_u32 s58, s58, s59
    s_mul_i32 s59, s3, 7168
    s_and_b32 s60, s49, 1
    s_xor_b32 s57, s60, 2
    s_mul_i32 s57, s57, 28672
    s_add_u32 s36, s57, s59
    s_lshl_b32 s57, s57, 2
    s_add_u32 s40, s57, s58
    s_xor_b32 s57, s60, 3
    s_mul_i32 s57, s57, 28672
    s_add_u32 s37, s57, s59
    s_lshl_b32 s57, s57, 2
    s_add_u32 s41, s57, s58
    s_xor_b32 s57, s60, 0
    s_mul_i32 s57, s57, 28672
    s_add_u32 s38, s57, s59
    s_lshl_b32 s57, s57, 2
    s_add_u32 s42, s57, s58
    s_xor_b32 s57, s60, 1
    s_mul_i32 s57, s57, 28672
    s_add_u32 s39, s57, s59
    s_lshl_b32 s57, s57, 2
    s_add_u32 s43, s57, s58
    s_lshl_b32 s57, s2, 7
    s_lshl_b32 s58, s3, 2
    s_add_u32 s57, s57, s58
    s_add_u32 s10, s57, 15728640
    s_lshl_b32 s57, s49, 3
    s_add_u32 s57, s57, s48
    s_lshl_b32 s57, s57, 7
    s_add_u32 s57, s57, s58
    s_add_u32 s9, s57, 15728640
    s_lshl_b32 s57, s50, 2
    s_add_u32 s57, s57, s3
    s_lshl_b32 s58, s57, 14
    s_add_u32 s13, s58, 6291456
    s_mul_i32 s57, s57, 57344
    s_lshr_b32 s58, s51, 1
    s_mul_i32 s58, s58, 7168
    s_add_u32 s57, s57, s58
    s_add_u32 s57, s57, 8388608
    s_and_b32 s58, s51, 1
    s_mul_i32 s59, s58, 3072
    s_add_u32 s11, s57, s59
    s_lshl_b32 s58, s58, 9
    s_add_u32 s57, s57, s58
    s_add_u32 s12, s57, 6144
    s_lshl_b32 s57, s54, 1
    s_add_u32 s57, s57, s56
    s_and_b32 s59, s3, 1
    s_lshl_b32 s59, s59, 7
    s_lshr_b32 s58, s3, 1
    s_add_u32 s59, s59, s58
    s_lshl_b32 s58, s54, 1
    s_add_u32 s59, s59, s58
    s_lshl_b32 s59, s59, 7
    s_lshl_b32 s58, s56, 3
    s_add_u32 s59, s59, s58
    s_add_u32 s7, s59, 15728656
    s_mul_i32 s57, s57, 114688
    s_mul_i32 s58, s3, 14336
    s_add_u32 s57, s57, s58
    s_add_u32 s95, s57, 8388608
    s_mul_i32 s57, s55, 229376
    s_mul_i32 s58, s3, 57344
    s_add_u32 s57, s57, s58
    s_add_u32 s8, s57, 4325376
    s_mul_i32 s57, s3, 7168
    s_lshr_b32 s58, s55, 1
    s_lshl_b32 s58, s58, 7
    s_add_u32 s57, s57, s58
    s_and_b32 s58, s55, 1
    s_lshl_b32 s58, s58, 3
    s_add_u32 s57, s57, s58
    s_add_u32 s15, s57, 15728640
    ds_write_b128 v59, v[38:41] offset:1056
    ds_write_b128 v59, v[74:77] offset:5216
    ds_write_b128 v59, v[78:81] offset:9376
    ds_write_b128 v59, v[82:85] offset:13536
    ds_read_b64 v[192:193], v60 offset:1024
    ds_read_b64 v[194:195], v60 offset:1032
    ds_read_b64 v[196:197], v60 offset:1088
    ds_read_b64 v[198:199], v60 offset:1096
    ds_read_b64 v[200:201], v60 offset:1152
    ds_read_b64 v[202:203], v60 offset:1160
    ds_read_b64 v[204:205], v60 offset:1216
    ds_read_b64 v[206:207], v60 offset:1224
    ds_read_b64 v[208:209], v60 offset:1280
    ds_read_b64 v[210:211], v60 offset:1288
    ds_read_b64 v[212:213], v60 offset:1344
    ds_read_b64 v[214:215], v60 offset:1352
    ds_read_b64 v[216:217], v60 offset:1408
    ds_read_b64 v[218:219], v60 offset:1416
    ds_read_b64 v[220:221], v60 offset:1472
    ds_read_b64 v[222:223], v60 offset:1480
    v_mov_b32_dpp v48, v50 wave_rol:1 row_mask:0xf bank_mask:0xf
    v_mov_b32_dpp v49, v51 wave_rol:1 row_mask:0xf bank_mask:0xf
    s_nop 0
    v_mov_b32_dpp v48, v44 wave_shl:1 row_mask:0xf bank_mask:0xf
    v_mov_b32_dpp v49, v45 wave_shl:1 row_mask:0xf bank_mask:0xf
    v_alignbit_b32 v62, v45, v44, 16
    v_alignbit_b32 v63, v46, v45, 16
    v_alignbit_b32 v64, v47, v46, 16
    v_alignbit_b32 v65, v48, v47, 16
    v_mov_b32 v66, v45
    v_mov_b32 v67, v46
    v_mov_b32 v68, v47
    v_mov_b32 v69, v48
    v_alignbit_b32 v70, v46, v45, 16
    v_alignbit_b32 v71, v47, v46, 16
    v_alignbit_b32 v72, v48, v47, 16
    v_alignbit_b32 v73, v49, v48, 16
    ds_read_b64 v[224:225], v60 offset:1536
    ds_read_b64 v[226:227], v60 offset:1544
    ds_read_b64 v[228:229], v60 offset:1600
    ds_read_b64 v[230:231], v60 offset:1608
    ds_read_b64 v[232:233], v60 offset:1664
    ds_read_b64 v[234:235], v60 offset:1672
    ds_read_b64 v[236:237], v60 offset:1728
    ds_read_b64 v[238:239], v60 offset:1736
    ds_read_b64 v[240:241], v60 offset:1792
    ds_read_b64 v[242:243], v60 offset:1800
    ds_read_b64 v[244:245], v60 offset:1856
    ds_read_b64 v[246:247], v60 offset:1864
    ds_read_b64 v[248:249], v60 offset:1920
    ds_read_b64 v[250:251], v60 offset:1928
    ds_read_b64 v[252:253], v60 offset:1984
    ds_read_b64 v[254:255], v60 offset:1992
    ds_write_b128 v59, v[44:47] offset:2080
    ds_write_b128 v59, v[62:65] offset:6240
    ds_write_b128 v59, v[66:69] offset:10400
    ds_write_b128 v59, v[70:73] offset:14560
    ds_read_b64 a[0:1], v60 offset:2048
    ds_read_b64 a[2:3], v60 offset:2056
    ds_read_b64 a[4:5], v60 offset:2112
    ds_read_b64 a[6:7], v60 offset:2120
    ds_read_b64 a[8:9], v60 offset:2176
    ds_read_b64 a[10:11], v60 offset:2184
    ds_read_b64 a[12:13], v60 offset:2240
    ds_read_b64 a[14:15], v60 offset:2248
    ds_read_b64 a[16:17], v60 offset:2304
    ds_read_b64 a[18:19], v60 offset:2312
    ds_read_b64 a[20:21], v60 offset:2368
    ds_read_b64 a[22:23], v60 offset:2376
    ds_read_b64 a[24:25], v60 offset:2432
    ds_read_b64 a[26:27], v60 offset:2440
    ds_read_b64 a[28:29], v60 offset:2496
    ds_read_b64 a[30:31], v60 offset:2504
    v_mov_b32_dpp v54, v50 wave_shl:1 row_mask:0xf bank_mask:0xf
    v_mov_b32_dpp v55, v51 wave_shl:1 row_mask:0xf bank_mask:0xf
    v_alignbit_b32 v74, v51, v50, 16
    v_alignbit_b32 v75, v52, v51, 16
    v_alignbit_b32 v76, v53, v52, 16
    v_alignbit_b32 v77, v54, v53, 16
    v_mov_b32 v78, v51
    v_mov_b32 v79, v52
    v_mov_b32 v80, v53
    v_mov_b32 v81, v54
    v_alignbit_b32 v82, v52, v51, 16
    v_alignbit_b32 v83, v53, v52, 16
    v_alignbit_b32 v84, v54, v53, 16
    v_alignbit_b32 v85, v55, v54, 16
    ds_read_b64 a[32:33], v60 offset:2560
    ds_read_b64 a[34:35], v60 offset:2568
    ds_read_b64 a[36:37], v60 offset:2624
    ds_read_b64 a[38:39], v60 offset:2632
    ds_read_b64 a[40:41], v60 offset:2688
    ds_read_b64 a[42:43], v60 offset:2696
    ds_read_b64 a[44:45], v60 offset:2752
    ds_read_b64 a[46:47], v60 offset:2760
    ds_read_b64 a[48:49], v60 offset:2816
    ds_read_b64 a[50:51], v60 offset:2824
    ds_read_b64 a[52:53], v60 offset:2880
    ds_read_b64 a[54:55], v60 offset:2888
    ds_read_b64 a[56:57], v60 offset:2944
    ds_read_b64 a[58:59], v60 offset:2952
    ds_read_b64 a[60:61], v60 offset:3008
    ds_read_b64 a[62:63], v60 offset:3016
    ds_write_b128 v59, v[50:53] offset:3104
    ds_write_b128 v59, v[74:77] offset:7264
    ds_write_b128 v59, v[78:81] offset:11424
    ds_write_b128 v59, v[82:85] offset:15584
    ds_read_b64 a[64:65], v60 offset:3072
    ds_read_b64 a[66:67], v60 offset:3080
    ds_read_b64 a[68:69], v60 offset:3136
    ds_read_b64 a[70:71], v60 offset:3144
    ds_read_b64 a[72:73], v60 offset:3200
    ds_read_b64 a[74:75], v60 offset:3208
    ds_read_b64 a[76:77], v60 offset:3264
    ds_read_b64 a[78:79], v60 offset:3272
    ds_read_b64 a[80:81], v60 offset:3328
    ds_read_b64 a[82:83], v60 offset:3336
    ds_read_b64 a[84:85], v60 offset:3392
    ds_read_b64 a[86:87], v60 offset:3400
    ds_read_b64 a[88:89], v60 offset:3456
    ds_read_b64 a[90:91], v60 offset:3464
    ds_read_b64 a[92:93], v60 offset:3520
    ds_read_b64 a[94:95], v60 offset:3528
    ds_read_b64 a[96:97], v60 offset:3584
    ds_read_b64 a[98:99], v60 offset:3592
    ds_read_b64 a[100:101], v60 offset:3648
    ds_read_b64 a[102:103], v60 offset:3656
    ds_read_b64 a[104:105], v60 offset:3712
    ds_read_b64 a[106:107], v60 offset:3720
    ds_read_b64 a[108:109], v60 offset:3776
    ds_read_b64 a[110:111], v60 offset:3784
    ds_read_b64 a[112:113], v60 offset:3840
    ds_read_b64 a[114:115], v60 offset:3848
    ds_read_b64 a[116:117], v60 offset:3904
    ds_read_b64 a[118:119], v60 offset:3912
    ds_read_b64 a[120:121], v60 offset:3968
    ds_read_b64 a[122:123], v60 offset:3976
    ds_read_b64 a[124:125], v60 offset:4032
    ds_read_b64 a[126:127], v60 offset:4040
    s_mov_b32 m0, s36
    s_nop 0
    buffer_load_dwordx4 v8, s[44:47], s40 offen offset:0 lds
    buffer_load_dwordx4 v9, s[44:47], s40 offen offset:1024 lds
    buffer_load_dwordx4 v10, s[44:47], s40 offen offset:2048 lds
    buffer_load_dwordx4 v11, s[44:47], s40 offen offset:3072 lds
    s_add_u32 m0, s36, 4096
    s_nop 0
    buffer_load_dwordx4 v12, s[44:47], s40 offen offset:0 lds
    buffer_load_dwordx4 v13, s[44:47], s40 offen offset:1024 lds
    buffer_load_dwordx4 v14, s[44:47], s40 offen offset:2048 lds
    v_mov_b32 v30, 0
    v_mov_b32 v31, 1
    s_waitcnt vmcnt(7)
    s_mov_b64 exec, 1
    buffer_store_dword v31, v30, s[32:35], s10 offen sc1
    s_mov_b64 exec, -1
    s_branch JOIN_A
ROLE_X:
    v_and_b32 v7, 7, v0
    v_lshrrev_b32 v5, 3, v0
    v_lshlrev_b32 v6, 10, v7
    v_lshl_add_u32 v6, v5, 4, v6
    s_lshl_b32 s62, s2, 13
    v_mov_b32 v16, -1
    v_mov_b32 v17, -1
    v_mov_b32 v18, -1
    v_mov_b32 v19, -1
    s_waitcnt lgkmcnt(0)
    s_mov_b32 s36, s4
    s_mov_b32 s37, s5
    s_mov_b32 s38, 2097152
    s_mov_b32 s39, 0x00020000
    s_barrier
    s_barrier
    buffer_load_dwordx4 v[128:131], v6, s[36:39], s62 offen offset:0 nt
    buffer_load_dwordx4 v[132:135], v6, s[36:39], s62 offen offset:128 nt
    buffer_load_dwordx4 v[136:139], v6, s[36:39], s62 offen offset:256 nt
    buffer_load_dwordx4 v[140:143], v6, s[36:39], s62 offen offset:384 nt
    buffer_load_dwordx4 v[144:147], v6, s[36:39], s62 offen offset:512 nt
    buffer_load_dwordx4 v[148:151], v6, s[36:39], s62 offen offset:640 nt
    buffer_load_dwordx4 v[152:155], v6, s[36:39], s62 offen offset:768 nt
    buffer_load_dwordx4 v[156:159], v6, s[36:39], s62 offen offset:896 nt
    s_lshl_b32 s57, s53, 2
    s_add_u32 s57, s57, s3
    s_lshl_b32 s58, s57, 12
    s_add_u32 s44, s12, s58
    s_addc_u32 s45, s13, 0
    s_mov_b32 s46, 4096
    s_mov_b32 s47, 0x00020000
    buffer_load_dwordx4 v[32:35], v3, s[44:47], 0 offen offset:0 nt
    buffer_load_dwordx4 v[38:41], v3, s[44:47], 0 offen offset:1024 nt
    buffer_load_dwordx4 v[44:47], v3, s[44:47], 0 offen offset:2048 nt
    buffer_load_dwordx4 v[50:53], v3, s[44:47], 0 offen offset:3072 nt
    s_lshr_b32 s57, s57, 1
    s_lshl_b32 s57, s57, 2
    s_load_dword s16, s[14:15], s57
    s_mov_b32 s32, s30
    s_mov_b32 s33, s31
    s_mov_b32 s34, 18874368
    s_mov_b32 s35, 0x00020000
    s_mul_i32 s57, s3, 16640
    s_add_u32 s57, s57, 81408
    v_add_u32 v59, s57, v3
    v_add_u32 v60, 1, v1
    v_and_b32 v29, 3, v60
    v_sub_u32 v60, v60, v29
    v_lshlrev_b32 v60, 1, v60
    v_mul_u32_u24 v29, 4160, v29
    v_add_u32 v60, v60, v29
    v_lshl_add_u32 v60, v2, 4, v60
    v_add_u32 v60, s57, v60
    s_lshr_b32 s57, s49, 1
    s_xor_b32 s52, s57, s49
    s_and_b32 s52, s52, 1
    s_and_b32 s56, s57, 1
    s_lshr_b32 s55, s49, 2
    s_and_b32 s57, s49, 3
    s_lshl_b32 s57, s57, 2
    s_lshr_b32 s58, s48, 1
    s_add_u32 s50, s57, s58
    s_and_b32 s57, s48, 1
    s_lshl_b32 s57, s57, 3
    s_add_u32 s51, s57, s55
    s_lshr_b32 s57, s48, 2
    s_mul_i32 s57, s57, 3
    s_xor_b32 s57, s57, s52
    s_lshl_b32 s57, s57, 2
    s_and_b32 s58, s48, 3
    s_add_u32 s54, s57, s58
    s_mov_b32 s40, s20
    s_mov_b32 s41, s21
    s_mov_b32 s42, 3584
    s_mov_b32 s43, 0x00020000
    s_mul_i32 s57, s51, 224
    v_lshlrev_b32 v29, 2, v0
    buffer_load_dword v28, v29, s[40:43], s57 offen
    s_lshr_b32 s57, s2, 2
    s_min_u32 s57, s57, 55
    s_mul_i32 s58, s57, 37
    s_lshr_b32 s58, s58, 8
    s_mul_i32 s59, s58, 7
    s_sub_u32 s59, s57, s59
    s_mul_i32 s58, s58, 224
    s_lshl_b32 s60, s59, 5
    s_add_u32 s61, s60, 16
    s_cmp_lt_u32 s59, 3
    s_cselect_b32 s60, s60, s61
    s_cmp_eq_u32 s59, 6
    s_cselect_b32 s60, 96, s60
    s_cselect_b32 s62, 111, 15
    s_lshl_b32 s62, s62, 10
    s_add_u32 s60, s60, s58
    s_lshl_b32 s60, s60, 10
    s_and_b32 s61, s2, 3
    s_lshl_b32 s61, s61, 2
    s_add_u32 s61, s61, s3
    s_lshl_b32 s58, s61, 6
    s_add_u32 s100, s60, s58
    s_add_u32 s101, s100, s62
    s_lshr_b32 s61, s61, 1
    s_mul_i32 s61, s61, 229376
    s_lshl_b32 s57, s57, 12
    s_add_u32 s61, s61, s57
    s_and_b32 s58, s3, 1
    s_lshl_b32 s58, s58, 11
    s_add_u32 s61, s61, s58
    s_add_u32 s94, s61, 4325376
    v_bfe_u32 v29, v0, 1, 1
    v_xor_b32 v29, v29, v2
    v_and_b32 v29, 1, v29
    v_and_b32 v58, 1, v0
    v_lshl_or_b32 v29, v29, 1, v58
    v_lshrrev_b32 v58, 2, v0
    v_lshlrev_b32 v56, 6, v58
    v_lshlrev_b32 v58, 10, v58
    v_lshl_add_u32 v58, v29, 4, v58
    s_lshl_b32 s58, s3, 11
    s_add_u32 s58, s58, 148480
    s_mov_b32 m0, s58
    s_mov_b32 s36, s22
    s_mov_b32 s37, s23
    s_mov_b32 s38, 1835008
    s_mov_b32 s39, 0x00020000
    buffer_load_dwordx4 v58, s[36:39], s100 offen nt lds
    buffer_load_dwordx4 v58, s[36:39], s101 offen offset:1024 nt lds
    v_and_b32 v29, 1, v2
    v_lshl_add_u32 v56, v29, 5, v56
    v_and_b32 v29, 3, v0
    v_lshl_add_u32 v56, v29, 3, v56
    v_add_u32 v56, s58, v56
    v_xor_b32 v57, 32, v56
    v_lshlrev_b32 v6, 4, v7
    v_lshl_add_u32 v4, v5, 8, v6
    v_lshl_add_u32 v6, v5, 15, v6
    s_lshl_b32 s57, s2, 3
    v_add_u32 v7, s57, v7
    v_mov_b32 v108, 0x3f803f80
    v_mov_b32 v96, 0
    v_mov_b32 v97, 0
    v_mov_b32 v98, 0
    v_mov_b32 v99, 0
    s_lshl_b32 s57, s2, 7
    s_add_u32 s59, s57, 2097152
    s_and_b32 s57, s57, 128
    s_lshr_b32 s58, s2, 1
    s_lshl_b32 s58, s58, 14
    s_add_u32 s57, s57, s58
    s_add_u32 s57, s57, 6291456
    s_barrier
    buffer_store_dwordx4 v[16:19], v4, s[32:35], s57 offen offset:0 sc1
    buffer_store_dwordx4 v[16:19], v4, s[32:35], s57 offen offset:2048 sc1
    s_add_u32 s57, s57, 4096
    buffer_store_dwordx4 v[16:19], v4, s[32:35], s57 offen offset:0 sc1
    buffer_store_dwordx4 v[16:19], v4, s[32:35], s57 offen offset:2048 sc1
    s_add_u32 s57, s57, 4096
    buffer_store_dwordx4 v[16:19], v4, s[32:35], s57 offen offset:0 sc1
    buffer_store_dwordx4 v[16:19], v4, s[32:35], s57 offen offset:2048 sc1
    s_add_u32 s57, s57, 4096
    buffer_store_dwordx4 v[16:19], v4, s[32:35], s57 offen offset:0 sc1
    buffer_store_dwordx4 v[16:19], v4, s[32:35], s57 offen offset:2048 sc1
    s_add_u32 s57, s57, 4096
    s_waitcnt vmcnt(22)
    buffer_store_dwordx4 v[128:131], v6, s[32:35], s59 offen sc1
    s_add_u32 s59, s59, 262144
    s_waitcnt vmcnt(22)
    buffer_store_dwordx4 v[132:135], v6, s[32:35], s59 offen sc1
    s_add_u32 s59, s59, 262144
    s_waitcnt vmcnt(22)
    buffer_store_dwordx4 v[136:139], v6, s[32:35], s59 offen sc1
    s_add_u32 s59, s59, 262144
    s_waitcnt vmcnt(22)
    buffer_store_dwordx4 v[140:143], v6, s[32:35], s59 offen sc1
    s_add_u32 s59, s59, 262144
    s_waitcnt vmcnt(22)
    buffer_store_dwordx4 v[144:147], v6, s[32:35], s59 offen sc1
    s_add_u32 s59, s59, 262144
    s_waitcnt vmcnt(22)
    buffer_store_dwordx4 v[148:151], v6, s[32:35], s59 offen sc1
    s_add_u32 s59, s59, 262144
    s_waitcnt vmcnt(22)
    buffer_store_dwordx4 v[152:155], v6, s[32:35], s59 offen sc1
    s_add_u32 s59, s59, 262144
    s_waitcnt vmcnt(22)
    buffer_store_dwordx4 v[156:159], v6, s[32:35], s59 offen sc1
    s_add_u32 s59, s59, 262144
    v_dot2_f32_bf16 v96, v128, v108, v96
    v_dot2_f32_bf16 v98, v128, v128, v98
    v_dot2_f32_bf16 v97, v129, v108, v97
    v_dot2_f32_bf16 v99, v129, v129, v99
    v_dot2_f32_bf16 v96, v130, v108, v96
    v_dot2_f32_bf16 v98, v130, v130, v98
    v_dot2_f32_bf16 v97, v131, v108, v97
    v_dot2_f32_bf16 v99, v131, v131, v99
    v_dot2_f32_bf16 v96, v132, v108, v96
    v_dot2_f32_bf16 v98, v132, v132, v98
    v_dot2_f32_bf16 v97, v133, v108, v97
    v_dot2_f32_bf16 v99, v133, v133, v99
    v_dot2_f32_bf16 v96, v134, v108, v96
    v_dot2_f32_bf16 v98, v134, v134, v98
    v_dot2_f32_bf16 v97, v135, v108, v97
    v_dot2_f32_bf16 v99, v135, v135, v99
    v_dot2_f32_bf16 v96, v136, v108, v96
    v_dot2_f32_bf16 v98, v136, v136, v98
    v_dot2_f32_bf16 v97, v137, v108, v97
    v_dot2_f32_bf16 v99, v137, v137, v99
    v_dot2_f32_bf16 v96, v138, v108, v96
    v_dot2_f32_bf16 v98, v138, v138, v98
    v_dot2_f32_bf16 v97, v139, v108, v97
    v_dot2_f32_bf16 v99, v139, v139, v99
    v_dot2_f32_bf16 v96, v140, v108, v96
    v_dot2_f32_bf16 v98, v140, v140, v98
    v_dot2_f32_bf16 v97, v141, v108, v97
    v_dot2_f32_bf16 v99, v141, v141, v99
    v_dot2_f32_bf16 v96, v142, v108, v96
    v_dot2_f32_bf16 v98, v142, v142, v98
    v_dot2_f32_bf16 v97, v143, v108, v97
    v_dot2_f32_bf16 v99, v143, v143, v99
    v_dot2_f32_bf16 v96, v144, v108, v96
    v_dot2_f32_bf16 v98, v144, v144, v98
    v_dot2_f32_bf16 v97, v145, v108, v97
    v_dot2_f32_bf16 v99, v145, v145, v99
    v_dot2_f32_bf16 v96, v146, v108, v96
    v_dot2_f32_bf16 v98, v146, v146, v98
    v_dot2_f32_bf16 v97, v147, v108, v97
    v_dot2_f32_bf16 v99, v147, v147, v99
    v_dot2_f32_bf16 v96, v148, v108, v96
    v_dot2_f32_bf16 v98, v148, v148, v98
    v_dot2_f32_bf16 v97, v149, v108, v97
    v_dot2_f32_bf16 v99, v149, v149, v99
    v_dot2_f32_bf16 v96, v150, v108, v96
    v_dot2_f32_bf16 v98, v150, v150, v98
    v_dot2_f32_bf16 v97, v151, v108, v97
    v_dot2_f32_bf16 v99, v151, v151, v99
    v_dot2_f32_bf16 v96, v152, v108, v96
    v_dot2_f32_bf16 v98, v152, v152, v98
    v_dot2_f32_bf16 v97, v153, v108, v97
    v_dot2_f32_bf16 v99, v153, v153, v99
    v_dot2_f32_bf16 v96, v154, v108, v96
    v_dot2_f32_bf16 v98, v154, v154, v98
    v_dot2_f32_bf16 v97, v155, v108, v97
    v_dot2_f32_bf16 v99, v155, v155, v99
    v_dot2_f32_bf16 v96, v156, v108, v96
    v_dot2_f32_bf16 v98, v156, v156, v98
    v_dot2_f32_bf16 v97, v157, v108, v97
    v_dot2_f32_bf16 v99, v157, v157, v99
    v_dot2_f32_bf16 v96, v158, v108, v96
    v_dot2_f32_bf16 v98, v158, v158, v98
    v_dot2_f32_bf16 v97, v159, v108, v97
    v_dot2_f32_bf16 v99, v159, v159, v99
    s_nop 1
    v_add_f32 v96, v96, v97
    v_add_f32 v98, v98, v99
    s_nop 0
    v_add_f32_dpp v96, v96, v96 row_ror:8 row_mask:0xf bank_mask:0xf
    v_add_f32_dpp v98, v98, v98 row_ror:8 row_mask:0xf bank_mask:0xf
    v_mov_b32 v97, v96
    v_mov_b32 v99, v98
    s_nop 0
    v_permlane16_swap_b32 v96, v97
    v_permlane16_swap_b32 v98, v99
    v_add_f32 v96, v96, v97
    v_add_f32 v98, v98, v99
    v_mov_b32 v97, v96
    v_mov_b32 v99, v98
    s_nop 0
    v_permlane32_swap_b32 v96, v97
    v_permlane32_swap_b32 v98, v99
    v_add_f32 v96, v96, v97
    v_add_f32 v98, v98, v99
    v_mul_f32 v96, 0x3b000000, v96
    v_mul_f32 v98, 0x3b000000, v98
    v_fma_f32 v98, -v96, v96, v98
    v_max_f32 v98, 0, v98
    v_cvt_pk_bf16_f32 v96, v96, v96
    v_lshlrev_b32 v96, 16, v96
    v_cvt_pk_bf16_f32 v98, v98, v98
    v_lshlrev_b32 v98, 16, v98
    v_add_f32 v98, 0x3727c5ac, v98
    v_cvt_pk_bf16_f32 v98, v98, v98
    v_lshlrev_b32 v98, 16, v98
    v_sqrt_f32 v98, v98
    s_nop 0
    v_cvt_pk_bf16_f32 v98, v98, v98
    v_lshlrev_b32 v98, 16, v98
    v_rcp_f32 v4, v98
    v_lshlrev_b32 v7, 3, v7
    v_mul_f32 v5, v96, v4
    v_sub_f32 v5, 0, v5
    s_waitcnt vmcnt(16)
    ds_read_b64_tr_b16 v[70:71], v56 offset:0
    ds_read_b64_tr_b16 v[72:73], v56 offset:1024
    ds_read_b64_tr_b16 v[74:75], v57 offset:0
    ds_read_b64_tr_b16 v[76:77], v57 offset:1024
    v_lshl_add_u32 v29, v2, 3, v1
    v_sub_u32 v29, 15, v29
    v_and_b32 v23, 1, v29
    v_lshlrev_b32 v23, 4, v23
    v_lshrrev_b32 v29, 1, v29
    s_and_b32 s58, s3, 1
    s_lshl_b32 s58, s58, 4
    s_waitcnt lgkmcnt(0)
    s_lshr_b32 s59, s16, s58
    s_and_b32 s59, s59, 0xffff
    v_lshlrev_b32 v23, v23, s59
    v_cmp_eq_u32 vcc, 0, v29
    s_nop 1
    v_cndmask_b32 v20, 0, v23, vcc
    v_cmp_eq_u32 vcc, 1, v29
    s_nop 1
    v_cndmask_b32 v21, 0, v23, vcc
    v_cmp_eq_u32 vcc, 2, v29
    s_nop 1
    v_cndmask_b32 v22, 0, v23, vcc
    v_cmp_eq_u32 vcc, 3, v29
    s_nop 1
    v_cndmask_b32 v23, 0, v23, vcc
    buffer_store_dwordx4 v[70:73], v3, s[32:35], s94 offen offset:0 sc1
    buffer_store_dwordx4 v[74:77], v3, s[32:35], s94 offen offset:1024 sc1
    v_mov_b32 v86, 0
    v_mov_b32 v87, 0
    v_mov_b32 v88, 0
    v_mov_b32 v89, 0
    v_mov_b32 v90, 0
    v_mov_b32 v91, 0
    v_mov_b32 v92, 0
    v_mov_b32 v93, 0
    v_mov_b32 v94, 0
    v_mov_b32 v95, 0
    v_mov_b32 v96, 0
    v_mov_b32 v97, 0
    v_mov_b32 v98, 0
    v_mov_b32 v99, 0
    v_mov_b32_dpp v97, v32 wave_shr:1 row_mask:0xf bank_mask:0xf bound_ctrl:0
    v_mov_b32_dpp v101, v33 wave_shr:1 row_mask:0xf bank_mask:0xf bound_ctrl:0
    v_lshlrev_b32 v93, 16, v97
    v_lshlrev_b32 v100, 16, v97
    v_alignbit_b32 v101, v101, v97, 16
    s_mov_b64 exec, 3
    ds_write_b128 v59, v[86:89] offset:0
    ds_write_b128 v59, v[90:93] offset:4160
    ds_write_b128 v59, v[94:97] offset:8320
    ds_write_b128 v59, v[98:101] offset:12480
    s_mov_b64 exec, -1
    v_mov_b32_dpp v36, v38 wave_rol:1 row_mask:0xf bank_mask:0xf
    v_mov_b32_dpp v37, v39 wave_rol:1 row_mask:0xf bank_mask:0xf
    s_nop 0
    v_mov_b32_dpp v36, v32 wave_shl:1 row_mask:0xf bank_mask:0xf
    v_mov_b32_dpp v37, v33 wave_shl:1 row_mask:0xf bank_mask:0xf
    v_alignbit_b32 v62, v33, v32, 16
    v_alignbit_b32 v63, v34, v33, 16
    v_alignbit_b32 v64, v35, v34, 16
    v_alignbit_b32 v65, v36, v35, 16
    v_mov_b32 v66, v33
    v_mov_b32 v67, v34
    v_mov_b32 v68, v35
    v_mov_b32 v69, v36
    v_alignbit_b32 v70, v34, v33, 16
    v_alignbit_b32 v71, v35, v34, 16
    v_alignbit_b32 v72, v36, v35, 16
    v_alignbit_b32 v73, v37, v36, 16
    ds_write_b128 v59, v[32:35] offset:32
    ds_write_b128 v59, v[62:65] offset:4192
    ds_write_b128 v59, v[66:69] offset:8352
    ds_write_b128 v59, v[70:73] offset:12512
    ds_read_b64 v[128:129], v60 offset:0
    ds_read_b64 v[130:131], v60 offset:8
    ds_read_b64 v[132:133], v60 offset:64
    ds_read_b64 v[134:135], v60 offset:72
    ds_read_b64 v[136:137], v60 offset:128
    ds_read_b64 v[138:139], v60 offset:136
    ds_read_b64 v[140:141], v60 offset:192
    ds_read_b64 v[142:143], v60 offset:200
    ds_read_b64 v[144:145], v60 offset:256
    ds_read_b64 v[146:147], v60 offset:264
    ds_read_b64 v[148:149], v60 offset:320
    ds_read_b64 v[150:151], v60 offset:328
    ds_read_b64 v[152:153], v60 offset:384
    ds_read_b64 v[154:155], v60 offset:392
    ds_read_b64 v[156:157], v60 offset:448
    ds_read_b64 v[158:159], v60 offset:456
    v_add_u32 v29, 0, v0
    v_mul_u32_u24 v8, 4682, v29
    v_lshrrev_b32 v8, 16, v8
    v_mul_u32_u24 v8, 3360, v8
    v_add_u32 v8, v8, v3
    s_movk_i32 s59, 4096
    v_add_u32 v29, 64, v0
    v_mul_u32_u24 v9, 4682, v29
    v_lshrrev_b32 v9, 16, v9
    v_mul_u32_u24 v9, 3360, v9
    v_add_u32 v9, v9, v3
    v_add_u32 v29, 128, v0
    v_mul_u32_u24 v10, 4682, v29
    v_lshrrev_b32 v10, 16, v10
    v_mul_u32_u24 v10, 3360, v10
    v_add_u32 v10, v10, v3
    v_add_u32 v29, 192, v0
    v_mul_u32_u24 v11, 4682, v29
    v_lshrrev_b32 v11, 16, v11
    v_mul_u32_u24 v11, 3360, v11
    v_add_u32 v11, v11, v3
    v_add_u32 v29, 256, v0
    v_mul_u32_u24 v12, 4682, v29
    v_lshrrev_b32 v12, 16, v12
    v_mul_u32_u24 v12, 3360, v12
    v_add3_u32 v12, v12, v3, s59
    v_add_u32 v29, 320, v0
    v_mul_u32_u24 v13, 4682, v29
    v_lshrrev_b32 v13, 16, v13
    v_mul_u32_u24 v13, 3360, v13
    v_add3_u32 v13, v13, v3, s59
    v_add_u32 v29, 384, v0
    v_mul_u32_u24 v14, 4682, v29
    v_lshrrev_b32 v14, 16, v14
    v_mul_u32_u24 v14, 3360, v14
    v_add3_u32 v14, v14, v3, s59
    s_mul_i32 s57, s3, 8448
    s_add_u32 s57, s57, 114688
    v_lshlrev_b32 v29, 1, v1
    v_sub_u32 v29, v2, v29
    v_add_u32 v29, 30, v29
    v_lshl_add_u32 v15, v29, 4, s57
    v_mul_u32_u24 v29, 288, v2
    v_lshl_add_u32 v29, v1, 4, v29
    v_add_u32 v24, s57, v29
    v_add_u32 v27, s57, v3
    v_bfe_u32 v29, v0, 2, 2
    v_mul_u32_u24 v29, 288, v29
    v_lshl_add_u32 v29, v2, 4, v29
    v_and_b32 v25, 3, v0
    v_lshl_add_u32 v29, v25, 2, v29
    s_lshl_b32 s58, s3, 6
    s_add_u32 s57, s58, 114688
    v_add_u32 v25, s57, v29
    v_and_b32 v29, 7, v1
    v_and_b32 v26, 8, v1
    v_lshl_add_u32 v26, v29, 4, v26
    v_lshl_add_u32 v26, v2, 14, v26
    v_mov_b32_dpp v42, v44 wave_rol:1 row_mask:0xf bank_mask:0xf
    v_mov_b32_dpp v43, v45 wave_rol:1 row_mask:0xf bank_mask:0xf
    s_nop 0
    v_mov_b32_dpp v42, v38 wave_shl:1 row_mask:0xf bank_mask:0xf
    v_mov_b32_dpp v43, v39 wave_shl:1 row_mask:0xf bank_mask:0xf
    v_alignbit_b32 v74, v39, v38, 16
    v_alignbit_b32 v75, v40, v39, 16
    v_alignbit_b32 v76, v41, v40, 16
    v_alignbit_b32 v77, v42, v41, 16
    v_mov_b32 v78, v39
    v_mov_b32 v79, v40
    v_mov_b32 v80, v41
    v_mov_b32 v81, v42
    v_alignbit_b32 v82, v40, v39, 16
    v_alignbit_b32 v83, v41, v40, 16
    v_alignbit_b32 v84, v42, v41, 16
    v_alignbit_b32 v85, v43, v42, 16
    ds_read_b64 v[160:161], v60 offset:512
    ds_read_b64 v[162:163], v60 offset:520
    ds_read_b64 v[164:165], v60 offset:576
    ds_read_b64 v[166:167], v60 offset:584
    ds_read_b64 v[168:169], v60 offset:640
    ds_read_b64 v[170:171], v60 offset:648
    ds_read_b64 v[172:173], v60 offset:704
    ds_read_b64 v[174:175], v60 offset:712
    ds_read_b64 v[176:177], v60 offset:768
    ds_read_b64 v[178:179], v60 offset:776
    ds_read_b64 v[180:181], v60 offset:832
    ds_read_b64 v[182:183], v60 offset:840
    ds_read_b64 v[184:185], v60 offset:896
    ds_read_b64 v[186:187], v60 offset:904
    ds_read_b64 v[188:189], v60 offset:960
    ds_read_b64 v[190:191], v60 offset:968
    s_mov_b32 s44, s18
    s_mov_b32 s45, s19
    s_mov_b32 s46, 1835008
    s_mov_b32 s47, 0x00020000
    s_mul_i32 s4, s3, 8448
    s_add_u32 s4, s4, 114688
    s_lshl_b32 s59, s3, 10
    s_lshr_b32 s57, s53, 1
    s_lshl_b32 s57, s57, 15
    s_and_b32 s58, s53, 1
    s_lshl_b32 s58, s58, 3
    s_add_u32 s57, s57, s58
    s_add_u32 s57, s57, s59
    s_add_u32 s5, s57, 2097152
    s_lshl_b32 s57, s3, 9
    s_add_u32 s100, s57, 4194304
    s_lshl_b32 s57, s53, 2
    s_add_u32 s57, s57, s3
    s_lshl_b32 s101, s57, 12
    s_lshl_b32 s57, s53, 7
    s_lshl_b32 s59, s3, 16
    s_add_u32 s57, s57, s59
    s_add_u32 s6, s57, 6291456
    s_mul_i32 s58, s51, 224
    s_mul_i32 s59, s3, 458752
    s_add_u32 s58, s58, s59
    s_mul_i32 s59, s3, 7168
    s_and_b32 s60, s49, 1
    s_xor_b32 s57, s60, 2
    s_mul_i32 s57, s57, 28672
    s_add_u32 s36, s57, s59
    s_lshl_b32 s57, s57, 2
    s_add_u32 s40, s57, s58
    s_xor_b32 s57, s60, 3
    s_mul_i32 s57, s57, 28672
    s_add_u32 s37, s57, s59
    s_lshl_b32 s57, s57, 2
    s_add_u32 s41, s57, s58
    s_xor_b32 s57, s60, 0
    s_mul_i32 s57, s57, 28672
    s_add_u32 s38, s57, s59
    s_lshl_b32 s57, s57, 2
    s_add_u32 s42, s57, s58
    s_xor_b32 s57, s60, 1
    s_mul_i32 s57, s57, 28672
    s_add_u32 s39, s57, s59
    s_lshl_b32 s57, s57, 2
    s_add_u32 s43, s57, s58
    s_lshl_b32 s57, s2, 7
    s_lshl_b32 s58, s3, 2
    s_add_u32 s57, s57, s58
    s_add_u32 s10, s57, 15728640
    s_lshl_b32 s57, s49, 3
    s_add_u32 s57, s57, s48
    s_lshl_b32 s57, s57, 7
    s_add_u32 s57, s57, s58
    s_add_u32 s9, s57, 15728640
    s_lshl_b32 s57, s50, 2
    s_add_u32 s57, s57, s3
    s_lshl_b32 s58, s57, 14
    s_add_u32 s13, s58, 6291456
    s_mul_i32 s57, s57, 57344
    s_lshr_b32 s58, s51, 1
    s_mul_i32 s58, s58, 7168
    s_add_u32 s57, s57, s58
    s_add_u32 s57, s57, 8388608
    s_and_b32 s58, s51, 1
    s_mul_i32 s59, s58, 3072
    s_add_u32 s11, s57, s59
    s_lshl_b32 s58, s58, 9
    s_add_u32 s57, s57, s58
    s_add_u32 s12, s57, 6144
    s_lshl_b32 s57, s54, 1
    s_add_u32 s57, s57, s56
    s_and_b32 s59, s3, 1
    s_lshl_b32 s59, s59, 7
    s_lshr_b32 s58, s3, 1
    s_add_u32 s59, s59, s58
    s_lshl_b32 s58, s54, 1
    s_add_u32 s59, s59, s58
    s_lshl_b32 s59, s59, 7
    s_lshl_b32 s58, s56, 3
    s_add_u32 s59, s59, s58
    s_add_u32 s7, s59, 15728656
    s_mul_i32 s57, s57, 114688
    s_mul_i32 s58, s3, 14336
    s_add_u32 s57, s57, s58
    s_add_u32 s95, s57, 8388608
    s_mul_i32 s57, s55, 229376
    s_mul_i32 s58, s3, 57344
    s_add_u32 s57, s57, s58
    s_add_u32 s8, s57, 4325376
    s_mul_i32 s57, s3, 7168
    s_lshr_b32 s58, s55, 1
    s_lshl_b32 s58, s58, 7
    s_add_u32 s57, s57, s58
    s_and_b32 s58, s55, 1
    s_lshl_b32 s58, s58, 3
    s_add_u32 s57, s57, s58
    s_add_u32 s15, s57, 15728640
    ds_write_b128 v59, v[38:41] offset:1056
    ds_write_b128 v59, v[74:77] offset:5216
    ds_write_b128 v59, v[78:81] offset:9376
    ds_write_b128 v59, v[82:85] offset:13536
    ds_read_b64 v[192:193], v60 offset:1024
    ds_read_b64 v[194:195], v60 offset:1032
    ds_read_b64 v[196:197], v60 offset:1088
    ds_read_b64 v[198:199], v60 offset:1096
    ds_read_b64 v[200:201], v60 offset:1152
    ds_read_b64 v[202:203], v60 offset:1160
    ds_read_b64 v[204:205], v60 offset:1216
    ds_read_b64 v[206:207], v60 offset:1224
    ds_read_b64 v[208:209], v60 offset:1280
    ds_read_b64 v[210:211], v60 offset:1288
    ds_read_b64 v[212:213], v60 offset:1344
    ds_read_b64 v[214:215], v60 offset:1352
    ds_read_b64 v[216:217], v60 offset:1408
    ds_read_b64 v[218:219], v60 offset:1416
    ds_read_b64 v[220:221], v60 offset:1472
    ds_read_b64 v[222:223], v60 offset:1480
    s_mov_b32 s57, 4194304
    s_mov_b64 exec, 0xff
    s_waitcnt vmcnt(10)
    s_waitcnt vmcnt(2)
    buffer_store_dwordx2 v[4:5], v7, s[32:35], s57 offen sc1
    s_mov_b64 exec, -1
    v_mov_b32_dpp v48, v50 wave_rol:1 row_mask:0xf bank_mask:0xf
    v_mov_b32_dpp v49, v51 wave_rol:1 row_mask:0xf bank_mask:0xf
    s_nop 0
    v_mov_b32_dpp v48, v44 wave_shl:1 row_mask:0xf bank_mask:0xf
    v_mov_b32_dpp v49, v45 wave_shl:1 row_mask:0xf bank_mask:0xf
    v_alignbit_b32 v62, v45, v44, 16
    v_alignbit_b32 v63, v46, v45, 16
    v_alignbit_b32 v64, v47, v46, 16
    v_alignbit_b32 v65, v48, v47, 16
    v_mov_b32 v66, v45
    v_mov_b32 v67, v46
    v_mov_b32 v68, v47
    v_mov_b32 v69, v48
    v_alignbit_b32 v70, v46, v45, 16
    v_alignbit_b32 v71, v47, v46, 16
    v_alignbit_b32 v72, v48, v47, 16
    v_alignbit_b32 v73, v49, v48, 16
    ds_read_b64 v[224:225], v60 offset:1536
    ds_read_b64 v[226:227], v60 offset:1544
    ds_read_b64 v[228:229], v60 offset:1600
    ds_read_b64 v[230:231], v60 offset:1608
    ds_read_b64 v[232:233], v60 offset:1664
    ds_read_b64 v[234:235], v60 offset:1672
    ds_read_b64 v[236:237], v60 offset:1728
    ds_read_b64 v[238:239], v60 offset:1736
    ds_read_b64 v[240:241], v60 offset:1792
    ds_read_b64 v[242:243], v60 offset:1800
    ds_read_b64 v[244:245], v60 offset:1856
    ds_read_b64 v[246:247], v60 offset:1864
    ds_read_b64 v[248:249], v60 offset:1920
    ds_read_b64 v[250:251], v60 offset:1928
    ds_read_b64 v[252:253], v60 offset:1984
    ds_read_b64 v[254:255], v60 offset:1992
    ds_write_b128 v59, v[44:47] offset:2080
    ds_write_b128 v59, v[62:65] offset:6240
    ds_write_b128 v59, v[66:69] offset:10400
    ds_write_b128 v59, v[70:73] offset:14560
    ds_read_b64 a[0:1], v60 offset:2048
    ds_read_b64 a[2:3], v60 offset:2056
    ds_read_b64 a[4:5], v60 offset:2112
    ds_read_b64 a[6:7], v60 offset:2120
    ds_read_b64 a[8:9], v60 offset:2176
    ds_read_b64 a[10:11], v60 offset:2184
    ds_read_b64 a[12:13], v60 offset:2240
    ds_read_b64 a[14:15], v60 offset:2248
    ds_read_b64 a[16:17], v60 offset:2304
    ds_read_b64 a[18:19], v60 offset:2312
    ds_read_b64 a[20:21], v60 offset:2368
    ds_read_b64 a[22:23], v60 offset:2376
    ds_read_b64 a[24:25], v60 offset:2432
    ds_read_b64 a[26:27], v60 offset:2440
    ds_read_b64 a[28:29], v60 offset:2496
    ds_read_b64 a[30:31], v60 offset:2504
    v_mov_b32_dpp v54, v50 wave_shl:1 row_mask:0xf bank_mask:0xf
    v_mov_b32_dpp v55, v51 wave_shl:1 row_mask:0xf bank_mask:0xf
    v_alignbit_b32 v74, v51, v50, 16
    v_alignbit_b32 v75, v52, v51, 16
    v_alignbit_b32 v76, v53, v52, 16
    v_alignbit_b32 v77, v54, v53, 16
    v_mov_b32 v78, v51
    v_mov_b32 v79, v52
    v_mov_b32 v80, v53
    v_mov_b32 v81, v54
    v_alignbit_b32 v82, v52, v51, 16
    v_alignbit_b32 v83, v53, v52, 16
    v_alignbit_b32 v84, v54, v53, 16
    v_alignbit_b32 v85, v55, v54, 16
    ds_read_b64 a[32:33], v60 offset:2560
    ds_read_b64 a[34:35], v60 offset:2568
    ds_read_b64 a[36:37], v60 offset:2624
    ds_read_b64 a[38:39], v60 offset:2632
    ds_read_b64 a[40:41], v60 offset:2688
    ds_read_b64 a[42:43], v60 offset:2696
    ds_read_b64 a[44:45], v60 offset:2752
    ds_read_b64 a[46:47], v60 offset:2760
    ds_read_b64 a[48:49], v60 offset:2816
    ds_read_b64 a[50:51], v60 offset:2824
    ds_read_b64 a[52:53], v60 offset:2880
    ds_read_b64 a[54:55], v60 offset:2888
    ds_read_b64 a[56:57], v60 offset:2944
    ds_read_b64 a[58:59], v60 offset:2952
    ds_read_b64 a[60:61], v60 offset:3008
    ds_read_b64 a[62:63], v60 offset:3016
    ds_write_b128 v59, v[50:53] offset:3104
    ds_write_b128 v59, v[74:77] offset:7264
    ds_write_b128 v59, v[78:81] offset:11424
    ds_write_b128 v59, v[82:85] offset:15584
    ds_read_b64 a[64:65], v60 offset:3072
    ds_read_b64 a[66:67], v60 offset:3080
    ds_read_b64 a[68:69], v60 offset:3136
    ds_read_b64 a[70:71], v60 offset:3144
    ds_read_b64 a[72:73], v60 offset:3200
    ds_read_b64 a[74:75], v60 offset:3208
    ds_read_b64 a[76:77], v60 offset:3264
    ds_read_b64 a[78:79], v60 offset:3272
    ds_read_b64 a[80:81], v60 offset:3328
    ds_read_b64 a[82:83], v60 offset:3336
    ds_read_b64 a[84:85], v60 offset:3392
    ds_read_b64 a[86:87], v60 offset:3400
    ds_read_b64 a[88:89], v60 offset:3456
    ds_read_b64 a[90:91], v60 offset:3464
    ds_read_b64 a[92:93], v60 offset:3520
    ds_read_b64 a[94:95], v60 offset:3528
    ds_read_b64 a[96:97], v60 offset:3584
    ds_read_b64 a[98:99], v60 offset:3592
    ds_read_b64 a[100:101], v60 offset:3648
    ds_read_b64 a[102:103], v60 offset:3656
    ds_read_b64 a[104:105], v60 offset:3712
    ds_read_b64 a[106:107], v60 offset:3720
    ds_read_b64 a[108:109], v60 offset:3776
    ds_read_b64 a[110:111], v60 offset:3784
    ds_read_b64 a[112:113], v60 offset:3840
    ds_read_b64 a[114:115], v60 offset:3848
    ds_read_b64 a[116:117], v60 offset:3904
    ds_read_b64 a[118:119], v60 offset:3912
    ds_read_b64 a[120:121], v60 offset:3968
    ds_read_b64 a[122:123], v60 offset:3976
    ds_read_b64 a[124:125], v60 offset:4032
    ds_read_b64 a[126:127], v60 offset:4040
    s_mov_b32 m0, s36
    s_nop 0
    buffer_load_dwordx4 v8, s[44:47], s40 offen offset:0 lds
    buffer_load_dwordx4 v9, s[44:47], s40 offen offset:1024 lds
    buffer_load_dwordx4 v10, s[44:47], s40 offen offset:2048 lds
    buffer_load_dwordx4 v11, s[44:47], s40 offen offset:3072 lds
    s_add_u32 m0, s36, 4096
    s_nop 0
    buffer_load_dwordx4 v12, s[44:47], s40 offen offset:0 lds
    buffer_load_dwordx4 v13, s[44:47], s40 offen offset:1024 lds
    buffer_load_dwordx4 v14, s[44:47], s40 offen offset:2048 lds
    v_mov_b32 v30, 0
    v_mov_b32 v31, 1
    s_waitcnt vmcnt(8)
    s_mov_b64 exec, 1
    buffer_store_dword v31, v30, s[32:35], s10 offen sc1
    s_mov_b64 exec, -1
    s_branch JOIN_A
ROLE_F:
    v_mov_b32 v16, -1
    v_mov_b32 v17, -1
    v_mov_b32 v18, -1
    v_mov_b32 v19, -1
    v_lshrrev_b32 v5, 3, v0
    v_and_b32 v6, 7, v0
    v_lshlrev_b32 v6, 4, v6
    v_lshl_add_u32 v7, v5, 15, v6
    v_lshl_add_u32 v6, v5, 12, v6
    s_lshl_b32 s60, s2, 7
    s_add_u32 s60, s60, 2097152
    s_lshl_b32 s59, s48, 18
    s_lshl_b32 s58, s49, 7
    s_sub_u32 s59, s59, s58
    s_add_u32 s59, s59, 3968
    v_mov_b32 v30, 0
    v_mov_b32 v31, 1
    v_lshlrev_b32 v61, 2, v0
    s_waitcnt lgkmcnt(0)
    s_mov_b32 s32, s30
    s_mov_b32 s33, s31
    s_mov_b32 s34, 18874368
    s_mov_b32 s35, 0x00020000
    buffer_store_dwordx4 v[16:19], v6, s[32:35], s59 offen sc1
    s_add_u32 s59, s59, 32768
    buffer_store_dwordx4 v[16:19], v6, s[32:35], s59 offen sc1
    s_add_u32 s59, s59, 32768
    buffer_store_dwordx4 v[16:19], v6, s[32:35], s59 offen sc1
    s_add_u32 s59, s59, 32768
    buffer_store_dwordx4 v[16:19], v6, s[32:35], s59 offen sc1
    s_add_u32 s59, s59, 32768
    buffer_store_dwordx4 v[16:19], v6, s[32:35], s59 offen sc1
    s_add_u32 s59, s59, 32768
    buffer_store_dwordx4 v[16:19], v6, s[32:35], s59 offen sc1
    s_add_u32 s59, s59, 32768
    buffer_store_dwordx4 v[16:19], v6, s[32:35], s59 offen sc1
    s_add_u32 s59, s59, 32768
    buffer_store_dwordx4 v[16:19], v6, s[32:35], s59 offen sc1
    s_add_u32 s59, s59, 32768
    s_lshl_b32 s57, s2, 6
    s_add_u32 s57, s57, 4194304
    s_lshl_b32 s58, s2, 7
    s_add_u32 s63, s58, 15728640
    s_mov_b64 exec, 15
    buffer_store_dwordx4 v[16:19], v3, s[32:35], s57 offen sc1
    s_mov_b64 exec, 0xffff
    buffer_store_dword v30, v61, s[32:35], s63 offen sc1
    s_mov_b64 exec, -1
    s_barrier
    s_barrier
    s_mov_b32 s96, s28
    s_mov_b32 s97, s29
    s_mov_b32 s98, 256
    s_mov_b32 s99, 0x00020000
    s_lshl_b32 s57, s53, 2
    s_add_u32 s57, s57, s3
    s_lshl_b32 s58, s57, 12
    s_add_u32 s44, s12, s58
    s_addc_u32 s45, s13, 0
    s_mov_b32 s46, 4096
    s_mov_b32 s47, 0x00020000
    buffer_load_dwordx4 v[32:35], v3, s[44:47], 0 offen offset:0 nt
    buffer_load_dwordx4 v[38:41], v3, s[44:47], 0 offen offset:1024 nt
    buffer_load_dwordx4 v[44:47], v3, s[44:47], 0 offen offset:2048 nt
    buffer_load_dwordx4 v[50:53], v3, s[44:47], 0 offen offset:3072 nt
    s_lshr_b32 s57, s57, 1
    s_lshl_b32 s57, s57, 2
    s_load_dword s16, s[14:15], s57
    s_mov_b32 s32, s30
    s_mov_b32 s33, s31
    s_mov_b32 s34, 18874368
    s_mov_b32 s35, 0x00020000
    s_mul_i32 s57, s3, 16640
    s_add_u32 s57, s57, 81408
    v_add_u32 v59, s57, v3
    v_add_u32 v60, 1, v1
    v_and_b32 v29, 3, v60
    v_sub_u32 v60, v60, v29
    v_lshlrev_b32 v60, 1, v60
    v_mul_u32_u24 v29, 4160, v29
    v_add_u32 v60, v60, v29
    v_lshl_add_u32 v60, v2, 4, v60
    v_add_u32 v60, s57, v60
    s_lshr_b32 s57, s49, 1
    s_xor_b32 s52, s57, s49
    s_and_b32 s52, s52, 1
    s_and_b32 s56, s57, 1
    s_lshr_b32 s55, s49, 2
    s_and_b32 s57, s49, 3
    s_lshl_b32 s57, s57, 2
    s_lshr_b32 s58, s48, 1
    s_add_u32 s50, s57, s58
    s_and_b32 s57, s48, 1
    s_lshl_b32 s57, s57, 3
    s_add_u32 s51, s57, s55
    s_lshr_b32 s57, s48, 2
    s_mul_i32 s57, s57, 3
    s_xor_b32 s57, s57, s52
    s_lshl_b32 s57, s57, 2
    s_and_b32 s58, s48, 3
    s_add_u32 s54, s57, s58
    s_mov_b32 s40, s20
    s_mov_b32 s41, s21
    s_mov_b32 s42, 3584
    s_mov_b32 s43, 0x00020000
    s_mul_i32 s57, s51, 224
    v_lshlrev_b32 v29, 2, v0
    buffer_load_dword v28, v29, s[40:43], s57 offen
    s_lshr_b32 s57, s2, 2
    s_min_u32 s57, s57, 55
    s_mul_i32 s58, s57, 37
    s_lshr_b32 s58, s58, 8
    s_mul_i32 s59, s58, 7
    s_sub_u32 s59, s57, s59
    s_mul_i32 s58, s58, 224
    s_lshl_b32 s60, s59, 5
    s_add_u32 s61, s60, 16
    s_cmp_lt_u32 s59, 3
    s_cselect_b32 s60, s60, s61
    s_cmp_eq_u32 s59, 6
    s_cselect_b32 s60, 96, s60
    s_cselect_b32 s62, 111, 15
    s_lshl_b32 s62, s62, 10
    s_add_u32 s60, s60, s58
    s_lshl_b32 s60, s60, 10
    s_and_b32 s61, s2, 3
    s_lshl_b32 s61, s61, 2
    s_add_u32 s61, s61, s3
    s_lshl_b32 s58, s61, 6
    s_add_u32 s100, s60, s58
    s_add_u32 s101, s100, s62
    s_lshr_b32 s61, s61, 1
    s_mul_i32 s61, s61, 229376
    s_lshl_b32 s57, s57, 12
    s_add_u32 s61, s61, s57
    s_and_b32 s58, s3, 1
    s_lshl_b32 s58, s58, 11
    s_add_u32 s61, s61, s58
    s_add_u32 s94, s61, 4325376
    v_bfe_u32 v29, v0, 1, 1
    v_xor_b32 v29, v29, v2
    v_and_b32 v29, 1, v29
    v_and_b32 v58, 1, v0
    v_lshl_or_b32 v29, v29, 1, v58
    v_lshrrev_b32 v58, 2, v0
    v_lshlrev_b32 v56, 6, v58
    v_lshlrev_b32 v58, 10, v58
    v_lshl_add_u32 v58, v29, 4, v58
    s_lshl_b32 s58, s3, 11
    s_add_u32 s58, s58, 148480
    s_mov_b32 m0, s58
    s_mov_b32 s36, s22
    s_mov_b32 s37, s23
    s_mov_b32 s38, 1835008
    s_mov_b32 s39, 0x00020000
    buffer_load_dwordx4 v58, s[36:39], s100 offen nt lds
    buffer_load_dwordx4 v58, s[36:39], s101 offen offset:1024 nt lds
    v_and_b32 v29, 1, v2
    v_lshl_add_u32 v56, v29, 5, v56
    v_and_b32 v29, 3, v0
    v_lshl_add_u32 v56, v29, 3, v56
    v_add_u32 v56, s58, v56
    v_xor_b32 v57, 32, v56
    s_and_b32 s57, s2, 7
    s_lshl_b32 s57, s57, 5
    v_and_b32 v4, 7, v0
    v_lshlrev_b32 v4, 5, v4
    s_waitcnt vmcnt(7)
    s_mov_b64 exec, 1
    buffer_atomic_add v31, v30, s[96:99], s57 offen sc1
    s_mov_b64 exec, -1
    s_barrier
    s_mov_b32 s40, s18
    s_mov_b32 s41, s19
    s_mov_b32 s42, 1835008
    s_mov_b32 s43, 0x00020000
    s_mul_i32 s57, s49, 57344
    s_and_b32 s58, s48, 1
    s_mul_i32 s58, s58, 1792
    s_add_u32 s57, s57, s58
    v_add_u32 v29, 0, v0
    v_mul_u32_u24 v62, 4682, v29
    v_lshrrev_b32 v62, 16, v62
    v_mul_u32_u24 v62, 1792, v62
    v_lshl_add_u32 v62, v29, 7, v62
    buffer_load_dword v61, v62, s[40:43], s57 offen offset:0
    buffer_load_dword v61, v62, s[40:43], s57 offen offset:64
    v_add_u32 v29, 64, v0
    v_mul_u32_u24 v63, 4682, v29
    v_lshrrev_b32 v63, 16, v63
    v_mul_u32_u24 v63, 1792, v63
    v_lshl_add_u32 v63, v29, 7, v63
    buffer_load_dword v61, v63, s[40:43], s57 offen offset:0
    buffer_load_dword v61, v63, s[40:43], s57 offen offset:64
    v_add_u32 v29, 128, v0
    v_mul_u32_u24 v64, 4682, v29
    v_lshrrev_b32 v64, 16, v64
    v_mul_u32_u24 v64, 1792, v64
    v_lshl_add_u32 v64, v29, 7, v64
    buffer_load_dword v61, v64, s[40:43], s57 offen offset:0
    buffer_load_dword v61, v64, s[40:43], s57 offen offset:64
    v_add_u32 v29, 192, v0
    v_mul_u32_u24 v65, 4682, v29
    v_lshrrev_b32 v65, 16, v65
    v_mul_u32_u24 v65, 1792, v65
    v_lshl_add_u32 v65, v29, 7, v65
    s_mov_b32 exec_hi, 0
    buffer_load_dword v61, v65, s[40:43], s57 offen offset:0
    buffer_load_dword v61, v65, s[40:43], s57 offen offset:64
    s_mov_b64 exec, -1
    s_waitcnt vmcnt(9)
    ds_read_b64_tr_b16 v[70:71], v56 offset:0
    ds_read_b64_tr_b16 v[72:73], v56 offset:1024
    ds_read_b64_tr_b16 v[74:75], v57 offset:0
    ds_read_b64_tr_b16 v[76:77], v57 offset:1024
    v_lshl_add_u32 v29, v2, 3, v1
    v_sub_u32 v29, 15, v29
    v_and_b32 v23, 1, v29
    v_lshlrev_b32 v23, 4, v23
    v_lshrrev_b32 v29, 1, v29
    s_and_b32 s58, s3, 1
    s_lshl_b32 s58, s58, 4
    s_waitcnt lgkmcnt(0)
    s_lshr_b32 s59, s16, s58
    s_and_b32 s59, s59, 0xffff
    v_lshlrev_b32 v23, v23, s59
    v_cmp_eq_u32 vcc, 0, v29
    s_nop 1
    v_cndmask_b32 v20, 0, v23, vcc
    v_cmp_eq_u32 vcc, 1, v29
    s_nop 1
    v_cndmask_b32 v21, 0, v23, vcc
    v_cmp_eq_u32 vcc, 2, v29
    s_nop 1
    v_cndmask_b32 v22, 0, v23, vcc
    v_cmp_eq_u32 vcc, 3, v29
    s_nop 1
    v_cndmask_b32 v23, 0, v23, vcc
    buffer_store_dwordx4 v[70:73], v3, s[32:35], s94 offen offset:0 sc1
    buffer_store_dwordx4 v[74:77], v3, s[32:35], s94 offen offset:1024 sc1
    v_mov_b32 v86, 0
    v_mov_b32 v87, 0
    v_mov_b32 v88, 0
    v_mov_b32 v89, 0
    v_mov_b32 v90, 0
    v_mov_b32 v91, 0
    v_mov_b32 v92, 0
    v_mov_b32 v93, 0
    v_mov_b32 v94, 0
    v_mov_b32 v95, 0
    v_mov_b32 v96, 0
    v_mov_b32 v97, 0
    v_mov_b32 v98, 0
    v_mov_b32 v99, 0
    v_mov_b32_dpp v97, v32 wave_shr:1 row_mask:0xf bank_mask:0xf bound_ctrl:0
    v_mov_b32_dpp v101, v33 wave_shr:1 row_mask:0xf bank_mask:0xf bound_ctrl:0
    v_lshlrev_b32 v93, 16, v97
    v_lshlrev_b32 v100, 16, v97
    v_alignbit_b32 v101, v101, v97, 16
    s_mov_b64 exec, 3
    ds_write_b128 v59, v[86:89] offset:0
    ds_write_b128 v59, v[90:93] offset:4160
    ds_write_b128 v59, v[94:97] offset:8320
    ds_write_b128 v59, v[98:101] offset:12480
    s_mov_b64 exec, -1
    v_mov_b32_dpp v36, v38 wave_rol:1 row_mask:0xf bank_mask:0xf
    v_mov_b32_dpp v37, v39 wave_rol:1 row_mask:0xf bank_mask:0xf
    s_nop 0
    v_mov_b32_dpp v36, v32 wave_shl:1 row_mask:0xf bank_mask:0xf
    v_mov_b32_dpp v37, v33 wave_shl:1 row_mask:0xf bank_mask:0xf
    v_alignbit_b32 v62, v33, v32, 16
    v_alignbit_b32 v63, v34, v33, 16
    v_alignbit_b32 v64, v35, v34, 16
    v_alignbit_b32 v65, v36, v35, 16
    v_mov_b32 v66, v33
    v_mov_b32 v67, v34
    v_mov_b32 v68, v35
    v_mov_b32 v69, v36
    v_alignbit_b32 v70, v34, v33, 16
    v_alignbit_b32 v71, v35, v34, 16
    v_alignbit_b32 v72, v36, v35, 16
    v_alignbit_b32 v73, v37, v36, 16
    ds_write_b128 v59, v[32:35] offset:32
    ds_write_b128 v59, v[62:65] offset:4192
    ds_write_b128 v59, v[66:69] offset:8352
    ds_write_b128 v59, v[70:73] offset:12512
    ds_read_b64 v[128:129], v60 offset:0
    ds_read_b64 v[130:131], v60 offset:8
    ds_read_b64 v[132:133], v60 offset:64
    ds_read_b64 v[134:135], v60 offset:72
    ds_read_b64 v[136:137], v60 offset:128
    ds_read_b64 v[138:139], v60 offset:136
    ds_read_b64 v[140:141], v60 offset:192
    ds_read_b64 v[142:143], v60 offset:200
    ds_read_b64 v[144:145], v60 offset:256
    ds_read_b64 v[146:147], v60 offset:264
    ds_read_b64 v[148:149], v60 offset:320
    ds_read_b64 v[150:151], v60 offset:328
    ds_read_b64 v[152:153], v60 offset:384
    ds_read_b64 v[154:155], v60 offset:392
    ds_read_b64 v[156:157], v60 offset:448
    ds_read_b64 v[158:159], v60 offset:456
    v_add_u32 v29, 0, v0
    v_mul_u32_u24 v8, 4682, v29
    v_lshrrev_b32 v8, 16, v8
    v_mul_u32_u24 v8, 3360, v8
    v_add_u32 v8, v8, v3
    s_movk_i32 s59, 4096
    v_add_u32 v29, 64, v0
    v_mul_u32_u24 v9, 4682, v29
    v_lshrrev_b32 v9, 16, v9
    v_mul_u32_u24 v9, 3360, v9
    v_add_u32 v9, v9, v3
    v_add_u32 v29, 128, v0
    v_mul_u32_u24 v10, 4682, v29
    v_lshrrev_b32 v10, 16, v10
    v_mul_u32_u24 v10, 3360, v10
    v_add_u32 v10, v10, v3
    v_add_u32 v29, 192, v0
    v_mul_u32_u24 v11, 4682, v29
    v_lshrrev_b32 v11, 16, v11
    v_mul_u32_u24 v11, 3360, v11
    v_add_u32 v11, v11, v3
    v_add_u32 v29, 256, v0
    v_mul_u32_u24 v12, 4682, v29
    v_lshrrev_b32 v12, 16, v12
    v_mul_u32_u24 v12, 3360, v12
    v_add3_u32 v12, v12, v3, s59
    v_add_u32 v29, 320, v0
    v_mul_u32_u24 v13, 4682, v29
    v_lshrrev_b32 v13, 16, v13
    v_mul_u32_u24 v13, 3360, v13
    v_add3_u32 v13, v13, v3, s59
    v_add_u32 v29, 384, v0
    v_mul_u32_u24 v14, 4682, v29
    v_lshrrev_b32 v14, 16, v14
    v_mul_u32_u24 v14, 3360, v14
    v_add3_u32 v14, v14, v3, s59
    s_mul_i32 s57, s3, 8448
    s_add_u32 s57, s57, 114688
    v_lshlrev_b32 v29, 1, v1
    v_sub_u32 v29, v2, v29
    v_add_u32 v29, 30, v29
    v_lshl_add_u32 v15, v29, 4, s57
    v_mul_u32_u24 v29, 288, v2
    v_lshl_add_u32 v29, v1, 4, v29
    v_add_u32 v24, s57, v29
    v_add_u32 v27, s57, v3
    v_bfe_u32 v29, v0, 2, 2
    v_mul_u32_u24 v29, 288, v29
    v_lshl_add_u32 v29, v2, 4, v29
    v_and_b32 v25, 3, v0
    v_lshl_add_u32 v29, v25, 2, v29
    s_lshl_b32 s58, s3, 6
    s_add_u32 s57, s58, 114688
    v_add_u32 v25, s57, v29
    v_and_b32 v29, 7, v1
    v_and_b32 v26, 8, v1
    v_lshl_add_u32 v26, v29, 4, v26
    v_lshl_add_u32 v26, v2, 14, v26
    v_mov_b32_dpp v42, v44 wave_rol:1 row_mask:0xf bank_mask:0xf
    v_mov_b32_dpp v43, v45 wave_rol:1 row_mask:0xf bank_mask:0xf
    s_nop 0
    v_mov_b32_dpp v42, v38 wave_shl:1 row_mask:0xf bank_mask:0xf
    v_mov_b32_dpp v43, v39 wave_shl:1 row_mask:0xf bank_mask:0xf
    v_alignbit_b32 v74, v39, v38, 16
    v_alignbit_b32 v75, v40, v39, 16
    v_alignbit_b32 v76, v41, v40, 16
    v_alignbit_b32 v77, v42, v41, 16
    v_mov_b32 v78, v39
    v_mov_b32 v79, v40
    v_mov_b32 v80, v41
    v_mov_b32 v81, v42
    v_alignbit_b32 v82, v40, v39, 16
    v_alignbit_b32 v83, v41, v40, 16
    v_alignbit_b32 v84, v42, v41, 16
    v_alignbit_b32 v85, v43, v42, 16
    ds_read_b64 v[160:161], v60 offset:512
    ds_read_b64 v[162:163], v60 offset:520
    ds_read_b64 v[164:165], v60 offset:576
    ds_read_b64 v[166:167], v60 offset:584
    ds_read_b64 v[168:169], v60 offset:640
    ds_read_b64 v[170:171], v60 offset:648
    ds_read_b64 v[172:173], v60 offset:704
    ds_read_b64 v[174:175], v60 offset:712
    ds_read_b64 v[176:177], v60 offset:768
    ds_read_b64 v[178:179], v60 offset:776
    ds_read_b64 v[180:181], v60 offset:832
    ds_read_b64 v[182:183], v60 offset:840
    ds_read_b64 v[184:185], v60 offset:896
    ds_read_b64 v[186:187], v60 offset:904
    ds_read_b64 v[188:189], v60 offset:960
    ds_read_b64 v[190:191], v60 offset:968
    s_mov_b32 s44, s18
    s_mov_b32 s45, s19
    s_mov_b32 s46, 1835008
    s_mov_b32 s47, 0x00020000
    s_mul_i32 s4, s3, 8448
    s_add_u32 s4, s4, 114688
    s_lshl_b32 s59, s3, 10
    s_lshr_b32 s57, s53, 1
    s_lshl_b32 s57, s57, 15
    s_and_b32 s58, s53, 1
    s_lshl_b32 s58, s58, 3
    s_add_u32 s57, s57, s58
    s_add_u32 s57, s57, s59
    s_add_u32 s5, s57, 2097152
    s_lshl_b32 s57, s3, 9
    s_add_u32 s100, s57, 4194304
    s_lshl_b32 s57, s53, 2
    s_add_u32 s57, s57, s3
    s_lshl_b32 s101, s57, 12
    s_lshl_b32 s57, s53, 7
    s_lshl_b32 s59, s3, 16
    s_add_u32 s57, s57, s59
    s_add_u32 s6, s57, 6291456
    s_mul_i32 s58, s51, 224
    s_mul_i32 s59, s3, 458752
    s_add_u32 s58, s58, s59
    s_mul_i32 s59, s3, 7168
    s_and_b32 s60, s49, 1
    s_xor_b32 s57, s60, 2
    s_mul_i32 s57, s57, 28672
    s_add_u32 s36, s57, s59
    s_lshl_b32 s57, s57, 2
    s_add_u32 s40, s57, s58
    s_xor_b32 s57, s60, 3
    s_mul_i32 s57, s57, 28672
    s_add_u32 s37, s57, s59
    s_lshl_b32 s57, s57, 2
    s_add_u32 s41, s57, s58
    s_xor_b32 s57, s60, 0
    s_mul_i32 s57, s57, 28672
    s_add_u32 s38, s57, s59
    s_lshl_b32 s57, s57, 2
    s_add_u32 s42, s57, s58
    s_xor_b32 s57, s60, 1
    s_mul_i32 s57, s57, 28672
    s_add_u32 s39, s57, s59
    s_lshl_b32 s57, s57, 2
    s_add_u32 s43, s57, s58
    s_lshl_b32 s57, s2, 7
    s_lshl_b32 s58, s3, 2
    s_add_u32 s57, s57, s58
    s_add_u32 s10, s57, 15728640
    s_lshl_b32 s57, s49, 3
    s_add_u32 s57, s57, s48
    s_lshl_b32 s57, s57, 7
    s_add_u32 s57, s57, s58
    s_add_u32 s9, s57, 15728640
    s_lshl_b32 s57, s50, 2
    s_add_u32 s57, s57, s3
    s_lshl_b32 s58, s57, 14
    s_add_u32 s13, s58, 6291456
    s_mul_i32 s57, s57, 57344
    s_lshr_b32 s58, s51, 1
    s_mul_i32 s58, s58, 7168
    s_add_u32 s57, s57, s58
    s_add_u32 s57, s57, 8388608
    s_and_b32 s58, s51, 1
    s_mul_i32 s59, s58, 3072
    s_add_u32 s11, s57, s59
    s_lshl_b32 s58, s58, 9
    s_add_u32 s57, s57, s58
    s_add_u32 s12, s57, 6144
    s_lshl_b32 s57, s54, 1
    s_add_u32 s57, s57, s56
    s_and_b32 s59, s3, 1
    s_lshl_b32 s59, s59, 7
    s_lshr_b32 s58, s3, 1
    s_add_u32 s59, s59, s58
    s_lshl_b32 s58, s54, 1
    s_add_u32 s59, s59, s58
    s_lshl_b32 s59, s59, 7
    s_lshl_b32 s58, s56, 3
    s_add_u32 s59, s59, s58
    s_add_u32 s7, s59, 15728656
    s_mul_i32 s57, s57, 114688
    s_mul_i32 s58, s3, 14336
    s_add_u32 s57, s57, s58
    s_add_u32 s95, s57, 8388608
    s_mul_i32 s57, s55, 229376
    s_mul_i32 s58, s3, 57344
    s_add_u32 s57, s57, s58
    s_add_u32 s8, s57, 4325376
    s_mul_i32 s57, s3, 7168
    s_lshr_b32 s58, s55, 1
    s_lshl_b32 s58, s58, 7
    s_add_u32 s57, s57, s58
    s_and_b32 s58, s55, 1
    s_lshl_b32 s58, s58, 3
    s_add_u32 s57, s57, s58
    s_add_u32 s15, s57, 15728640
    ds_write_b128 v59, v[38:41] offset:1056
    ds_write_b128 v59, v[74:77] offset:5216
    ds_write_b128 v59, v[78:81] offset:9376
    ds_write_b128 v59, v[82:85] offset:13536
    ds_read_b64 v[192:193], v60 offset:1024
    ds_read_b64 v[194:195], v60 offset:1032
    ds_read_b64 v[196:197], v60 offset:1088
    ds_read_b64 v[198:199], v60 offset:1096
    ds_read_b64 v[200:201], v60 offset:1152
    ds_read_b64 v[202:203], v60 offset:1160
    ds_read_b64 v[204:205], v60 offset:1216
    ds_read_b64 v[206:207], v60 offset:1224
    ds_read_b64 v[208:209], v60 offset:1280
    ds_read_b64 v[210:211], v60 offset:1288
    ds_read_b64 v[212:213], v60 offset:1344
    ds_read_b64 v[214:215], v60 offset:1352
    ds_read_b64 v[216:217], v60 offset:1408
    ds_read_b64 v[218:219], v60 offset:1416
    ds_read_b64 v[220:221], v60 offset:1472
    ds_read_b64 v[222:223], v60 offset:1480
    v_mov_b32_dpp v48, v50 wave_rol:1 row_mask:0xf bank_mask:0xf
    v_mov_b32_dpp v49, v51 wave_rol:1 row_mask:0xf bank_mask:0xf
    s_nop 0
    v_mov_b32_dpp v48, v44 wave_shl:1 row_mask:0xf bank_mask:0xf
    v_mov_b32_dpp v49, v45 wave_shl:1 row_mask:0xf bank_mask:0xf
    v_alignbit_b32 v62, v45, v44, 16
    v_alignbit_b32 v63, v46, v45, 16
    v_alignbit_b32 v64, v47, v46, 16
    v_alignbit_b32 v65, v48, v47, 16
    v_mov_b32 v66, v45
    v_mov_b32 v67, v46
    v_mov_b32 v68, v47
    v_mov_b32 v69, v48
    v_alignbit_b32 v70, v46, v45, 16
    v_alignbit_b32 v71, v47, v46, 16
    v_alignbit_b32 v72, v48, v47, 16
    v_alignbit_b32 v73, v49, v48, 16
    ds_read_b64 v[224:225], v60 offset:1536
    ds_read_b64 v[226:227], v60 offset:1544
    ds_read_b64 v[228:229], v60 offset:1600
    ds_read_b64 v[230:231], v60 offset:1608
    ds_read_b64 v[232:233], v60 offset:1664
    ds_read_b64 v[234:235], v60 offset:1672
    ds_read_b64 v[236:237], v60 offset:1728
    ds_read_b64 v[238:239], v60 offset:1736
    ds_read_b64 v[240:241], v60 offset:1792
    ds_read_b64 v[242:243], v60 offset:1800
    ds_read_b64 v[244:245], v60 offset:1856
    ds_read_b64 v[246:247], v60 offset:1864
    ds_read_b64 v[248:249], v60 offset:1920
    ds_read_b64 v[250:251], v60 offset:1928
    ds_read_b64 v[252:253], v60 offset:1984
    ds_read_b64 v[254:255], v60 offset:1992
    ds_write_b128 v59, v[44:47] offset:2080
    ds_write_b128 v59, v[62:65] offset:6240
    ds_write_b128 v59, v[66:69] offset:10400
    ds_write_b128 v59, v[70:73] offset:14560
    ds_read_b64 a[0:1], v60 offset:2048
    ds_read_b64 a[2:3], v60 offset:2056
    ds_read_b64 a[4:5], v60 offset:2112
    ds_read_b64 a[6:7], v60 offset:2120
    ds_read_b64 a[8:9], v60 offset:2176
    ds_read_b64 a[10:11], v60 offset:2184
    ds_read_b64 a[12:13], v60 offset:2240
    ds_read_b64 a[14:15], v60 offset:2248
    ds_read_b64 a[16:17], v60 offset:2304
    ds_read_b64 a[18:19], v60 offset:2312
    ds_read_b64 a[20:21], v60 offset:2368
    ds_read_b64 a[22:23], v60 offset:2376
    ds_read_b64 a[24:25], v60 offset:2432
    ds_read_b64 a[26:27], v60 offset:2440
    ds_read_b64 a[28:29], v60 offset:2496
    ds_read_b64 a[30:31], v60 offset:2504
    v_mov_b32_dpp v54, v50 wave_shl:1 row_mask:0xf bank_mask:0xf
    v_mov_b32_dpp v55, v51 wave_shl:1 row_mask:0xf bank_mask:0xf
    v_alignbit_b32 v74, v51, v50, 16
    v_alignbit_b32 v75, v52, v51, 16
    v_alignbit_b32 v76, v53, v52, 16
    v_alignbit_b32 v77, v54, v53, 16
    v_mov_b32 v78, v51
    v_mov_b32 v79, v52
    v_mov_b32 v80, v53
    v_mov_b32 v81, v54
    v_alignbit_b32 v82, v52, v51, 16
    v_alignbit_b32 v83, v53, v52, 16
    v_alignbit_b32 v84, v54, v53, 16
    v_alignbit_b32 v85, v55, v54, 16
    ds_read_b64 a[32:33], v60 offset:2560
    ds_read_b64 a[34:35], v60 offset:2568
    ds_read_b64 a[36:37], v60 offset:2624
    ds_read_b64 a[38:39], v60 offset:2632
    ds_read_b64 a[40:41], v60 offset:2688
    ds_read_b64 a[42:43], v60 offset:2696
    ds_read_b64 a[44:45], v60 offset:2752
    ds_read_b64 a[46:47], v60 offset:2760
    ds_read_b64 a[48:49], v60 offset:2816
    ds_read_b64 a[50:51], v60 offset:2824
    ds_read_b64 a[52:53], v60 offset:2880
    ds_read_b64 a[54:55], v60 offset:2888
    ds_read_b64 a[56:57], v60 offset:2944
    ds_read_b64 a[58:59], v60 offset:2952
    ds_read_b64 a[60:61], v60 offset:3008
    ds_read_b64 a[62:63], v60 offset:3016
    ds_write_b128 v59, v[50:53] offset:3104
    ds_write_b128 v59, v[74:77] offset:7264
    ds_write_b128 v59, v[78:81] offset:11424
    ds_write_b128 v59, v[82:85] offset:15584
    ds_read_b64 a[64:65], v60 offset:3072
    ds_read_b64 a[66:67], v60 offset:3080
    ds_read_b64 a[68:69], v60 offset:3136
    ds_read_b64 a[70:71], v60 offset:3144
    ds_read_b64 a[72:73], v60 offset:3200
    ds_read_b64 a[74:75], v60 offset:3208
    ds_read_b64 a[76:77], v60 offset:3264
    ds_read_b64 a[78:79], v60 offset:3272
    ds_read_b64 a[80:81], v60 offset:3328
    ds_read_b64 a[82:83], v60 offset:3336
    ds_read_b64 a[84:85], v60 offset:3392
    ds_read_b64 a[86:87], v60 offset:3400
    ds_read_b64 a[88:89], v60 offset:3456
    ds_read_b64 a[90:91], v60 offset:3464
    ds_read_b64 a[92:93], v60 offset:3520
    ds_read_b64 a[94:95], v60 offset:3528
    ds_read_b64 a[96:97], v60 offset:3584
    ds_read_b64 a[98:99], v60 offset:3592
    ds_read_b64 a[100:101], v60 offset:3648
    ds_read_b64 a[102:103], v60 offset:3656
    ds_read_b64 a[104:105], v60 offset:3712
    ds_read_b64 a[106:107], v60 offset:3720
    ds_read_b64 a[108:109], v60 offset:3776
    ds_read_b64 a[110:111], v60 offset:3784
    ds_read_b64 a[112:113], v60 offset:3840
    ds_read_b64 a[114:115], v60 offset:3848
    ds_read_b64 a[116:117], v60 offset:3904
    ds_read_b64 a[118:119], v60 offset:3912
    ds_read_b64 a[120:121], v60 offset:3968
    ds_read_b64 a[122:123], v60 offset:3976
    ds_read_b64 a[124:125], v60 offset:4032
    ds_read_b64 a[126:127], v60 offset:4040
    buffer_load_dword v5, v4, s[96:99], 0 offen sc1
    s_mov_b32 m0, s36
    s_nop 0
    buffer_load_dwordx4 v8, s[44:47], s40 offen offset:0 lds
    buffer_load_dwordx4 v9, s[44:47], s40 offen offset:1024 lds
    buffer_load_dwordx4 v10, s[44:47], s40 offen offset:2048 lds
    buffer_load_dwordx4 v11, s[44:47], s40 offen offset:3072 lds
    s_add_u32 m0, s36, 4096
    s_nop 0
    buffer_load_dwordx4 v12, s[44:47], s40 offen offset:0 lds
    buffer_load_dwordx4 v13, s[44:47], s40 offen offset:1024 lds
    buffer_load_dwordx4 v14, s[44:47], s40 offen offset:2048 lds
    v_mov_b32 v30, 0
    v_mov_b32 v31, 1
    s_waitcnt vmcnt(8)
    s_mov_b64 exec, 1
    buffer_store_dword v31, v30, s[32:35], s10 offen sc1
    s_mov_b64 exec, -1
    s_waitcnt vmcnt(8)
    v_cmp_ne_u32 vcc, 32, v5
    s_cbranch_vccz GODONE_2
GOP_1:
    buffer_load_dword v5, v4, s[96:99], 0 offen sc1
    s_sub_u32 s64, s64, 1
    s_cmp_lt_i32 s64, 0
    s_cbranch_scc1 GODONE_2
    s_waitcnt vmcnt(0)
    v_cmp_ne_u32 vcc, 32, v5
    s_cbranch_vccnz GOP_1
GODONE_2:
JOIN_A:
    s_waitcnt lgkmcnt(0)
    s_barrier
    s_cmp_eq_u32 s52, 1
    s_cbranch_scc1 PATH_B1
    buffer_load_dwordx4 v[96:99], v3, s[32:35], s101 offen offset:0 sc1
    buffer_load_dwordx4 v[100:103], v3, s[32:35], s101 offen offset:1024 sc1
    buffer_load_dwordx4 v[104:107], v3, s[32:35], s101 offen offset:2048 sc1
    buffer_load_dwordx4 v[108:111], v3, s[32:35], s101 offen offset:3072 sc1
    v_lshlrev_b32 v5, 3, v0
    s_mov_b32 m0, s37
    s_nop 0
    buffer_load_dwordx4 v8, s[44:47], s41 offen offset:0 lds
    buffer_load_dwordx4 v9, s[44:47], s41 offen offset:1024 lds
    buffer_load_dwordx4 v10, s[44:47], s41 offen offset:2048 lds
    buffer_load_dwordx4 v11, s[44:47], s41 offen offset:3072 lds
    v_mov_b32 v64, 0
    v_mov_b32 v65, 0
    v_mov_b32 v66, 0
    v_mov_b32 v67, 0
    s_mov_b32 exec_hi, 0
    ds_write_b128 v27, v[64:67] offset:4096
    s_mov_b64 exec, -1
    v_min_u32 v4, 13, v0
    v_lshlrev_b32 v4, 9, v4
    s_add_u32 s57, s6, 0
    s_add_u32 s58, s6, 786432
    s_add_u32 s17, s6, 1048576
    s_add_u32 s20, s6, 1835008
    s_waitcnt vmcnt(4)
    s_add_u32 s61, s100, 0
    buffer_load_dwordx2 v[40:41], v5, s[32:35], s61 offen sc1
    s_add_u32 s61, s100, 6144
    buffer_load_dwordx2 v[42:43], v5, s[32:35], s61 offen sc1
    s_add_u32 s61, s100, 8192
    buffer_load_dwordx2 v[44:45], v5, s[32:35], s61 offen sc1
    s_add_u32 s61, s100, 14336
    buffer_load_dwordx2 v[46:47], v5, s[32:35], s61 offen sc1
    v_max3_u32 v29, v96, v100, v104
    v_max_u32 v29, v29, v108
    v_cmp_eq_u32 vcc, -1, v29
    s_cbranch_vccnz RTU_3
BKU_4:
    ds_write_b128 v27, v[108:111] offset:3072
    ds_write_b128 v27, v[104:107] offset:2048
    ds_write_b128 v27, v[100:103] offset:1024
    ds_write_b128 v27, v[96:99] offset:0
    ds_read_b128 v[64:67], v15 offset:2048
    ds_read_b128 v[68:71], v15 offset:2112
    ds_read_b128 v[72:75], v15 offset:2176
    ds_read_b128 v[76:79], v15 offset:2240
    ds_read_b128 v[80:83], v15 offset:2304
    ds_read_b128 v[84:87], v15 offset:2368
    ds_read_b128 v[88:91], v15 offset:2432
    ds_read_b128 v[92:95], v15 offset:2496
    s_waitcnt lgkmcnt(7)
    v_mfma_f32_16x16x32_bf16 v[52:55], v[128:131], v[64:67], 0
    v_mfma_f32_16x16x32_bf16 v[52:55], v[20:23], v[64:67], v[52:55]
    s_waitcnt lgkmcnt(6)
    ds_read_b128 v[64:67], v15 offset:2560
    v_mfma_f32_16x16x32_bf16 v[52:55], v[132:135], v[68:71], v[52:55]
    s_waitcnt lgkmcnt(6)
    ds_read_b128 v[68:71], v15 offset:2624
    s_add_u32 m0, s37, 4096
    s_nop 0
    buffer_load_dwordx4 v12, s[44:47], s41 offen offset:0 lds
    v_mfma_f32_16x16x32_bf16 v[52:55], v[136:139], v[72:75], v[52:55]
    s_waitcnt lgkmcnt(6)
    ds_read_b128 v[72:75], v15 offset:2688
    v_mfma_f32_16x16x32_bf16 v[52:55], v[140:143], v[76:79], v[52:55]
    s_waitcnt lgkmcnt(6)
    ds_read_b128 v[76:79], v15 offset:2752
    v_mfma_f32_16x16x32_bf16 v[52:55], v[144:147], v[80:83], v[52:55]
    s_waitcnt lgkmcnt(6)
    ds_read_b128 v[80:83], v15 offset:2816
    v_mfma_f32_16x16x32_bf16 v[52:55], v[148:151], v[84:87], v[52:55]
    s_waitcnt lgkmcnt(6)
    ds_read_b128 v[84:87], v15 offset:2880
    buffer_load_dwordx4 v13, s[44:47], s41 offen offset:1024 lds
    v_mfma_f32_16x16x32_bf16 v[52:55], v[152:155], v[88:91], v[52:55]
    s_waitcnt lgkmcnt(6)
    ds_read_b128 v[88:91], v15 offset:2944
    v_mfma_f32_16x16x32_bf16 v[52:55], v[156:159], v[92:95], v[52:55]
    s_waitcnt lgkmcnt(6)
    ds_read_b128 v[92:95], v15 offset:3008
    v_mfma_f32_16x16x32_bf16 v[52:55], v[160:163], v[64:67], v[52:55]
    s_waitcnt lgkmcnt(6)
    ds_read_b128 v[64:67], v15 offset:3072
    v_mfma_f32_16x16x32_bf16 v[52:55], v[164:167], v[68:71], v[52:55]
    s_waitcnt lgkmcnt(6)
    ds_read_b128 v[68:71], v15 offset:3136
    buffer_load_dwordx4 v14, s[44:47], s41 offen offset:2048 lds
    v_mfma_f32_16x16x32_bf16 v[52:55], v[168:171], v[72:75], v[52:55]
    s_waitcnt lgkmcnt(6)
    ds_read_b128 v[72:75], v15 offset:3200
    v_mfma_f32_16x16x32_bf16 v[52:55], v[172:175], v[76:79], v[52:55]
    s_waitcnt lgkmcnt(6)
    ds_read_b128 v[76:79], v15 offset:3264
    v_mfma_f32_16x16x32_bf16 v[52:55], v[176:179], v[80:83], v[52:55]
    s_waitcnt lgkmcnt(6)
    ds_read_b128 v[80:83], v15 offset:3328
    v_mfma_f32_16x16x32_bf16 v[52:55], v[180:183], v[84:87], v[52:55]
    s_waitcnt lgkmcnt(6)
    ds_read_b128 v[84:87], v15 offset:3392
    s_mov_b32 m0, s38
    s_nop 0
    buffer_load_dwordx4 v8, s[44:47], s42 offen offset:0 lds
    v_mfma_f32_16x16x32_bf16 v[52:55], v[184:187], v[88:91], v[52:55]
    s_waitcnt lgkmcnt(6)
    ds_read_b128 v[88:91], v15 offset:3456
    v_mfma_f32_16x16x32_bf16 v[52:55], v[188:191], v[92:95], v[52:55]
    s_waitcnt lgkmcnt(6)
    ds_read_b128 v[92:95], v15 offset:3520
    s_waitcnt vmcnt(4)
    v_mfma_f32_16x16x32_bf16 v[52:55], v[192:195], v[64:67], v[52:55]
    s_waitcnt lgkmcnt(6)
    ds_read_b128 v[64:67], v15 offset:3584
    v_max3_u32 v29, v40, v42, v44
    v_mfma_f32_16x16x32_bf16 v[52:55], v[196:199], v[68:71], v[52:55]
    s_waitcnt lgkmcnt(6)
    ds_read_b128 v[68:71], v15 offset:3648
    v_max_u32 v29, v29, v46
    buffer_load_dwordx4 v9, s[44:47], s42 offen offset:1024 lds
    v_mfma_f32_16x16x32_bf16 v[52:55], v[200:203], v[72:75], v[52:55]
    s_waitcnt lgkmcnt(6)
    ds_read_b128 v[72:75], v15 offset:3712
    v_cmp_eq_u32 vcc, -1, v29
    v_mfma_f32_16x16x32_bf16 v[52:55], v[204:207], v[76:79], v[52:55]
    s_waitcnt lgkmcnt(6)
    ds_read_b128 v[76:79], v15 offset:3776
    s_cbranch_vccnz RTS_5
BKS_6:
    v_mfma_f32_16x16x32_bf16 v[52:55], v[208:211], v[80:83], v[52:55]
    s_waitcnt lgkmcnt(6)
    ds_read_b128 v[80:83], v15 offset:3840
    s_add_u32 s60, s5, 0
    buffer_load_dwordx2 v[32:33], v3, s[32:35], s60 offen sc1
    v_mfma_f32_16x16x32_bf16 v[52:55], v[212:215], v[84:87], v[52:55]
    s_waitcnt lgkmcnt(6)
    ds_read_b128 v[84:87], v15 offset:3904
    s_add_u32 s60, s5, 12288
    buffer_load_dwordx2 v[34:35], v3, s[32:35], s60 offen sc1
    buffer_load_dwordx4 v10, s[44:47], s42 offen offset:2048 lds
    v_mfma_f32_16x16x32_bf16 v[52:55], v[216:219], v[88:91], v[52:55]
    s_waitcnt lgkmcnt(6)
    ds_read_b128 v[88:91], v15 offset:3968
    s_add_u32 s60, s5, 16384
    buffer_load_dwordx2 v[36:37], v3, s[32:35], s60 offen sc1
    v_mfma_f32_16x16x32_bf16 v[52:55], v[220:223], v[92:95], v[52:55]
    s_waitcnt lgkmcnt(6)
    ds_read_b128 v[92:95], v15 offset:4032
    s_add_u32 s60, s5, 28672
    buffer_load_dwordx2 v[38:39], v3, s[32:35], s60 offen sc1
    v_mfma_f32_16x16x32_bf16 v[52:55], v[224:227], v[64:67], v[52:55]
    v_mfma_f32_16x16x32_bf16 v[48:51], v[128:131], v[64:67], 0
    s_nop 0
    buffer_load_dwordx4 v11, s[44:47], s42 offen offset:3072 lds
    v_mfma_f32_16x16x32_bf16 v[48:51], v[20:23], v[64:67], v[48:51]
    s_waitcnt lgkmcnt(6)
    ds_read_b128 v[64:67], v15 offset:0
    v_mfma_f32_16x16x32_bf16 v[52:55], v[228:231], v[68:71], v[52:55]
    v_mfma_f32_16x16x32_bf16 v[48:51], v[132:135], v[68:71], v[48:51]
    s_waitcnt lgkmcnt(6)
    ds_read_b128 v[68:71], v15 offset:64
    v_mfma_f32_16x16x32_bf16 v[52:55], v[232:235], v[72:75], v[52:55]
    s_add_u32 m0, s38, 4096
    s_nop 0
    buffer_load_dwordx4 v12, s[44:47], s42 offen offset:0 lds
    v_mfma_f32_16x16x32_bf16 v[48:51], v[136:139], v[72:75], v[48:51]
    s_waitcnt lgkmcnt(6)
    ds_read_b128 v[72:75], v15 offset:128
    v_mfma_f32_16x16x32_bf16 v[52:55], v[236:239], v[76:79], v[52:55]
    v_mfma_f32_16x16x32_bf16 v[48:51], v[140:143], v[76:79], v[48:51]
    s_waitcnt lgkmcnt(6)
    ds_read_b128 v[76:79], v15 offset:192
    v_mfma_f32_16x16x32_bf16 v[52:55], v[240:243], v[80:83], v[52:55]
    s_nop 0
    buffer_load_dwordx4 v13, s[44:47], s42 offen offset:1024 lds
    v_mfma_f32_16x16x32_bf16 v[48:51], v[144:147], v[80:83], v[48:51]
    s_waitcnt lgkmcnt(6)
    ds_read_b128 v[80:83], v15 offset:256
    v_mfma_f32_16x16x32_bf16 v[52:55], v[244:247], v[84:87], v[52:55]
    v_mfma_f32_16x16x32_bf16 v[48:51], v[148:151], v[84:87], v[48:51]
    s_waitcnt lgkmcnt(6)
    ds_read_b128 v[84:87], v15 offset:320
    v_mfma_f32_16x16x32_bf16 v[52:55], v[248:251], v[88:91], v[52:55]
    s_nop 0
    buffer_load_dwordx4 v14, s[44:47], s42 offen offset:2048 lds
    v_mfma_f32_16x16x32_bf16 v[48:51], v[152:155], v[88:91], v[48:51]
    s_waitcnt lgkmcnt(6)
    ds_read_b128 v[88:91], v15 offset:384
    v_mfma_f32_16x16x32_bf16 v[52:55], v[252:255], v[92:95], v[52:55]
    s_nop 0
    buffer_load_dwordx2 v[126:127], v4, s[32:35], s15 offen sc1
    v_mfma_f32_16x16x32_bf16 v[48:51], v[156:159], v[92:95], v[48:51]
    s_waitcnt lgkmcnt(6)
    ds_read_b128 v[92:95], v15 offset:448
    v_mfma_f32_16x16x32_bf16 v[60:63], v[128:131], v[64:67], 0
    s_mov_b32 m0, s39
    s_nop 0
    buffer_load_dwordx4 v8, s[44:47], s43 offen offset:0 lds
    v_mfma_f32_16x16x32_bf16 v[60:63], v[20:23], v[64:67], v[60:63]
    s_waitcnt lgkmcnt(6)
    ds_read_b128 v[64:67], v15 offset:512
    v_mfma_f32_16x16x32_bf16 v[60:63], v[132:135], v[68:71], v[60:63]
    s_waitcnt lgkmcnt(6)
    ds_read_b128 v[68:71], v15 offset:576
    ds_write_b128 v24, v[48:51] offset:4608
    v_mfma_f32_16x16x32_bf16 v[60:63], v[136:139], v[72:75], v[60:63]
    s_waitcnt lgkmcnt(7)
    ds_read_b128 v[72:75], v15 offset:640
    ds_write_b128 v24, v[52:55] offset:5888
    v_mfma_f32_16x16x32_bf16 v[60:63], v[140:143], v[76:79], v[60:63]
    s_waitcnt lgkmcnt(8)
    ds_read_b128 v[76:79], v15 offset:704
    buffer_load_dwordx4 v9, s[44:47], s43 offen offset:1024 lds
    s_waitcnt vmcnt(10)
    v_lshlrev_b32 v96, 16, v32
    v_mfma_f32_16x16x32_bf16 v[60:63], v[144:147], v[80:83], v[60:63]
    s_waitcnt lgkmcnt(8)
    ds_read_b128 v[80:83], v15 offset:768
    v_and_b32 v97, s65, v32
    v_lshlrev_b32 v98, 16, v33
    v_mfma_f32_16x16x32_bf16 v[60:63], v[148:151], v[84:87], v[60:63]
    s_waitcnt lgkmcnt(8)
    ds_read_b128 v[84:87], v15 offset:832
    v_and_b32 v99, s65, v33
    v_fma_f32 v104, v96, v40, v41
    v_mfma_f32_16x16x32_bf16 v[60:63], v[152:155], v[88:91], v[60:63]
    s_waitcnt lgkmcnt(8)
    ds_read_b128 v[88:91], v15 offset:896
    v_fma_f32 v105, v97, v40, v41
    v_fma_f32 v106, v98, v40, v41
    v_mfma_f32_16x16x32_bf16 v[60:63], v[156:159], v[92:95], v[60:63]
    s_waitcnt lgkmcnt(8)
    ds_read_b128 v[92:95], v15 offset:960
    buffer_load_dwordx4 v10, s[44:47], s43 offen offset:2048 lds
    v_fma_f32 v107, v99, v40, v41
    v_lshlrev_b32 v100, 16, v34
    v_mfma_f32_16x16x32_bf16 v[60:63], v[160:163], v[64:67], v[60:63]
    s_waitcnt lgkmcnt(8)
    ds_read_b128 v[64:67], v15 offset:1024
    v_and_b32 v101, s65, v34
    v_lshlrev_b32 v102, 16, v35
    v_mfma_f32_16x16x32_bf16 v[60:63], v[164:167], v[68:71], v[60:63]
    s_waitcnt lgkmcnt(7)
    ds_read_b128 v[68:71], v15 offset:1088
    v_and_b32 v103, s65, v35
    v_fma_f32 v108, v100, v42, v43
    v_mfma_f32_16x16x32_bf16 v[60:63], v[168:171], v[72:75], v[60:63]
    s_waitcnt lgkmcnt(6)
    ds_read_b128 v[72:75], v15 offset:1152
    v_fma_f32 v109, v101, v42, v43
    v_fma_f32 v110, v102, v42, v43
    v_mfma_f32_16x16x32_bf16 v[60:63], v[172:175], v[76:79], v[60:63]
    s_waitcnt lgkmcnt(6)
    ds_read_b128 v[76:79], v15 offset:1216
    buffer_load_dwordx4 v11, s[44:47], s43 offen offset:3072 lds
    v_fma_f32 v111, v103, v42, v43
    v_mfma_f32_16x16x32_bf16 v[60:63], v[176:179], v[80:83], v[60:63]
    s_waitcnt lgkmcnt(6)
    ds_read_b128 v[80:83], v15 offset:1280
    v_mfma_f32_16x16x32_bf16 v[60:63], v[180:183], v[84:87], v[60:63]
    s_waitcnt lgkmcnt(6)
    ds_read_b128 v[84:87], v15 offset:1344
    s_barrier
    ds_read2st64_b32 v[112:113], v25 offset0:18 offset1:51
    ds_read2st64_b32 v[114:115], v25 offset0:84 offset1:117
    v_mfma_f32_16x16x32_bf16 v[60:63], v[184:187], v[88:91], v[60:63]
    s_waitcnt lgkmcnt(8)
    ds_read_b128 v[88:91], v15 offset:1408
    ds_read2st64_b32 v[116:117], v25 offset0:23 offset1:56
    ds_read2st64_b32 v[118:119], v25 offset0:89 offset1:122
    v_mfma_f32_16x16x32_bf16 v[60:63], v[188:191], v[92:95], v[60:63]
    s_waitcnt lgkmcnt(10)
    ds_read_b128 v[92:95], v15 offset:1472
    s_add_u32 m0, s39, 4096
    s_nop 0
    buffer_load_dwordx4 v12, s[44:47], s43 offen offset:0 lds
    v_mfma_f32_16x16x32_bf16 v[60:63], v[192:195], v[64:67], v[60:63]
    s_waitcnt lgkmcnt(10)
    ds_read_b128 v[64:67], v15 offset:1536
    v_mfma_f32_16x16x32_bf16 v[60:63], v[196:199], v[68:71], v[60:63]
    s_waitcnt lgkmcnt(10)
    ds_read_b128 v[68:71], v15 offset:1600
    s_waitcnt lgkmcnt(6)
    v_fma_f32 v112, v104, v112, v96
    v_mfma_f32_16x16x32_bf16 v[60:63], v[200:203], v[72:75], v[60:63]
    s_nop 0
    ds_read_b128 v[72:75], v15 offset:1664
    v_fma_f32 v113, v105, v113, v97
    v_fma_f32 v114, v106, v114, v98
    v_mfma_f32_16x16x32_bf16 v[60:63], v[204:207], v[76:79], v[60:63]
    s_nop 0
    ds_read_b128 v[76:79], v15 offset:1728
    buffer_load_dwordx4 v13, s[44:47], s43 offen offset:1024 lds
    v_fma_f32 v115, v107, v115, v99
    v_cvt_pk_bf16_f32 v120, v112, v113
    v_mfma_f32_16x16x32_bf16 v[60:63], v[208:211], v[80:83], v[60:63]
    s_nop 0
    ds_read_b128 v[80:83], v15 offset:1792
    v_cvt_pk_bf16_f32 v121, v114, v115
    buffer_store_dwordx2 v[120:121], v26, s[32:35], s57 offen sc1
    v_mfma_f32_16x16x32_bf16 v[60:63], v[212:215], v[84:87], v[60:63]
    s_waitcnt lgkmcnt(8)
    ds_read_b128 v[84:87], v15 offset:1856
    s_waitcnt lgkmcnt(7)
    v_fma_f32 v116, v108, v116, v100
    v_mfma_f32_16x16x32_bf16 v[60:63], v[216:219], v[88:91], v[60:63]
    s_waitcnt lgkmcnt(6)
    ds_read_b128 v[88:91], v15 offset:1920
    v_fma_f32 v117, v109, v117, v101
    v_fma_f32 v118, v110, v118, v102
    v_mfma_f32_16x16x32_bf16 v[60:63], v[220:223], v[92:95], v[60:63]
    s_waitcnt lgkmcnt(6)
    ds_read_b128 v[92:95], v15 offset:1984
    buffer_load_dwordx4 v14, s[44:47], s43 offen offset:2048 lds
    v_fma_f32 v119, v111, v119, v103
    v_cvt_pk_bf16_f32 v122, v116, v117
    v_mfma_f32_16x16x32_bf16 v[60:63], v[224:227], v[64:67], v[60:63]
    v_cvt_pk_bf16_f32 v123, v118, v119
    buffer_store_dwordx2 v[122:123], v26, s[32:35], s58 offen sc1
    v_mfma_f32_16x16x32_bf16 v[56:59], v[128:131], v[64:67], 0
    v_mfma_f32_16x16x32_bf16 v[56:59], v[20:23], v[64:67], v[56:59]
    s_waitcnt lgkmcnt(6)
    ds_read_b128 v[64:67], v15 offset:2048
    v_mfma_f32_16x16x32_bf16 v[60:63], v[228:231], v[68:71], v[60:63]
    v_mfma_f32_16x16x32_bf16 v[56:59], v[132:135], v[68:71], v[56:59]
    s_waitcnt lgkmcnt(6)
    ds_read_b128 v[68:71], v15 offset:2112
    v_mfma_f32_16x16x32_bf16 v[60:63], v[232:235], v[72:75], v[60:63]
    v_mfma_f32_16x16x32_bf16 v[56:59], v[136:139], v[72:75], v[56:59]
    s_waitcnt lgkmcnt(6)
    ds_read_b128 v[72:75], v15 offset:2176
    v_mfma_f32_16x16x32_bf16 v[60:63], v[236:239], v[76:79], v[60:63]
    v_mfma_f32_16x16x32_bf16 v[56:59], v[140:143], v[76:79], v[56:59]
    s_waitcnt lgkmcnt(6)
    ds_read_b128 v[76:79], v15 offset:2240
    v_mfma_f32_16x16x32_bf16 v[60:63], v[240:243], v[80:83], v[60:63]
    v_mfma_f32_16x16x32_bf16 v[56:59], v[144:147], v[80:83], v[56:59]
    s_waitcnt lgkmcnt(6)
    ds_read_b128 v[80:83], v15 offset:2304
    v_mfma_f32_16x16x32_bf16 v[60:63], v[244:247], v[84:87], v[60:63]
    v_mfma_f32_16x16x32_bf16 v[56:59], v[148:151], v[84:87], v[56:59]
    s_waitcnt lgkmcnt(6)
    ds_read_b128 v[84:87], v15 offset:2368
    v_mfma_f32_16x16x32_bf16 v[60:63], v[248:251], v[88:91], v[60:63]
    s_waitcnt vmcnt(9)
    v_and_b32 v126, v126, v127
    v_cmp_ne_u32 vcc, 1, v126
    s_cbranch_vccnz FP_7
FD_8:
    v_mfma_f32_16x16x32_bf16 v[56:59], v[152:155], v[88:91], v[56:59]
    s_waitcnt lgkmcnt(6)
    ds_read_b128 v[88:91], v15 offset:2432
    s_add_u32 s63, s8, 0
    buffer_load_dwordx4 a[128:131], v3, s[32:35], s63 offen offset:0 sc1
    v_mfma_f32_16x16x32_bf16 v[60:63], v[252:255], v[92:95], v[60:63]
    v_mfma_f32_16x16x32_bf16 v[56:59], v[156:159], v[92:95], v[56:59]
    s_waitcnt lgkmcnt(6)
    ds_read_b128 v[92:95], v15 offset:2496
    v_mfma_f32_16x16x32_bf16 v[60:63], a[0:3], v[64:67], v[60:63]
    s_add_u32 s59, s3, 0
    v_mfma_f32_16x16x32_bf16 v[56:59], v[160:163], v[64:67], v[56:59]
    s_waitcnt lgkmcnt(6)
    ds_read_b128 v[64:67], v15 offset:2560
    s_and_b32 s59, s59, 3
    v_mfma_f32_16x16x32_bf16 v[60:63], a[4:7], v[68:71], v[60:63]
    s_mul_i32 s36, s59, 7168
    v_mfma_f32_16x16x32_bf16 v[56:59], v[164:167], v[68:71], v[56:59]
    s_waitcnt lgkmcnt(6)
    ds_read_b128 v[68:71], v15 offset:2624
    buffer_load_dwordx4 a[132:135], v3, s[32:35], s63 offen offset:1024 sc1
    s_lshl_b32 s59, s59, 12
    v_mfma_f32_16x16x32_bf16 v[60:63], a[8:11], v[72:75], v[60:63]
    s_add_u32 s40, s59, s13
    v_mfma_f32_16x16x32_bf16 v[56:59], v[168:171], v[72:75], v[56:59]
    s_waitcnt lgkmcnt(6)
    ds_read_b128 v[72:75], v15 offset:2688
    s_add_u32 s59, s3, 1
    v_mfma_f32_16x16x32_bf16 v[60:63], a[12:15], v[76:79], v[60:63]
    s_and_b32 s59, s59, 3
    v_mfma_f32_16x16x32_bf16 v[56:59], v[172:175], v[76:79], v[56:59]
    s_waitcnt lgkmcnt(6)
    ds_read_b128 v[76:79], v15 offset:2752
    s_mul_i32 s37, s59, 7168
    v_mfma_f32_16x16x32_bf16 v[60:63], a[16:19], v[80:83], v[60:63]
    s_lshl_b32 s59, s59, 12
    v_mfma_f32_16x16x32_bf16 v[56:59], v[176:179], v[80:83], v[56:59]
    s_waitcnt lgkmcnt(6)
    ds_read_b128 v[80:83], v15 offset:2816
    buffer_load_dwordx4 a[136:139], v3, s[32:35], s63 offen offset:2048 sc1
    s_add_u32 s41, s59, s13
    v_mfma_f32_16x16x32_bf16 v[60:63], a[20:23], v[84:87], v[60:63]
    s_add_u32 s59, s3, 2
    v_mfma_f32_16x16x32_bf16 v[56:59], v[180:183], v[84:87], v[56:59]
    s_waitcnt lgkmcnt(6)
    ds_read_b128 v[84:87], v15 offset:2880
    s_and_b32 s59, s59, 3
    v_mfma_f32_16x16x32_bf16 v[60:63], a[24:27], v[88:91], v[60:63]
    s_mul_i32 s38, s59, 7168
    v_mfma_f32_16x16x32_bf16 v[56:59], v[184:187], v[88:91], v[56:59]
    s_waitcnt lgkmcnt(6)
    ds_read_b128 v[88:91], v15 offset:2944
    s_lshl_b32 s59, s59, 12
    v_mfma_f32_16x16x32_bf16 v[60:63], a[28:31], v[92:95], v[60:63]
    s_add_u32 s42, s59, s13
    v_mfma_f32_16x16x32_bf16 v[56:59], v[188:191], v[92:95], v[56:59]
    s_waitcnt lgkmcnt(6)
    ds_read_b128 v[92:95], v15 offset:3008
    buffer_load_dwordx4 a[140:143], v3, s[32:35], s63 offen offset:3072 sc1
    s_add_u32 s59, s3, 3
    v_mfma_f32_16x16x32_bf16 v[60:63], a[32:35], v[64:67], v[60:63]
    s_and_b32 s59, s59, 3
    v_mfma_f32_16x16x32_bf16 v[56:59], v[192:195], v[64:67], v[56:59]
    s_waitcnt lgkmcnt(6)
    ds_read_b128 v[64:67], v15 offset:3072
    s_mul_i32 s39, s59, 7168
    v_mfma_f32_16x16x32_bf16 v[60:63], a[36:39], v[68:71], v[60:63]
    s_lshl_b32 s59, s59, 12
    v_mfma_f32_16x16x32_bf16 v[56:59], v[196:199], v[68:71], v[56:59]
    s_waitcnt lgkmcnt(6)
    ds_read_b128 v[68:71], v15 offset:3136
    s_add_u32 s43, s59, s13
    v_mfma_f32_16x16x32_bf16 v[60:63], a[40:43], v[72:75], v[60:63]
    v_lshrrev_b32 v11, 2, v1
    v_mfma_f32_16x16x32_bf16 v[56:59], v[200:203], v[72:75], v[56:59]
    s_waitcnt lgkmcnt(6)
    ds_read_b128 v[72:75], v15 offset:3200
    s_add_u32 s63, s8, 12288
    buffer_load_dwordx4 a[144:147], v3, s[32:35], s63 offen offset:0 sc1
    v_lshl_add_u32 v11, v2, 2, v11
    v_mfma_f32_16x16x32_bf16 v[60:63], a[44:47], v[76:79], v[60:63]
    v_mul_u32_u24 v8, 224, v11
    v_mfma_f32_16x16x32_bf16 v[56:59], v[204:207], v[76:79], v[56:59]
    s_waitcnt lgkmcnt(6)
    ds_read_b128 v[76:79], v15 offset:3264
    v_and_b32 v11, 3, v0
    v_mfma_f32_16x16x32_bf16 v[60:63], a[48:51], v[80:83], v[60:63]
    v_lshl_add_u32 v8, v11, 3, v8
    v_mfma_f32_16x16x32_bf16 v[56:59], v[208:211], v[80:83], v[56:59]
    s_waitcnt lgkmcnt(6)
    ds_read_b128 v[80:83], v15 offset:3328
    v_add_u32 v9, 57344, v8
    v_mfma_f32_16x16x32_bf16 v[60:63], a[52:55], v[84:87], v[60:63]
    v_add_u32 v10, s36, v8
    v_mfma_f32_16x16x32_bf16 v[56:59], v[212:215], v[84:87], v[56:59]
    s_waitcnt lgkmcnt(6)
    ds_read_b128 v[84:87], v15 offset:3392
    buffer_load_dwordx4 a[148:151], v3, s[32:35], s63 offen offset:1024 sc1
    v_mfma_f32_16x16x32_bf16 v[60:63], a[56:59], v[88:91], v[60:63]
    v_mfma_f32_16x16x32_bf16 v[56:59], v[216:219], v[88:91], v[56:59]
    s_waitcnt lgkmcnt(6)
    ds_read_b128 v[88:91], v15 offset:3456
    v_mfma_f32_16x16x32_bf16 v[60:63], a[60:63], v[92:95], v[60:63]
    v_mfma_f32_16x16x32_bf16 v[56:59], v[220:223], v[92:95], v[56:59]
    s_waitcnt lgkmcnt(6)
    ds_read_b128 v[92:95], v15 offset:3520
    v_mfma_f32_16x16x32_bf16 v[60:63], a[64:67], v[64:67], v[60:63]
    v_mfma_f32_16x16x32_bf16 v[56:59], v[224:227], v[64:67], v[56:59]
    s_waitcnt lgkmcnt(6)
    ds_read_b128 v[64:67], v15 offset:3584
    buffer_load_dwordx4 a[152:155], v3, s[32:35], s63 offen offset:2048 sc1
    v_mfma_f32_16x16x32_bf16 v[60:63], a[68:71], v[68:71], v[60:63]
    v_mfma_f32_16x16x32_bf16 v[56:59], v[228:231], v[68:71], v[56:59]
    s_waitcnt lgkmcnt(6)
    ds_read_b128 v[68:71], v15 offset:3648
    v_mfma_f32_16x16x32_bf16 v[60:63], a[72:75], v[72:75], v[60:63]
    v_mfma_f32_16x16x32_bf16 v[56:59], v[232:235], v[72:75], v[56:59]
    s_waitcnt lgkmcnt(6)
    ds_read_b128 v[72:75], v15 offset:3712
    v_lshlrev_b32 v96, 16, v36
    v_mfma_f32_16x16x32_bf16 v[60:63], a[76:79], v[76:79], v[60:63]
    v_and_b32 v97, s65, v36
    v_mfma_f32_16x16x32_bf16 v[56:59], v[236:239], v[76:79], v[56:59]
    s_waitcnt lgkmcnt(6)
    ds_read_b128 v[76:79], v15 offset:3776
    buffer_load_dwordx4 a[156:159], v3, s[32:35], s63 offen offset:3072 sc1
    v_lshlrev_b32 v98, 16, v37
    v_mfma_f32_16x16x32_bf16 v[60:63], a[80:83], v[80:83], v[60:63]
    v_and_b32 v99, s65, v37
    v_mfma_f32_16x16x32_bf16 v[56:59], v[240:243], v[80:83], v[56:59]
    s_waitcnt lgkmcnt(6)
    ds_read_b128 v[80:83], v15 offset:3840
    s_add_u32 s62, s11, 3670016
    buffer_store_dwordx4 v[16:19], v3, s[32:35], s62 offen offset:0 sc1
    v_fma_f32 v104, v96, v44, v45
    v_mfma_f32_16x16x32_bf16 v[60:63], a[84:87], v[84:87], v[60:63]
    v_fma_f32 v105, v97, v44, v45
    v_mfma_f32_16x16x32_bf16 v[56:59], v[244:247], v[84:87], v[56:59]
    s_waitcnt lgkmcnt(6)
    ds_read_b128 v[84:87], v15 offset:3904
    v_fma_f32 v106, v98, v44, v45
    v_mfma_f32_16x16x32_bf16 v[60:63], a[88:91], v[88:91], v[60:63]
    s_nop 0
    buffer_store_dwordx4 v[16:19], v3, s[32:35], s62 offen offset:1024 sc1
    v_fma_f32 v107, v99, v44, v45
    v_mfma_f32_16x16x32_bf16 v[56:59], v[248:251], v[88:91], v[56:59]
    s_waitcnt lgkmcnt(6)
    ds_read_b128 v[88:91], v15 offset:3968
    v_lshlrev_b32 v100, 16, v38
    v_mfma_f32_16x16x32_bf16 v[60:63], a[92:95], v[92:95], v[60:63]
    v_and_b32 v101, s65, v38
    v_mfma_f32_16x16x32_bf16 v[56:59], v[252:255], v[92:95], v[56:59]
    s_waitcnt lgkmcnt(6)
    ds_read_b128 v[92:95], v15 offset:4032
    buffer_store_dwordx4 v[16:19], v3, s[32:35], s62 offen offset:2048 sc1
    v_lshlrev_b32 v102, 16, v39
    v_mfma_f32_16x16x32_bf16 v[60:63], a[96:99], v[64:67], v[60:63]
    v_and_b32 v103, s65, v39
    v_mfma_f32_16x16x32_bf16 v[56:59], a[0:3], v[64:67], v[56:59]
    s_waitcnt lgkmcnt(6)
    v_fma_f32 v108, v100, v46, v47
    v_mfma_f32_16x16x32_bf16 v[60:63], a[100:103], v[68:71], v[60:63]
    s_add_u32 s62, s12, 3670016
    buffer_store_dwordx2 v[16:17], v5, s[32:35], s62 offen sc1
    v_fma_f32 v109, v101, v46, v47
    v_mfma_f32_16x16x32_bf16 v[56:59], a[4:7], v[68:71], v[56:59]
    s_waitcnt lgkmcnt(5)
    v_fma_f32 v110, v102, v46, v47
    v_mfma_f32_16x16x32_bf16 v[60:63], a[104:107], v[72:75], v[60:63]
    v_fma_f32 v111, v103, v46, v47
    v_mfma_f32_16x16x32_bf16 v[56:59], a[8:11], v[72:75], v[56:59]
    s_waitcnt lgkmcnt(4)
    v_mfma_f32_16x16x32_bf16 v[60:63], a[108:111], v[76:79], v[60:63]
    v_mfma_f32_16x16x32_bf16 v[56:59], a[12:15], v[76:79], v[56:59]
    s_waitcnt lgkmcnt(3)
    v_mfma_f32_16x16x32_bf16 v[60:63], a[112:115], v[80:83], v[60:63]
    v_mfma_f32_16x16x32_bf16 v[56:59], a[16:19], v[80:83], v[56:59]
    s_waitcnt lgkmcnt(2)
    v_mfma_f32_16x16x32_bf16 v[60:63], a[116:119], v[84:87], v[60:63]
    v_mfma_f32_16x16x32_bf16 v[56:59], a[20:23], v[84:87], v[56:59]
    s_waitcnt lgkmcnt(1)
    v_mfma_f32_16x16x32_bf16 v[60:63], a[120:123], v[88:91], v[60:63]
    v_mfma_f32_16x16x32_bf16 v[56:59], a[24:27], v[88:91], v[56:59]
    s_waitcnt lgkmcnt(0)
    v_mov_b32 v16, v5
    v_and_b32 v18, 8, v1
    v_and_b32 v19, 7, v1
    v_mfma_f32_16x16x32_bf16 v[60:63], a[124:127], v[92:95], v[60:63]
    v_lshlrev_b32 v18, 6, v18
    v_lshl_add_u32 v18, v19, 4, v18
    v_mfma_f32_16x16x32_bf16 v[56:59], a[28:31], v[92:95], v[56:59]
    v_lshl_add_u32 v17, v2, 7, v18
    s_branch JOIN_B
PATH_B1:
    s_nop 7
    buffer_load_dwordx4 v[96:99], v3, s[32:35], s101 offen offset:0 sc1
    buffer_load_dwordx4 v[100:103], v3, s[32:35], s101 offen offset:1024 sc1
    buffer_load_dwordx4 v[104:107], v3, s[32:35], s101 offen offset:2048 sc1
    buffer_load_dwordx4 v[108:111], v3, s[32:35], s101 offen offset:3072 sc1
    v_lshlrev_b32 v5, 3, v0
    s_mov_b32 m0, s37
    s_nop 0
    buffer_load_dwordx4 v8, s[44:47], s41 offen offset:0 lds
    buffer_load_dwordx4 v9, s[44:47], s41 offen offset:1024 lds
    buffer_load_dwordx4 v10, s[44:47], s41 offen offset:2048 lds
    buffer_load_dwordx4 v11, s[44:47], s41 offen offset:3072 lds
    v_mov_b32 v64, 0
    v_mov_b32 v65, 0
    v_mov_b32 v66, 0
    v_mov_b32 v67, 0
    s_mov_b32 exec_hi, 0
    ds_write_b128 v27, v[64:67] offset:4096
    s_mov_b64 exec, -1
    v_min_u32 v4, 13, v0
    v_lshlrev_b32 v4, 9, v4
    s_add_u32 s57, s6, 262144
    s_add_u32 s58, s6, 524288
    s_add_u32 s17, s6, 1310720
    s_add_u32 s20, s6, 1572864
    s_waitcnt vmcnt(4)
    s_add_u32 s61, s100, 2048
    buffer_load_dwordx2 v[40:41], v5, s[32:35], s61 offen sc1
    s_add_u32 s61, s100, 4096
    buffer_load_dwordx2 v[42:43], v5, s[32:35], s61 offen sc1
    s_add_u32 s61, s100, 10240
    buffer_load_dwordx2 v[44:45], v5, s[32:35], s61 offen sc1
    s_add_u32 s61, s100, 12288
    buffer_load_dwordx2 v[46:47], v5, s[32:35], s61 offen sc1
    v_max3_u32 v29, v96, v100, v104
    v_max_u32 v29, v29, v108
    v_cmp_eq_u32 vcc, -1, v29
    s_cbranch_vccnz RTU_9
BKU_10:
    ds_write_b128 v27, v[108:111] offset:3072
    ds_write_b128 v27, v[104:107] offset:2048
    ds_write_b128 v27, v[100:103] offset:1024
    ds_write_b128 v27, v[96:99] offset:0
    ds_read_b128 v[64:67], v15 offset:2560
    ds_read_b128 v[68:71], v15 offset:2624
    ds_read_b128 v[72:75], v15 offset:2688
    ds_read_b128 v[76:79], v15 offset:2752
    ds_read_b128 v[80:83], v15 offset:2816
    ds_read_b128 v[84:87], v15 offset:2880
    ds_read_b128 v[88:91], v15 offset:2944
    ds_read_b128 v[92:95], v15 offset:3008
    s_waitcnt lgkmcnt(7)
    v_mfma_f32_16x16x32_bf16 v[52:55], v[128:131], v[64:67], 0
    v_mfma_f32_16x16x32_bf16 v[52:55], v[20:23], v[64:67], v[52:55]
    s_waitcnt lgkmcnt(6)
    ds_read_b128 v[64:67], v15 offset:3072
    v_mfma_f32_16x16x32_bf16 v[52:55], v[132:135], v[68:71], v[52:55]
    s_waitcnt lgkmcnt(6)
    ds_read_b128 v[68:71], v15 offset:3136
    s_add_u32 m0, s37, 4096
    s_nop 0
    buffer_load_dwordx4 v12, s[44:47], s41 offen offset:0 lds
    v_mfma_f32_16x16x32_bf16 v[52:55], v[136:139], v[72:75], v[52:55]
    s_waitcnt lgkmcnt(6)
    ds_read_b128 v[72:75], v15 offset:3200
    v_mfma_f32_16x16x32_bf16 v[52:55], v[140:143], v[76:79], v[52:55]
    s_waitcnt lgkmcnt(6)
    ds_read_b128 v[76:79], v15 offset:3264
    v_mfma_f32_16x16x32_bf16 v[52:55], v[144:147], v[80:83], v[52:55]
    s_waitcnt lgkmcnt(6)
    ds_read_b128 v[80:83], v15 offset:3328
    v_mfma_f32_16x16x32_bf16 v[52:55], v[148:151], v[84:87], v[52:55]
    s_waitcnt lgkmcnt(6)
    ds_read_b128 v[84:87], v15 offset:3392
    buffer_load_dwordx4 v13, s[44:47], s41 offen offset:1024 lds
    v_mfma_f32_16x16x32_bf16 v[52:55], v[152:155], v[88:91], v[52:55]
    s_waitcnt lgkmcnt(6)
    ds_read_b128 v[88:91], v15 offset:3456
    v_mfma_f32_16x16x32_bf16 v[52:55], v[156:159], v[92:95], v[52:55]
    s_waitcnt lgkmcnt(6)
    ds_read_b128 v[92:95], v15 offset:3520
    v_mfma_f32_16x16x32_bf16 v[52:55], v[160:163], v[64:67], v[52:55]
    v_mfma_f32_16x16x32_bf16 v[48:51], v[128:131], v[64:67], 0
    s_nop 0
    buffer_load_dwordx4 v14, s[44:47], s41 offen offset:2048 lds
    v_mfma_f32_16x16x32_bf16 v[48:51], v[20:23], v[64:67], v[48:51]
    s_waitcnt lgkmcnt(6)
    ds_read_b128 v[64:67], v15 offset:3584
    v_mfma_f32_16x16x32_bf16 v[52:55], v[164:167], v[68:71], v[52:55]
    v_mfma_f32_16x16x32_bf16 v[48:51], v[132:135], v[68:71], v[48:51]
    s_waitcnt lgkmcnt(6)
    ds_read_b128 v[68:71], v15 offset:3648
    v_mfma_f32_16x16x32_bf16 v[52:55], v[168:171], v[72:75], v[52:55]
    s_mov_b32 m0, s38
    s_nop 0
    buffer_load_dwordx4 v8, s[44:47], s42 offen offset:0 lds
    v_mfma_f32_16x16x32_bf16 v[48:51], v[136:139], v[72:75], v[48:51]
    s_waitcnt lgkmcnt(6)
    ds_read_b128 v[72:75], v15 offset:3712
    v_mfma_f32_16x16x32_bf16 v[52:55], v[172:175], v[76:79], v[52:55]
    s_waitcnt vmcnt(4)
    v_mfma_f32_16x16x32_bf16 v[48:51], v[140:143], v[76:79], v[48:51]
    s_waitcnt lgkmcnt(6)
    ds_read_b128 v[76:79], v15 offset:3776
    v_max3_u32 v29, v40, v42, v44
    v_mfma_f32_16x16x32_bf16 v[52:55], v[176:179], v[80:83], v[52:55]
    v_max_u32 v29, v29, v46
    buffer_load_dwordx4 v9, s[44:47], s42 offen offset:1024 lds
    v_mfma_f32_16x16x32_bf16 v[48:51], v[144:147], v[80:83], v[48:51]
    s_waitcnt lgkmcnt(6)
    ds_read_b128 v[80:83], v15 offset:3840
    v_cmp_eq_u32 vcc, -1, v29
    v_mfma_f32_16x16x32_bf16 v[52:55], v[180:183], v[84:87], v[52:55]
    s_cbranch_vccnz RTS_11
BKS_12:
    v_mfma_f32_16x16x32_bf16 v[48:51], v[148:151], v[84:87], v[48:51]
    s_waitcnt lgkmcnt(6)
    ds_read_b128 v[84:87], v15 offset:3904
    s_add_u32 s60, s5, 4096
    buffer_load_dwordx2 v[32:33], v3, s[32:35], s60 offen sc1
    v_mfma_f32_16x16x32_bf16 v[52:55], v[184:187], v[88:91], v[52:55]
    s_add_u32 s60, s5, 8192
    buffer_load_dwordx2 v[34:35], v3, s[32:35], s60 offen sc1
    buffer_load_dwordx4 v10, s[44:47], s42 offen offset:2048 lds
    v_mfma_f32_16x16x32_bf16 v[48:51], v[152:155], v[88:91], v[48:51]
    s_waitcnt lgkmcnt(6)
    ds_read_b128 v[88:91], v15 offset:3968
    s_add_u32 s60, s5, 20480
    buffer_load_dwordx2 v[36:37], v3, s[32:35], s60 offen sc1
    v_mfma_f32_16x16x32_bf16 v[52:55], v[188:191], v[92:95], v[52:55]
    s_add_u32 s60, s5, 24576
    buffer_load_dwordx2 v[38:39], v3, s[32:35], s60 offen sc1
    v_mfma_f32_16x16x32_bf16 v[48:51], v[156:159], v[92:95], v[48:51]
    s_waitcnt lgkmcnt(6)
    ds_read_b128 v[92:95], v15 offset:4032
    v_mfma_f32_16x16x32_bf16 v[52:55], v[192:195], v[64:67], v[52:55]
    s_nop 0
    buffer_load_dwordx4 v11, s[44:47], s42 offen offset:3072 lds
    v_mfma_f32_16x16x32_bf16 v[48:51], v[160:163], v[64:67], v[48:51]
    s_waitcnt lgkmcnt(6)
    ds_read_b128 v[64:67], v15 offset:512
    v_mfma_f32_16x16x32_bf16 v[52:55], v[196:199], v[68:71], v[52:55]
    v_mfma_f32_16x16x32_bf16 v[48:51], v[164:167], v[68:71], v[48:51]
    s_waitcnt lgkmcnt(6)
    ds_read_b128 v[68:71], v15 offset:576
    v_mfma_f32_16x16x32_bf16 v[52:55], v[200:203], v[72:75], v[52:55]
    s_add_u32 m0, s38, 4096
    s_nop 0
    buffer_load_dwordx4 v12, s[44:47], s42 offen offset:0 lds
    v_mfma_f32_16x16x32_bf16 v[48:51], v[168:171], v[72:75], v[48:51]
    s_waitcnt lgkmcnt(6)
    ds_read_b128 v[72:75], v15 offset:640
    v_mfma_f32_16x16x32_bf16 v[52:55], v[204:207], v[76:79], v[52:55]
    v_mfma_f32_16x16x32_bf16 v[48:51], v[172:175], v[76:79], v[48:51]
    s_waitcnt lgkmcnt(6)
    ds_read_b128 v[76:79], v15 offset:704
    v_mfma_f32_16x16x32_bf16 v[52:55], v[208:211], v[80:83], v[52:55]
    s_nop 0
    buffer_load_dwordx4 v13, s[44:47], s42 offen offset:1024 lds
    v_mfma_f32_16x16x32_bf16 v[48:51], v[176:179], v[80:83], v[48:51]
    s_waitcnt lgkmcnt(6)
    ds_read_b128 v[80:83], v15 offset:768
    v_mfma_f32_16x16x32_bf16 v[52:55], v[212:215], v[84:87], v[52:55]
    v_mfma_f32_16x16x32_bf16 v[48:51], v[180:183], v[84:87], v[48:51]
    s_waitcnt lgkmcnt(6)
    ds_read_b128 v[84:87], v15 offset:832
    v_mfma_f32_16x16x32_bf16 v[52:55], v[216:219], v[88:91], v[52:55]
    s_nop 0
    buffer_load_dwordx4 v14, s[44:47], s42 offen offset:2048 lds
    v_mfma_f32_16x16x32_bf16 v[48:51], v[184:187], v[88:91], v[48:51]
    s_waitcnt lgkmcnt(6)
    ds_read_b128 v[88:91], v15 offset:896
    v_mfma_f32_16x16x32_bf16 v[52:55], v[220:223], v[92:95], v[52:55]
    s_nop 0
    buffer_load_dwordx2 v[126:127], v4, s[32:35], s15 offen sc1
    v_mfma_f32_16x16x32_bf16 v[48:51], v[188:191], v[92:95], v[48:51]
    s_waitcnt lgkmcnt(6)
    ds_read_b128 v[92:95], v15 offset:960
    v_mfma_f32_16x16x32_bf16 v[60:63], v[128:131], v[64:67], 0
    s_mov_b32 m0, s39
    s_nop 0
    buffer_load_dwordx4 v8, s[44:47], s43 offen offset:0 lds
    v_mfma_f32_16x16x32_bf16 v[60:63], v[20:23], v[64:67], v[60:63]
    s_waitcnt lgkmcnt(6)
    ds_read_b128 v[64:67], v15 offset:1024
    v_mfma_f32_16x16x32_bf16 v[60:63], v[132:135], v[68:71], v[60:63]
    s_waitcnt lgkmcnt(6)
    ds_read_b128 v[68:71], v15 offset:1088
    ds_write_b128 v24, v[48:51] offset:4608
    v_mfma_f32_16x16x32_bf16 v[60:63], v[136:139], v[72:75], v[60:63]
    s_waitcnt lgkmcnt(7)
    ds_read_b128 v[72:75], v15 offset:1152
    ds_write_b128 v24, v[52:55] offset:5888
    v_mfma_f32_16x16x32_bf16 v[60:63], v[140:143], v[76:79], v[60:63]
    s_waitcnt lgkmcnt(8)
    ds_read_b128 v[76:79], v15 offset:1216
    buffer_load_dwordx4 v9, s[44:47], s43 offen offset:1024 lds
    s_waitcnt vmcnt(10)
    v_lshlrev_b32 v96, 16, v32
    v_mfma_f32_16x16x32_bf16 v[60:63], v[144:147], v[80:83], v[60:63]
    s_waitcnt lgkmcnt(8)
    ds_read_b128 v[80:83], v15 offset:1280
    v_and_b32 v97, s65, v32
    v_lshlrev_b32 v98, 16, v33
    v_mfma_f32_16x16x32_bf16 v[60:63], v[148:151], v[84:87], v[60:63]
    s_waitcnt lgkmcnt(8)
    ds_read_b128 v[84:87], v15 offset:1344
    v_and_b32 v99, s65, v33
    v_fma_f32 v104, v96, v40, v41
    v_mfma_f32_16x16x32_bf16 v[60:63], v[152:155], v[88:91], v[60:63]
    s_waitcnt lgkmcnt(8)
    ds_read_b128 v[88:91], v15 offset:1408
    v_fma_f32 v105, v97, v40, v41
    v_fma_f32 v106, v98, v40, v41
    v_mfma_f32_16x16x32_bf16 v[60:63], v[156:159], v[92:95], v[60:63]
    s_waitcnt lgkmcnt(8)
    ds_read_b128 v[92:95], v15 offset:1472
    buffer_load_dwordx4 v10, s[44:47], s43 offen offset:2048 lds
    v_fma_f32 v107, v99, v40, v41
    v_lshlrev_b32 v100, 16, v34
    v_mfma_f32_16x16x32_bf16 v[60:63], v[160:163], v[64:67], v[60:63]
    v_and_b32 v101, s65, v34
    v_lshlrev_b32 v102, 16, v35
    v_mfma_f32_16x16x32_bf16 v[56:59], v[128:131], v[64:67], 0
    v_and_b32 v103, s65, v35
    v_fma_f32 v108, v100, v42, v43
    v_mfma_f32_16x16x32_bf16 v[56:59], v[20:23], v[64:67], v[56:59]
    s_waitcnt lgkmcnt(8)
    ds_read_b128 v[64:67], v15 offset:1536
    v_fma_f32 v109, v101, v42, v43
    v_fma_f32 v110, v102, v42, v43
    v_mfma_f32_16x16x32_bf16 v[60:63], v[164:167], v[68:71], v[60:63]
    s_nop 0
    buffer_load_dwordx4 v11, s[44:47], s43 offen offset:3072 lds
    v_fma_f32 v111, v103, v42, v43
    v_mfma_f32_16x16x32_bf16 v[56:59], v[132:135], v[68:71], v[56:59]
    s_waitcnt lgkmcnt(7)
    ds_read_b128 v[68:71], v15 offset:1600
    v_mfma_f32_16x16x32_bf16 v[60:63], v[168:171], v[72:75], v[60:63]
    s_waitcnt lgkmcnt(7)
    s_barrier
    ds_read2st64_b32 v[112:113], v25 offset0:18 offset1:51
    ds_read2st64_b32 v[114:115], v25 offset0:84 offset1:117
    v_mfma_f32_16x16x32_bf16 v[56:59], v[136:139], v[72:75], v[56:59]
    s_waitcnt lgkmcnt(8)
    ds_read_b128 v[72:75], v15 offset:1664
    ds_read2st64_b32 v[116:117], v25 offset0:23 offset1:56
    ds_read2st64_b32 v[118:119], v25 offset0:89 offset1:122
    v_mfma_f32_16x16x32_bf16 v[60:63], v[172:175], v[76:79], v[60:63]
    s_add_u32 m0, s39, 4096
    s_nop 0
    buffer_load_dwordx4 v12, s[44:47], s43 offen offset:0 lds
    v_mfma_f32_16x16x32_bf16 v[56:59], v[140:143], v[76:79], v[56:59]
    s_waitcnt lgkmcnt(10)
    ds_read_b128 v[76:79], v15 offset:1728
    v_mfma_f32_16x16x32_bf16 v[60:63], v[176:179], v[80:83], v[60:63]
    s_waitcnt lgkmcnt(4)
    v_fma_f32 v112, v104, v112, v96
    v_mfma_f32_16x16x32_bf16 v[56:59], v[144:147], v[80:83], v[56:59]
    s_nop 0
    ds_read_b128 v[80:83], v15 offset:1792
    v_fma_f32 v113, v105, v113, v97
    v_fma_f32 v114, v106, v114, v98
    v_mfma_f32_16x16x32_bf16 v[60:63], v[180:183], v[84:87], v[60:63]
    s_nop 0
    buffer_load_dwordx4 v13, s[44:47], s43 offen offset:1024 lds
    v_fma_f32 v115, v107, v115, v99
    v_cvt_pk_bf16_f32 v120, v112, v113
    v_mfma_f32_16x16x32_bf16 v[56:59], v[148:151], v[84:87], v[56:59]
    s_nop 0
    ds_read_b128 v[84:87], v15 offset:1856
    v_cvt_pk_bf16_f32 v121, v114, v115
    buffer_store_dwordx2 v[120:121], v26, s[32:35], s57 offen sc1
    v_mfma_f32_16x16x32_bf16 v[60:63], v[184:187], v[88:91], v[60:63]
    s_waitcnt lgkmcnt(3)
    v_fma_f32 v116, v108, v116, v100
    v_mfma_f32_16x16x32_bf16 v[56:59], v[152:155], v[88:91], v[56:59]
    s_nop 0
    ds_read_b128 v[88:91], v15 offset:1920
    v_fma_f32 v117, v109, v117, v101
    v_fma_f32 v118, v110, v118, v102
    v_mfma_f32_16x16x32_bf16 v[60:63], v[188:191], v[92:95], v[60:63]
    s_nop 0
    buffer_load_dwordx4 v14, s[44:47], s43 offen offset:2048 lds
    v_fma_f32 v119, v111, v119, v103
    v_cvt_pk_bf16_f32 v122, v116, v117
    v_mfma_f32_16x16x32_bf16 v[56:59], v[156:159], v[92:95], v[56:59]
    s_nop 0
    ds_read_b128 v[92:95], v15 offset:1984
    v_cvt_pk_bf16_f32 v123, v118, v119
    buffer_store_dwordx2 v[122:123], v26, s[32:35], s58 offen sc1
    v_mfma_f32_16x16x32_bf16 v[60:63], v[192:195], v[64:67], v[60:63]
    v_mfma_f32_16x16x32_bf16 v[56:59], v[160:163], v[64:67], v[56:59]
    s_nop 0
    ds_read_b128 v[64:67], v15 offset:2048
    v_mfma_f32_16x16x32_bf16 v[60:63], v[196:199], v[68:71], v[60:63]
    v_mfma_f32_16x16x32_bf16 v[56:59], v[164:167], v[68:71], v[56:59]
    s_nop 0
    ds_read_b128 v[68:71], v15 offset:2112
    v_mfma_f32_16x16x32_bf16 v[60:63], v[200:203], v[72:75], v[60:63]
    v_mfma_f32_16x16x32_bf16 v[56:59], v[168:171], v[72:75], v[56:59]
    s_waitcnt lgkmcnt(6)
    ds_read_b128 v[72:75], v15 offset:2176
    v_mfma_f32_16x16x32_bf16 v[60:63], v[204:207], v[76:79], v[60:63]
    v_mfma_f32_16x16x32_bf16 v[56:59], v[172:175], v[76:79], v[56:59]
    s_waitcnt lgkmcnt(6)
    ds_read_b128 v[76:79], v15 offset:2240
    v_mfma_f32_16x16x32_bf16 v[60:63], v[208:211], v[80:83], v[60:63]
    v_mfma_f32_16x16x32_bf16 v[56:59], v[176:179], v[80:83], v[56:59]
    s_waitcnt lgkmcnt(6)
    ds_read_b128 v[80:83], v15 offset:2304
    v_mfma_f32_16x16x32_bf16 v[60:63], v[212:215], v[84:87], v[60:63]
    v_mfma_f32_16x16x32_bf16 v[56:59], v[180:183], v[84:87], v[56:59]
    s_waitcnt lgkmcnt(6)
    ds_read_b128 v[84:87], v15 offset:2368
    v_mfma_f32_16x16x32_bf16 v[60:63], v[216:219], v[88:91], v[60:63]
    s_waitcnt vmcnt(9)
    v_and_b32 v126, v126, v127
    v_cmp_ne_u32 vcc, 1, v126
    s_cbranch_vccnz FP_13
FD_14:
    v_mfma_f32_16x16x32_bf16 v[56:59], v[184:187], v[88:91], v[56:59]
    s_waitcnt lgkmcnt(6)
    ds_read_b128 v[88:91], v15 offset:2432
    s_add_u32 s63, s8, 0
    buffer_load_dwordx4 a[128:131], v3, s[32:35], s63 offen offset:0 sc1
    v_mfma_f32_16x16x32_bf16 v[60:63], v[220:223], v[92:95], v[60:63]
    v_mfma_f32_16x16x32_bf16 v[56:59], v[188:191], v[92:95], v[56:59]
    s_waitcnt lgkmcnt(6)
    ds_read_b128 v[92:95], v15 offset:2496
    v_mfma_f32_16x16x32_bf16 v[60:63], v[224:227], v[64:67], v[60:63]
    s_add_u32 s59, s3, 0
    v_mfma_f32_16x16x32_bf16 v[56:59], v[192:195], v[64:67], v[56:59]
    s_waitcnt lgkmcnt(6)
    ds_read_b128 v[64:67], v15 offset:2560
    s_and_b32 s59, s59, 3
    v_mfma_f32_16x16x32_bf16 v[60:63], v[228:231], v[68:71], v[60:63]
    s_mul_i32 s36, s59, 7168
    v_mfma_f32_16x16x32_bf16 v[56:59], v[196:199], v[68:71], v[56:59]
    s_waitcnt lgkmcnt(6)
    ds_read_b128 v[68:71], v15 offset:2624
    buffer_load_dwordx4 a[132:135], v3, s[32:35], s63 offen offset:1024 sc1
    s_lshl_b32 s59, s59, 12
    v_mfma_f32_16x16x32_bf16 v[60:63], v[232:235], v[72:75], v[60:63]
    s_add_u32 s40, s59, s13
    v_mfma_f32_16x16x32_bf16 v[56:59], v[200:203], v[72:75], v[56:59]
    s_waitcnt lgkmcnt(6)
    ds_read_b128 v[72:75], v15 offset:2688
    s_add_u32 s59, s3, 1
    v_mfma_f32_16x16x32_bf16 v[60:63], v[236:239], v[76:79], v[60:63]
    s_and_b32 s59, s59, 3
    v_mfma_f32_16x16x32_bf16 v[56:59], v[204:207], v[76:79], v[56:59]
    s_waitcnt lgkmcnt(6)
    ds_read_b128 v[76:79], v15 offset:2752
    s_mul_i32 s37, s59, 7168
    v_mfma_f32_16x16x32_bf16 v[60:63], v[240:243], v[80:83], v[60:63]
    s_lshl_b32 s59, s59, 12
    v_mfma_f32_16x16x32_bf16 v[56:59], v[208:211], v[80:83], v[56:59]
    s_waitcnt lgkmcnt(6)
    ds_read_b128 v[80:83], v15 offset:2816
    buffer_load_dwordx4 a[136:139], v3, s[32:35], s63 offen offset:2048 sc1
    s_add_u32 s41, s59, s13
    v_mfma_f32_16x16x32_bf16 v[60:63], v[244:247], v[84:87], v[60:63]
    s_add_u32 s59, s3, 2
    v_mfma_f32_16x16x32_bf16 v[56:59], v[212:215], v[84:87], v[56:59]
    s_waitcnt lgkmcnt(6)
    ds_read_b128 v[84:87], v15 offset:2880
    s_and_b32 s59, s59, 3
    v_mfma_f32_16x16x32_bf16 v[60:63], v[248:251], v[88:91], v[60:63]
    s_mul_i32 s38, s59, 7168
    v_mfma_f32_16x16x32_bf16 v[56:59], v[216:219], v[88:91], v[56:59]
    s_waitcnt lgkmcnt(6)
    ds_read_b128 v[88:91], v15 offset:2944
    s_lshl_b32 s59, s59, 12
    v_mfma_f32_16x16x32_bf16 v[60:63], v[252:255], v[92:95], v[60:63]
    s_add_u32 s42, s59, s13
    v_mfma_f32_16x16x32_bf16 v[56:59], v[220:223], v[92:95], v[56:59]
    s_waitcnt lgkmcnt(6)
    ds_read_b128 v[92:95], v15 offset:3008
    buffer_load_dwordx4 a[140:143], v3, s[32:35], s63 offen offset:3072 sc1
    s_add_u32 s59, s3, 3
    v_mfma_f32_16x16x32_bf16 v[60:63], a[0:3], v[64:67], v[60:63]
    s_and_b32 s59, s59, 3
    v_mfma_f32_16x16x32_bf16 v[56:59], v[224:227], v[64:67], v[56:59]
    s_waitcnt lgkmcnt(6)
    ds_read_b128 v[64:67], v15 offset:3072
    s_mul_i32 s39, s59, 7168
    v_mfma_f32_16x16x32_bf16 v[60:63], a[4:7], v[68:71], v[60:63]
    s_lshl_b32 s59, s59, 12
    v_mfma_f32_16x16x32_bf16 v[56:59], v[228:231], v[68:71], v[56:59]
    s_waitcnt lgkmcnt(6)
    ds_read_b128 v[68:71], v15 offset:3136
    s_add_u32 s43, s59, s13
    v_mfma_f32_16x16x32_bf16 v[60:63], a[8:11], v[72:75], v[60:63]
    v_lshrrev_b32 v11, 2, v1
    v_mfma_f32_16x16x32_bf16 v[56:59], v[232:235], v[72:75], v[56:59]
    s_waitcnt lgkmcnt(6)
    ds_read_b128 v[72:75], v15 offset:3200
    s_add_u32 s63, s8, 12288
    buffer_load_dwordx4 a[144:147], v3, s[32:35], s63 offen offset:0 sc1
    v_lshl_add_u32 v11, v2, 2, v11
    v_mfma_f32_16x16x32_bf16 v[60:63], a[12:15], v[76:79], v[60:63]
    v_mul_u32_u24 v8, 224, v11
    v_mfma_f32_16x16x32_bf16 v[56:59], v[236:239], v[76:79], v[56:59]
    s_waitcnt lgkmcnt(6)
    ds_read_b128 v[76:79], v15 offset:3264
    v_and_b32 v11, 3, v0
    v_mfma_f32_16x16x32_bf16 v[60:63], a[16:19], v[80:83], v[60:63]
    v_lshl_add_u32 v8, v11, 3, v8
    v_mfma_f32_16x16x32_bf16 v[56:59], v[240:243], v[80:83], v[56:59]
    s_waitcnt lgkmcnt(6)
    ds_read_b128 v[80:83], v15 offset:3328
    v_add_u32 v9, 57344, v8
    v_mfma_f32_16x16x32_bf16 v[60:63], a[20:23], v[84:87], v[60:63]
    v_add_u32 v10, s36, v8
    v_mfma_f32_16x16x32_bf16 v[56:59], v[244:247], v[84:87], v[56:59]
    s_waitcnt lgkmcnt(6)
    ds_read_b128 v[84:87], v15 offset:3392
    buffer_load_dwordx4 a[148:151], v3, s[32:35], s63 offen offset:1024 sc1
    v_mfma_f32_16x16x32_bf16 v[60:63], a[24:27], v[88:91], v[60:63]
    v_mfma_f32_16x16x32_bf16 v[56:59], v[248:251], v[88:91], v[56:59]
    s_waitcnt lgkmcnt(6)
    ds_read_b128 v[88:91], v15 offset:3456
    v_mfma_f32_16x16x32_bf16 v[60:63], a[28:31], v[92:95], v[60:63]
    v_mfma_f32_16x16x32_bf16 v[56:59], v[252:255], v[92:95], v[56:59]
    s_waitcnt lgkmcnt(6)
    ds_read_b128 v[92:95], v15 offset:3520
    v_mfma_f32_16x16x32_bf16 v[60:63], a[32:35], v[64:67], v[60:63]
    v_mfma_f32_16x16x32_bf16 v[56:59], a[0:3], v[64:67], v[56:59]
    s_waitcnt lgkmcnt(6)
    ds_read_b128 v[64:67], v15 offset:3584
    buffer_load_dwordx4 a[152:155], v3, s[32:35], s63 offen offset:2048 sc1
    v_mfma_f32_16x16x32_bf16 v[60:63], a[36:39], v[68:71], v[60:63]
    v_mfma_f32_16x16x32_bf16 v[56:59], a[4:7], v[68:71], v[56:59]
    s_waitcnt lgkmcnt(6)
    ds_read_b128 v[68:71], v15 offset:3648
    v_mfma_f32_16x16x32_bf16 v[60:63], a[40:43], v[72:75], v[60:63]
    v_mfma_f32_16x16x32_bf16 v[56:59], a[8:11], v[72:75], v[56:59]
    s_waitcnt lgkmcnt(6)
    ds_read_b128 v[72:75], v15 offset:3712
    v_lshlrev_b32 v96, 16, v36
    v_mfma_f32_16x16x32_bf16 v[60:63], a[44:47], v[76:79], v[60:63]
    v_and_b32 v97, s65, v36
    v_mfma_f32_16x16x32_bf16 v[56:59], a[12:15], v[76:79], v[56:59]
    s_waitcnt lgkmcnt(6)
    ds_read_b128 v[76:79], v15 offset:3776
    buffer_load_dwordx4 a[156:159], v3, s[32:35], s63 offen offset:3072 sc1
    v_lshlrev_b32 v98, 16, v37
    v_mfma_f32_16x16x32_bf16 v[60:63], a[48:51], v[80:83], v[60:63]
    v_and_b32 v99, s65, v37
    v_mfma_f32_16x16x32_bf16 v[56:59], a[16:19], v[80:83], v[56:59]
    s_waitcnt lgkmcnt(6)
    ds_read_b128 v[80:83], v15 offset:3840
    s_add_u32 s62, s11, 3670016
    buffer_store_dwordx4 v[16:19], v3, s[32:35], s62 offen offset:0 sc1
    v_fma_f32 v104, v96, v44, v45
    v_mfma_f32_16x16x32_bf16 v[60:63], a[52:55], v[84:87], v[60:63]
    v_fma_f32 v105, v97, v44, v45
    v_mfma_f32_16x16x32_bf16 v[56:59], a[20:23], v[84:87], v[56:59]
    s_waitcnt lgkmcnt(6)
    ds_read_b128 v[84:87], v15 offset:3904
    v_fma_f32 v106, v98, v44, v45
    v_mfma_f32_16x16x32_bf16 v[60:63], a[56:59], v[88:91], v[60:63]
    s_nop 0
    buffer_store_dwordx4 v[16:19], v3, s[32:35], s62 offen offset:1024 sc1
    v_fma_f32 v107, v99, v44, v45
    v_mfma_f32_16x16x32_bf16 v[56:59], a[24:27], v[88:91], v[56:59]
    s_waitcnt lgkmcnt(6)
    ds_read_b128 v[88:91], v15 offset:3968
    v_lshlrev_b32 v100, 16, v38
    v_mfma_f32_16x16x32_bf16 v[60:63], a[60:63], v[92:95], v[60:63]
    v_and_b32 v101, s65, v38
    v_mfma_f32_16x16x32_bf16 v[56:59], a[28:31], v[92:95], v[56:59]
    s_waitcnt lgkmcnt(6)
    ds_read_b128 v[92:95], v15 offset:4032
    buffer_store_dwordx4 v[16:19], v3, s[32:35], s62 offen offset:2048 sc1
    v_lshlrev_b32 v102, 16, v39
    v_mfma_f32_16x16x32_bf16 v[60:63], a[64:67], v[64:67], v[60:63]
    v_and_b32 v103, s65, v39
    v_mfma_f32_16x16x32_bf16 v[56:59], a[32:35], v[64:67], v[56:59]
    s_waitcnt lgkmcnt(6)
    v_fma_f32 v108, v100, v46, v47
    v_mfma_f32_16x16x32_bf16 v[60:63], a[68:71], v[68:71], v[60:63]
    s_add_u32 s62, s12, 3670016
    buffer_store_dwordx2 v[16:17], v5, s[32:35], s62 offen sc1
    v_fma_f32 v109, v101, v46, v47
    v_mfma_f32_16x16x32_bf16 v[56:59], a[36:39], v[68:71], v[56:59]
    s_waitcnt lgkmcnt(5)
    v_fma_f32 v110, v102, v46, v47
    v_mfma_f32_16x16x32_bf16 v[60:63], a[72:75], v[72:75], v[60:63]
    v_fma_f32 v111, v103, v46, v47
    v_mfma_f32_16x16x32_bf16 v[56:59], a[40:43], v[72:75], v[56:59]
    s_waitcnt lgkmcnt(4)
    v_mfma_f32_16x16x32_bf16 v[60:63], a[76:79], v[76:79], v[60:63]
    v_mfma_f32_16x16x32_bf16 v[56:59], a[44:47], v[76:79], v[56:59]
    s_waitcnt lgkmcnt(3)
    v_mfma_f32_16x16x32_bf16 v[60:63], a[80:83], v[80:83], v[60:63]
    v_mfma_f32_16x16x32_bf16 v[56:59], a[48:51], v[80:83], v[56:59]
    s_waitcnt lgkmcnt(2)
    v_mfma_f32_16x16x32_bf16 v[60:63], a[84:87], v[84:87], v[60:63]
    v_mfma_f32_16x16x32_bf16 v[56:59], a[52:55], v[84:87], v[56:59]
    s_waitcnt lgkmcnt(1)
    v_mfma_f32_16x16x32_bf16 v[60:63], a[88:91], v[88:91], v[60:63]
    v_mfma_f32_16x16x32_bf16 v[56:59], a[56:59], v[88:91], v[56:59]
    s_waitcnt lgkmcnt(0)
    v_mov_b32 v16, v5
    v_and_b32 v18, 8, v1
    v_and_b32 v19, 7, v1
    v_mfma_f32_16x16x32_bf16 v[60:63], a[92:95], v[92:95], v[60:63]
    v_lshlrev_b32 v18, 6, v18
    v_lshl_add_u32 v18, v19, 4, v18
    v_mfma_f32_16x16x32_bf16 v[56:59], a[60:63], v[92:95], v[56:59]
    v_lshl_add_u32 v17, v2, 7, v18
JOIN_B:
    buffer_load_dwordx4 v[128:131], v17, s[32:35], s40 offen offset:0 sc1
    buffer_load_dwordx4 v[132:135], v17, s[32:35], s40 offen offset:1024 sc1
    s_nop 3
    s_nop 0
    ds_write_b128 v24, v[56:59] offset:0
    ds_write_b128 v24, v[60:63] offset:1280
    buffer_load_dwordx4 v[136:139], v17, s[32:35], s40 offen offset:2048 sc1
    buffer_load_dwordx4 v[140:143], v17, s[32:35], s40 offen offset:3072 sc1
    s_waitcnt vmcnt(17)
    s_waitcnt lgkmcnt(0)
    s_barrier
    ds_read2st64_b32 v[112:113], v25 offset0:0 offset1:33
    ds_read2st64_b32 v[114:115], v25 offset0:66 offset1:99
    ds_read2st64_b32 v[116:117], v25 offset0:5 offset1:38
    ds_read2st64_b32 v[118:119], v25 offset0:71 offset1:104
    ds_read_b64_tr_b16 v[32:33], v10 offset:0
    ds_read_b64_tr_b16 v[34:35], v10 offset:3584
    ds_read_b64_tr_b16 v[36:37], v10 offset:32
    ds_read_b64_tr_b16 v[38:39], v10 offset:3616
    ds_read_b64_tr_b16 v[40:41], v10 offset:64
    ds_read_b64_tr_b16 v[42:43], v10 offset:3648
    ds_read_b64_tr_b16 v[44:45], v10 offset:96
    ds_read_b64_tr_b16 v[46:47], v10 offset:3680
    s_waitcnt lgkmcnt(10)
    v_fma_f32 v112, v104, v112, v96
    v_fma_f32 v113, v105, v113, v97
    v_fma_f32 v114, v106, v114, v98
    v_fma_f32 v115, v107, v115, v99
    v_cvt_pk_bf16_f32 v120, v112, v113
    v_cvt_pk_bf16_f32 v121, v114, v115
    buffer_store_dwordx2 v[120:121], v26, s[32:35], s17 offen sc1
    s_waitcnt lgkmcnt(8)
    v_fma_f32 v116, v108, v116, v100
    v_fma_f32 v117, v109, v117, v101
    v_fma_f32 v118, v110, v118, v102
    v_fma_f32 v119, v111, v119, v103
    v_cvt_pk_bf16_f32 v122, v116, v117
    v_cvt_pk_bf16_f32 v123, v118, v119
    buffer_store_dwordx2 v[122:123], v26, s[32:35], s20 offen sc1
    ds_read_b64_tr_b16 v[48:49], v10 offset:128
    ds_read_b64_tr_b16 v[50:51], v10 offset:3712
    ds_read_b64_tr_b16 v[52:53], v10 offset:160
    ds_read_b64_tr_b16 v[54:55], v10 offset:3744
    ds_read_b64_tr_b16 v[56:57], v10 offset:192
    ds_read_b64_tr_b16 v[58:59], v10 offset:3776
    buffer_load_dwordx4 v[144:147], v17, s[32:35], s41 offen offset:0 sc1
    buffer_load_dwordx4 v[148:151], v17, s[32:35], s41 offen offset:1024 sc1
    buffer_load_dwordx4 v[152:155], v17, s[32:35], s41 offen offset:2048 sc1
    buffer_load_dwordx4 v[156:159], v17, s[32:35], s41 offen offset:3072 sc1
    buffer_load_dwordx4 v[160:163], v17, s[32:35], s42 offen offset:0 sc1
    buffer_load_dwordx4 v[164:167], v17, s[32:35], s42 offen offset:1024 sc1
    buffer_load_dwordx4 v[168:171], v17, s[32:35], s42 offen offset:2048 sc1
    buffer_load_dwordx4 v[172:175], v17, s[32:35], s42 offen offset:3072 sc1
    buffer_load_dwordx4 v[176:179], v17, s[32:35], s43 offen offset:0 sc1
    buffer_load_dwordx4 v[180:183], v17, s[32:35], s43 offen offset:1024 sc1
    buffer_load_dwordx4 v[184:187], v17, s[32:35], s43 offen offset:2048 sc1
    buffer_load_dwordx4 v[188:191], v17, s[32:35], s43 offen offset:3072 sc1
    v_mov_b32 v96, 0x3f803f80
    v_mov_b32 v97, 0x3f803f80
    v_mov_b32 v98, 0x3f803f80
    v_mov_b32 v99, 0x3f803f80
    s_waitcnt vmcnt(16)
    v_max3_u32 v14, v128, v130, v132
    v_max_u32 v14, v14, v134
    v_cmp_eq_u32 vcc, -1, v14
    s_cbranch_vccnz RTC_23
BKC_24:
    v_mov_b32 v18, v130
    v_mov_b32 v19, v131
    v_mov_b32_dpp v130, v128 row_ror:8 row_mask:0xf bank_mask:0x3
    v_mov_b32_dpp v131, v129 row_ror:8 row_mask:0xf bank_mask:0x3
    v_mov_b32_dpp v128, v18 row_ror:8 row_mask:0xf bank_mask:0xc
    v_mov_b32_dpp v129, v19 row_ror:8 row_mask:0xf bank_mask:0xc
    s_waitcnt lgkmcnt(12)
    s_nop 0
    v_mfma_f32_16x16x32_bf16 v[60:63], v[32:35], v[128:131], 0
    s_add_u32 s63, s8, 28672
    buffer_load_dwordx4 a[160:163], v3, s[32:35], s63 offen offset:0 sc1
    v_mfma_f32_16x16x32_bf16 v[192:195], v[96:99], v[32:35], 0
    s_waitcnt lgkmcnt(10)
    ds_read_b64_tr_b16 v[32:33], v10 offset:28672
    ds_read_b64_tr_b16 v[34:35], v10 offset:32256
    v_mfma_f32_16x16x32_bf16 v[64:67], v[36:39], v[128:131], 0
    v_mov_b32 v18, v134
    v_mov_b32 v19, v135
    v_mfma_f32_16x16x32_bf16 v[196:199], v[96:99], v[36:39], 0
    s_waitcnt lgkmcnt(10)
    ds_read_b64_tr_b16 v[36:37], v10 offset:28704
    ds_read_b64_tr_b16 v[38:39], v10 offset:32288
    v_mfma_f32_16x16x32_bf16 v[68:71], v[40:43], v[128:131], 0
    s_nop 0
    buffer_load_dwordx4 a[164:167], v3, s[32:35], s63 offen offset:1024 sc1
    v_mfma_f32_16x16x32_bf16 v[200:203], v[96:99], v[40:43], 0
    s_waitcnt lgkmcnt(10)
    ds_read_b64_tr_b16 v[40:41], v10 offset:28736
    ds_read_b64_tr_b16 v[42:43], v10 offset:32320
    v_mfma_f32_16x16x32_bf16 v[88:91], v[128:131], v[128:131], 0
    v_mov_b32 v20, 0xc0135761
    v_mov_b32 v21, v20
    v_mfma_f32_16x16x32_bf16 v[72:75], v[44:47], v[128:131], 0
    v_mov_b32_dpp v134, v132 row_ror:8 row_mask:0xf bank_mask:0x3
    v_mov_b32_dpp v135, v133 row_ror:8 row_mask:0xf bank_mask:0x3
    v_mfma_f32_16x16x32_bf16 v[204:207], v[96:99], v[44:47], 0
    s_waitcnt lgkmcnt(10)
    ds_read_b64_tr_b16 v[44:45], v10 offset:28768
    ds_read_b64_tr_b16 v[46:47], v10 offset:32352
    v_mfma_f32_16x16x32_bf16 v[76:79], v[48:51], v[128:131], 0
    s_nop 0
    buffer_load_dwordx4 a[168:171], v3, s[32:35], s63 offen offset:2048 sc1
    v_mov_b32 v22, 0xbdd2d3e8
    v_mfma_f32_16x16x32_bf16 v[208:211], v[96:99], v[48:51], 0
    s_waitcnt lgkmcnt(10)
    ds_read_b64_tr_b16 v[48:49], v10 offset:28800
    ds_read_b64_tr_b16 v[50:51], v10 offset:32384
    v_mfma_f32_16x16x32_bf16 v[80:83], v[52:55], v[128:131], 0
    v_mov_b32_dpp v132, v18 row_ror:8 row_mask:0xf bank_mask:0xc
    v_mov_b32_dpp v133, v19 row_ror:8 row_mask:0xf bank_mask:0xc
    v_mfma_f32_16x16x32_bf16 v[212:215], v[96:99], v[52:55], 0
    s_waitcnt lgkmcnt(10)
    ds_read_b64_tr_b16 v[52:53], v10 offset:28832
    ds_read_b64_tr_b16 v[54:55], v10 offset:32416
    v_mfma_f32_16x16x32_bf16 v[84:87], v[56:59], v[128:131], 0
    s_nop 0
    buffer_load_dwordx4 a[172:175], v3, s[32:35], s63 offen offset:3072 sc1
    v_mov_b32 v23, v22
    v_mfma_f32_16x16x32_bf16 v[216:219], v[96:99], v[56:59], 0
    s_waitcnt lgkmcnt(10)
    ds_read_b64_tr_b16 v[56:57], v10 offset:28864
    ds_read_b64_tr_b16 v[58:59], v10 offset:32448
    v_mfma_f32_16x16x32_bf16 v[92:95], v[96:99], v[128:131], 0
    v_mov_b32 v24, 1.0
    v_add_u32 v10, s36, v9
    v_mfma_f32_16x16x32_bf16 v[60:63], v[32:35], v[132:135], v[60:63]
    s_add_u32 s63, s8, 40960
    buffer_load_dwordx4 a[176:179], v3, s[32:35], s63 offen offset:0 sc1
    s_waitcnt vmcnt(19)
    v_max3_u32 v14, v136, v138, v140
    v_mfma_f32_16x16x32_bf16 v[192:195], v[96:99], v[32:35], v[192:195]
    s_waitcnt lgkmcnt(10)
    ds_read_b64_tr_b16 v[32:33], v10 offset:0
    ds_read_b64_tr_b16 v[34:35], v10 offset:3584
    v_mfma_f32_16x16x32_bf16 v[64:67], v[36:39], v[132:135], v[64:67]
    v_max_u32 v14, v14, v142
    v_mfma_f32_16x16x32_bf16 v[196:199], v[96:99], v[36:39], v[196:199]
    s_waitcnt lgkmcnt(10)
    ds_read_b64_tr_b16 v[36:37], v10 offset:32
    ds_read_b64_tr_b16 v[38:39], v10 offset:3616
    v_mfma_f32_16x16x32_bf16 v[68:71], v[40:43], v[132:135], v[68:71]
    s_nop 0
    buffer_load_dwordx4 a[180:183], v3, s[32:35], s63 offen offset:1024 sc1
    v_cmp_eq_u32 vcc, -1, v14
    s_cbranch_vccnz RTC_15
BKC_16:
    v_mfma_f32_16x16x32_bf16 v[200:203], v[96:99], v[40:43], v[200:203]
    s_waitcnt lgkmcnt(10)
    ds_read_b64_tr_b16 v[40:41], v10 offset:64
    ds_read_b64_tr_b16 v[42:43], v10 offset:3648
    v_mfma_f32_16x16x32_bf16 v[88:91], v[132:135], v[132:135], v[88:91]
    v_mov_b32 v18, v138
    v_mov_b32 v19, v139
    v_mfma_f32_16x16x32_bf16 v[72:75], v[44:47], v[132:135], v[72:75]
    v_mov_b32_dpp v138, v136 row_ror:8 row_mask:0xf bank_mask:0x3
    v_mov_b32_dpp v139, v137 row_ror:8 row_mask:0xf bank_mask:0x3
    v_mfma_f32_16x16x32_bf16 v[204:207], v[96:99], v[44:47], v[204:207]
    s_waitcnt lgkmcnt(10)
    ds_read_b64_tr_b16 v[44:45], v10 offset:96
    ds_read_b64_tr_b16 v[46:47], v10 offset:3680
    v_mfma_f32_16x16x32_bf16 v[76:79], v[48:51], v[132:135], v[76:79]
    s_nop 0
    buffer_load_dwordx4 a[184:187], v3, s[32:35], s63 offen offset:2048 sc1
    v_mov_b32 v25, 1.0
    v_mfma_f32_16x16x32_bf16 v[208:211], v[96:99], v[48:51], v[208:211]
    s_waitcnt lgkmcnt(10)
    ds_read_b64_tr_b16 v[48:49], v10 offset:128
    ds_read_b64_tr_b16 v[50:51], v10 offset:3712
    v_mfma_f32_16x16x32_bf16 v[80:83], v[52:55], v[132:135], v[80:83]
    v_mov_b32_dpp v136, v18 row_ror:8 row_mask:0xf bank_mask:0xc
    v_mov_b32_dpp v137, v19 row_ror:8 row_mask:0xf bank_mask:0xc
    v_mfma_f32_16x16x32_bf16 v[212:215], v[96:99], v[52:55], v[212:215]
    s_waitcnt lgkmcnt(10)
    ds_read_b64_tr_b16 v[52:53], v10 offset:160
    ds_read_b64_tr_b16 v[54:55], v10 offset:3744
    v_mfma_f32_16x16x32_bf16 v[84:87], v[56:59], v[132:135], v[84:87]
    s_nop 0
    buffer_load_dwordx4 a[188:191], v3, s[32:35], s63 offen offset:3072 sc1
    v_lshl_add_u32 v11, v2, 4, s4
    v_mfma_f32_16x16x32_bf16 v[216:219], v[96:99], v[56:59], v[216:219]
    s_waitcnt lgkmcnt(10)
    ds_read_b64_tr_b16 v[56:57], v10 offset:192
    ds_read_b64_tr_b16 v[58:59], v10 offset:3776
    v_mfma_f32_16x16x32_bf16 v[92:95], v[96:99], v[132:135], v[92:95]
    v_lshrrev_b32 v12, 2, v1
    v_lshl_add_u32 v12, v12, 4, v1
    v_mfma_f32_16x16x32_bf16 v[60:63], v[32:35], v[136:139], v[60:63]
    s_add_u32 s63, s8, 4096
    buffer_load_dwordx4 a[192:195], v3, s[32:35], s63 offen offset:0 sc1
    v_lshlrev_b32 v12, 2, v12
    v_mfma_f32_16x16x32_bf16 v[192:195], v[96:99], v[32:35], v[192:195]
    s_waitcnt lgkmcnt(10)
    ds_read_b64_tr_b16 v[32:33], v10 offset:28672
    ds_read_b64_tr_b16 v[34:35], v10 offset:32256
    v_mfma_f32_16x16x32_bf16 v[64:67], v[36:39], v[136:139], v[64:67]
    v_mov_b32 v18, v142
    v_mov_b32 v19, v143
    v_mfma_f32_16x16x32_bf16 v[196:199], v[96:99], v[36:39], v[196:199]
    s_waitcnt lgkmcnt(10)
    ds_read_b64_tr_b16 v[36:37], v10 offset:28704
    ds_read_b64_tr_b16 v[38:39], v10 offset:32288
    v_mfma_f32_16x16x32_bf16 v[68:71], v[40:43], v[136:139], v[68:71]
    s_nop 0
    buffer_load_dwordx4 a[196:199], v3, s[32:35], s63 offen offset:1024 sc1
    v_and_b32 v15, 3, v0
    v_mfma_f32_16x16x32_bf16 v[200:203], v[96:99], v[40:43], v[200:203]
    s_waitcnt lgkmcnt(10)
    ds_read_b64_tr_b16 v[40:41], v10 offset:28736
    ds_read_b64_tr_b16 v[42:43], v10 offset:32320
    v_mfma_f32_16x16x32_bf16 v[88:91], v[136:139], v[136:139], v[88:91]
    v_lshlrev_b32 v15, 12, v15
    s_mul_i32 s59, s3, 1792
    s_add_u32 s59, s59, 156672
    v_mul_u32_u24 v13, 448, v2
    v_mfma_f32_16x16x32_bf16 v[72:75], v[44:47], v[136:139], v[72:75]
    v_mov_b32_dpp v142, v140 row_ror:8 row_mask:0xf bank_mask:0x3
    v_mov_b32_dpp v143, v141 row_ror:8 row_mask:0xf bank_mask:0x3
    v_mfma_f32_16x16x32_bf16 v[204:207], v[96:99], v[44:47], v[204:207]
    s_waitcnt lgkmcnt(10)
    ds_read_b64_tr_b16 v[44:45], v10 offset:28768
    ds_read_b64_tr_b16 v[46:47], v10 offset:32352
    v_mfma_f32_16x16x32_bf16 v[76:79], v[48:51], v[136:139], v[76:79]
    s_nop 0
    buffer_load_dwordx4 a[200:203], v3, s[32:35], s63 offen offset:2048 sc1
    v_lshl_add_u32 v13, v1, 2, v13
    v_mfma_f32_16x16x32_bf16 v[208:211], v[96:99], v[48:51], v[208:211]
    s_waitcnt lgkmcnt(10)
    ds_read_b64_tr_b16 v[48:49], v10 offset:28800
    ds_read_b64_tr_b16 v[50:51], v10 offset:32384
    v_mfma_f32_16x16x32_bf16 v[80:83], v[52:55], v[136:139], v[80:83]
    v_mov_b32_dpp v140, v18 row_ror:8 row_mask:0xf bank_mask:0xc
    v_mov_b32_dpp v141, v19 row_ror:8 row_mask:0xf bank_mask:0xc
    v_mfma_f32_16x16x32_bf16 v[212:215], v[96:99], v[52:55], v[212:215]
    s_waitcnt lgkmcnt(10)
    ds_read_b64_tr_b16 v[52:53], v10 offset:28832
    ds_read_b64_tr_b16 v[54:55], v10 offset:32416
    v_mfma_f32_16x16x32_bf16 v[84:87], v[56:59], v[136:139], v[84:87]
    s_nop 0
    buffer_load_dwordx4 a[204:207], v3, s[32:35], s63 offen offset:3072 sc1
    v_add_u32 v13, s59, v13
    v_mfma_f32_16x16x32_bf16 v[216:219], v[96:99], v[56:59], v[216:219]
    s_waitcnt lgkmcnt(10)
    ds_read_b64_tr_b16 v[56:57], v10 offset:28864
    ds_read_b64_tr_b16 v[58:59], v10 offset:32448
    v_mfma_f32_16x16x32_bf16 v[92:95], v[96:99], v[136:139], v[92:95]
    v_lshlrev_b32 v116, 16, v28
    v_add_u32 v10, s37, v8
    v_mfma_f32_16x16x32_bf16 v[60:63], v[32:35], v[140:143], v[60:63]
    s_add_u32 s63, s8, 16384
    buffer_load_dwordx4 a[208:211], v3, s[32:35], s63 offen offset:0 sc1
    s_waitcnt vmcnt(21)
    v_max3_u32 v14, v144, v146, v148
    v_mfma_f32_16x16x32_bf16 v[192:195], v[96:99], v[32:35], v[192:195]
    s_waitcnt lgkmcnt(10)
    ds_read_b64_tr_b16 v[32:33], v10 offset:0
    ds_read_b64_tr_b16 v[34:35], v10 offset:3584
    v_mfma_f32_16x16x32_bf16 v[64:67], v[36:39], v[140:143], v[64:67]
    v_max3_u32 v14, v14, v150, v152
    v_max3_u32 v14, v14, v154, v156
    v_max_u32 v14, v14, v158
    v_mfma_f32_16x16x32_bf16 v[196:199], v[96:99], v[36:39], v[196:199]
    s_waitcnt lgkmcnt(10)
    ds_read_b64_tr_b16 v[36:37], v10 offset:32
    ds_read_b64_tr_b16 v[38:39], v10 offset:3616
    v_mfma_f32_16x16x32_bf16 v[68:71], v[40:43], v[140:143], v[68:71]
    s_nop 0
    buffer_load_dwordx4 a[212:215], v3, s[32:35], s63 offen offset:1024 sc1
    v_cmp_eq_u32 vcc, -1, v14
    s_cbranch_vccnz RTC_17
BKC_18:
    v_mfma_f32_16x16x32_bf16 v[200:203], v[96:99], v[40:43], v[200:203]
    s_waitcnt lgkmcnt(10)
    ds_read_b64_tr_b16 v[40:41], v10 offset:64
    ds_read_b64_tr_b16 v[42:43], v10 offset:3648
    v_mfma_f32_16x16x32_bf16 v[88:91], v[140:143], v[140:143], v[88:91]
    v_mov_b32 v18, v146
    v_mov_b32 v19, v147
    v_mfma_f32_16x16x32_bf16 v[72:75], v[44:47], v[140:143], v[72:75]
    v_mov_b32_dpp v146, v144 row_ror:8 row_mask:0xf bank_mask:0x3
    v_mov_b32_dpp v147, v145 row_ror:8 row_mask:0xf bank_mask:0x3
    v_mfma_f32_16x16x32_bf16 v[204:207], v[96:99], v[44:47], v[204:207]
    s_waitcnt lgkmcnt(10)
    ds_read_b64_tr_b16 v[44:45], v10 offset:96
    ds_read_b64_tr_b16 v[46:47], v10 offset:3680
    v_mfma_f32_16x16x32_bf16 v[76:79], v[48:51], v[140:143], v[76:79]
    s_nop 0
    buffer_load_dwordx4 a[216:219], v3, s[32:35], s63 offen offset:2048 sc1
    v_and_b32 v117, s65, v28
    v_mfma_f32_16x16x32_bf16 v[208:211], v[96:99], v[48:51], v[208:211]
    s_waitcnt lgkmcnt(10)
    ds_read_b64_tr_b16 v[48:49], v10 offset:128
    ds_read_b64_tr_b16 v[50:51], v10 offset:3712
    v_mfma_f32_16x16x32_bf16 v[80:83], v[52:55], v[140:143], v[80:83]
    v_mov_b32_dpp v144, v18 row_ror:8 row_mask:0xf bank_mask:0xc
    v_mov_b32_dpp v145, v19 row_ror:8 row_mask:0xf bank_mask:0xc
    v_mfma_f32_16x16x32_bf16 v[212:215], v[96:99], v[52:55], v[212:215]
    s_waitcnt lgkmcnt(10)
    ds_read_b64_tr_b16 v[52:53], v10 offset:160
    ds_read_b64_tr_b16 v[54:55], v10 offset:3744
    v_mfma_f32_16x16x32_bf16 v[84:87], v[56:59], v[140:143], v[84:87]
    s_nop 0
    buffer_load_dwordx4 a[220:223], v3, s[32:35], s63 offen offset:3072 sc1
    v_mfma_f32_16x16x32_bf16 v[216:219], v[96:99], v[56:59], v[216:219]
    s_waitcnt lgkmcnt(10)
    ds_read_b64_tr_b16 v[56:57], v10 offset:192
    ds_read_b64_tr_b16 v[58:59], v10 offset:3776
    v_mfma_f32_16x16x32_bf16 v[92:95], v[96:99], v[140:143], v[92:95]
    v_mfma_f32_16x16x32_bf16 v[60:63], v[32:35], v[144:147], v[60:63]
    s_waitcnt lgkmcnt(10)
    ds_read_b64_tr_b16 v[32:33], v10 offset:28672
    ds_read_b64_tr_b16 v[34:35], v10 offset:32256
    v_mfma_f32_16x16x32_bf16 v[64:67], v[36:39], v[144:147], v[64:67]
    s_waitcnt lgkmcnt(10)
    ds_read_b64_tr_b16 v[36:37], v10 offset:28704
    ds_read_b64_tr_b16 v[38:39], v10 offset:32288
    v_mov_b32 v18, v150
    v_mfma_f32_16x16x32_bf16 v[68:71], v[40:43], v[144:147], v[68:71]
    s_waitcnt lgkmcnt(10)
    ds_read_b64_tr_b16 v[40:41], v10 offset:28736
    ds_read_b64_tr_b16 v[42:43], v10 offset:32320
    v_mfma_f32_16x16x32_bf16 v[88:91], v[144:147], v[144:147], v[88:91]
    s_nop 0
    ds_write_b32 v13, v192 offset:0
    ds_write_b32 v13, v196 offset:64
    v_mov_b32 v19, v151
    v_mov_b32_dpp v150, v148 row_ror:8 row_mask:0xf bank_mask:0x3
    v_mfma_f32_16x16x32_bf16 v[72:75], v[44:47], v[144:147], v[72:75]
    s_waitcnt lgkmcnt(12)
    ds_read_b64_tr_b16 v[44:45], v10 offset:28768
    ds_read_b64_tr_b16 v[46:47], v10 offset:32352
    v_mfma_f32_16x16x32_bf16 v[76:79], v[48:51], v[144:147], v[76:79]
    s_waitcnt lgkmcnt(12)
    ds_read_b64_tr_b16 v[48:49], v10 offset:28800
    ds_read_b64_tr_b16 v[50:51], v10 offset:32384
    v_mov_b32_dpp v151, v149 row_ror:8 row_mask:0xf bank_mask:0x3
    v_mfma_f32_16x16x32_bf16 v[80:83], v[52:55], v[144:147], v[80:83]
    s_waitcnt lgkmcnt(12)
    ds_read_b64_tr_b16 v[52:53], v10 offset:28832
    ds_read_b64_tr_b16 v[54:55], v10 offset:32416
    v_mfma_f32_16x16x32_bf16 v[84:87], v[56:59], v[144:147], v[84:87]
    s_waitcnt lgkmcnt(12)
    ds_read_b64_tr_b16 v[56:57], v10 offset:28864
    ds_read_b64_tr_b16 v[58:59], v10 offset:32448
    v_mov_b32_dpp v148, v18 row_ror:8 row_mask:0xf bank_mask:0xc
    v_mfma_f32_16x16x32_bf16 v[92:95], v[96:99], v[144:147], v[92:95]
    s_nop 0
    ds_write_b32 v13, v200 offset:128
    ds_write_b32 v13, v204 offset:192
    v_mov_b32_dpp v149, v19 row_ror:8 row_mask:0xf bank_mask:0xc
    v_add_u32 v10, s37, v9
    s_nop 0
    v_mfma_f32_16x16x32_bf16 v[60:63], v[32:35], v[148:151], v[60:63]
    s_waitcnt lgkmcnt(14)
    ds_read_b64_tr_b16 v[32:33], v10 offset:0
    ds_read_b64_tr_b16 v[34:35], v10 offset:3584
    v_mfma_f32_16x16x32_bf16 v[64:67], v[36:39], v[148:151], v[64:67]
    s_waitcnt lgkmcnt(14)
    ds_read_b64_tr_b16 v[36:37], v10 offset:32
    ds_read_b64_tr_b16 v[38:39], v10 offset:3616
    v_mov_b32 v18, v154
    v_mfma_f32_16x16x32_bf16 v[68:71], v[40:43], v[148:151], v[68:71]
    s_waitcnt lgkmcnt(12)
    ds_read_b64_tr_b16 v[40:41], v10 offset:64
    ds_read_b64_tr_b16 v[42:43], v10 offset:3648
    v_mfma_f32_16x16x32_bf16 v[88:91], v[148:151], v[148:151], v[88:91]
    s_nop 0
    ds_write_b32 v13, v208 offset:256
    ds_write_b32 v13, v212 offset:320
    v_mov_b32 v19, v155
    v_mov_b32_dpp v154, v152 row_ror:8 row_mask:0xf bank_mask:0x3
    v_mfma_f32_16x16x32_bf16 v[72:75], v[44:47], v[148:151], v[72:75]
    s_waitcnt lgkmcnt(14)
    ds_read_b64_tr_b16 v[44:45], v10 offset:96
    ds_read_b64_tr_b16 v[46:47], v10 offset:3680
    v_mfma_f32_16x16x32_bf16 v[76:79], v[48:51], v[148:151], v[76:79]
    s_waitcnt lgkmcnt(14)
    ds_read_b64_tr_b16 v[48:49], v10 offset:128
    ds_read_b64_tr_b16 v[50:51], v10 offset:3712
    v_mov_b32_dpp v155, v153 row_ror:8 row_mask:0xf bank_mask:0x3
    v_mfma_f32_16x16x32_bf16 v[80:83], v[52:55], v[148:151], v[80:83]
    s_waitcnt lgkmcnt(14)
    ds_read_b64_tr_b16 v[52:53], v10 offset:160
    ds_read_b64_tr_b16 v[54:55], v10 offset:3744
    v_mfma_f32_16x16x32_bf16 v[84:87], v[56:59], v[148:151], v[84:87]
    s_waitcnt lgkmcnt(12)
    ds_read_b64_tr_b16 v[56:57], v10 offset:192
    ds_read_b64_tr_b16 v[58:59], v10 offset:3776
    v_mov_b32_dpp v152, v18 row_ror:8 row_mask:0xf bank_mask:0xc
    v_mfma_f32_16x16x32_bf16 v[92:95], v[96:99], v[148:151], v[92:95]
    s_nop 0
    ds_write_b32 v13, v216 offset:384
    v_add_u32 v13, 156672, v3
    v_mov_b32_dpp v153, v19 row_ror:8 row_mask:0xf bank_mask:0xc
    s_nop 1
    v_mfma_f32_16x16x32_bf16 v[60:63], v[32:35], v[152:155], v[60:63]
    s_waitcnt lgkmcnt(13)
    ds_read_b64_tr_b16 v[32:33], v10 offset:28672
    ds_read_b64_tr_b16 v[34:35], v10 offset:32256
    v_mfma_f32_16x16x32_bf16 v[64:67], v[36:39], v[152:155], v[64:67]
    s_waitcnt lgkmcnt(13)
    ds_read_b64_tr_b16 v[36:37], v10 offset:28704
    ds_read_b64_tr_b16 v[38:39], v10 offset:32288
    v_mov_b32 v18, v158
    v_mfma_f32_16x16x32_bf16 v[68:71], v[40:43], v[152:155], v[68:71]
    s_waitcnt lgkmcnt(11)
    ds_read_b64_tr_b16 v[40:41], v10 offset:28736
    ds_read_b64_tr_b16 v[42:43], v10 offset:32320
    v_mfma_f32_16x16x32_bf16 v[88:91], v[152:155], v[152:155], v[88:91]
    s_waitcnt lgkmcnt(6)
    s_barrier
    ds_read_b128 v[100:103], v13 offset:0
    ds_read_b128 v[104:107], v13 offset:1792
    v_mov_b32 v19, v159
    v_mov_b32_dpp v158, v156 row_ror:8 row_mask:0xf bank_mask:0x3
    v_mfma_f32_16x16x32_bf16 v[72:75], v[44:47], v[152:155], v[72:75]
    s_nop 0
    ds_read_b64_tr_b16 v[44:45], v10 offset:28768
    ds_read_b64_tr_b16 v[46:47], v10 offset:32352
    v_mfma_f32_16x16x32_bf16 v[76:79], v[48:51], v[152:155], v[76:79]
    s_nop 0
    ds_read_b64_tr_b16 v[48:49], v10 offset:28800
    ds_read_b64_tr_b16 v[50:51], v10 offset:32384
    v_mov_b32_dpp v159, v157 row_ror:8 row_mask:0xf bank_mask:0x3
    v_mfma_f32_16x16x32_bf16 v[80:83], v[52:55], v[152:155], v[80:83]
    s_nop 0
    ds_read_b64_tr_b16 v[52:53], v10 offset:28832
    ds_read_b64_tr_b16 v[54:55], v10 offset:32416
    v_mfma_f32_16x16x32_bf16 v[84:87], v[56:59], v[152:155], v[84:87]
    s_waitcnt lgkmcnt(12)
    ds_read_b64_tr_b16 v[56:57], v10 offset:28864
    ds_read_b64_tr_b16 v[58:59], v10 offset:32448
    v_mov_b32_dpp v156, v18 row_ror:8 row_mask:0xf bank_mask:0xc
    v_mfma_f32_16x16x32_bf16 v[92:95], v[96:99], v[152:155], v[92:95]
    s_nop 0
    ds_read_b128 v[108:111], v13 offset:3584
    ds_read_b128 v[112:115], v13 offset:5376
    v_mov_b32_dpp v157, v19 row_ror:8 row_mask:0xf bank_mask:0xc
    v_add_u32 v10, s38, v8
    s_nop 0
    v_mfma_f32_16x16x32_bf16 v[60:63], v[32:35], v[156:159], v[60:63]
    s_waitcnt lgkmcnt(14)
    ds_read_b64_tr_b16 v[32:33], v10 offset:0
    ds_read_b64_tr_b16 v[34:35], v10 offset:3584
    s_waitcnt vmcnt(20)
    v_mfma_f32_16x16x32_bf16 v[64:67], v[36:39], v[156:159], v[64:67]
    s_waitcnt lgkmcnt(14)
    ds_read_b64_tr_b16 v[36:37], v10 offset:32
    ds_read_b64_tr_b16 v[38:39], v10 offset:3616
    v_max3_u32 v14, v160, v162, v164
    v_mfma_f32_16x16x32_bf16 v[68:71], v[40:43], v[156:159], v[68:71]
    s_waitcnt lgkmcnt(12)
    ds_read_b64_tr_b16 v[40:41], v10 offset:64
    ds_read_b64_tr_b16 v[42:43], v10 offset:3648
    v_max3_u32 v14, v14, v166, v168
    v_mfma_f32_16x16x32_bf16 v[88:91], v[156:159], v[156:159], v[88:91]
    v_max3_u32 v14, v14, v170, v172
    v_max_u32 v14, v14, v174
    v_cmp_eq_u32 vcc, -1, v14
    s_cbranch_vccnz RTC_19
BKC_20:
    v_mfma_f32_16x16x32_bf16 v[72:75], v[44:47], v[156:159], v[72:75]
    s_waitcnt lgkmcnt(12)
    ds_read_b64_tr_b16 v[44:45], v10 offset:96
    ds_read_b64_tr_b16 v[46:47], v10 offset:3680
    v_mov_b32 v18, v162
    v_mfma_f32_16x16x32_bf16 v[76:79], v[48:51], v[156:159], v[76:79]
    s_waitcnt lgkmcnt(12)
    ds_read_b64_tr_b16 v[48:49], v10 offset:128
    ds_read_b64_tr_b16 v[50:51], v10 offset:3712
    v_mov_b32 v19, v163
    v_mov_b32_dpp v162, v160 row_ror:8 row_mask:0xf bank_mask:0x3
    v_mfma_f32_16x16x32_bf16 v[80:83], v[52:55], v[156:159], v[80:83]
    s_waitcnt lgkmcnt(12)
    ds_read_b64_tr_b16 v[52:53], v10 offset:160
    ds_read_b64_tr_b16 v[54:55], v10 offset:3744
    v_mfma_f32_16x16x32_bf16 v[84:87], v[56:59], v[156:159], v[84:87]
    s_waitcnt lgkmcnt(10)
    ds_read_b64_tr_b16 v[56:57], v10 offset:192
    ds_read_b64_tr_b16 v[58:59], v10 offset:3776
    v_mov_b32_dpp v163, v161 row_ror:8 row_mask:0xf bank_mask:0x3
    v_mov_b32_dpp v160, v18 row_ror:8 row_mask:0xf bank_mask:0xc
    v_mfma_f32_16x16x32_bf16 v[92:95], v[96:99], v[156:159], v[92:95]
    v_mov_b32_dpp v161, v19 row_ror:8 row_mask:0xf bank_mask:0xc
    s_nop 1
    v_mfma_f32_16x16x32_bf16 v[60:63], v[32:35], v[160:163], v[60:63]
    s_waitcnt lgkmcnt(10)
    ds_read_b64_tr_b16 v[32:33], v10 offset:28672
    ds_read_b64_tr_b16 v[34:35], v10 offset:32256
    v_add_f32 v100, v100, v104
    v_mfma_f32_16x16x32_bf16 v[64:67], v[36:39], v[160:163], v[64:67]
    s_waitcnt lgkmcnt(10)
    ds_read_b64_tr_b16 v[36:37], v10 offset:28704
    ds_read_b64_tr_b16 v[38:39], v10 offset:32288
    v_add_f32 v101, v101, v105
    v_mov_b32 v18, v166
    v_mfma_f32_16x16x32_bf16 v[68:71], v[40:43], v[160:163], v[68:71]
    s_waitcnt lgkmcnt(10)
    ds_read_b64_tr_b16 v[40:41], v10 offset:28736
    ds_read_b64_tr_b16 v[42:43], v10 offset:32320
    v_add_f32 v102, v102, v106
    v_mfma_f32_16x16x32_bf16 v[88:91], v[160:163], v[160:163], v[88:91]
    s_add_u32 s62, s13, 1048576
    buffer_load_dwordx4 v[192:195], v17, s[32:35], s62 offen offset:0 sc1
    v_mov_b32 v19, v167
    v_mov_b32_dpp v166, v164 row_ror:8 row_mask:0xf bank_mask:0x3
    v_mfma_f32_16x16x32_bf16 v[72:75], v[44:47], v[160:163], v[72:75]
    s_waitcnt lgkmcnt(10)
    ds_read_b64_tr_b16 v[44:45], v10 offset:28768
    ds_read_b64_tr_b16 v[46:47], v10 offset:32352
    v_add_f32 v103, v103, v107
    v_mfma_f32_16x16x32_bf16 v[76:79], v[48:51], v[160:163], v[76:79]
    s_waitcnt lgkmcnt(10)
    ds_read_b64_tr_b16 v[48:49], v10 offset:28800
    ds_read_b64_tr_b16 v[50:51], v10 offset:32384
    v_add_f32 v108, v108, v112
    v_mov_b32_dpp v167, v165 row_ror:8 row_mask:0xf bank_mask:0x3
    v_mfma_f32_16x16x32_bf16 v[80:83], v[52:55], v[160:163], v[80:83]
    s_waitcnt lgkmcnt(10)
    ds_read_b64_tr_b16 v[52:53], v10 offset:28832
    ds_read_b64_tr_b16 v[54:55], v10 offset:32416
    v_add_f32 v109, v109, v113
    v_mfma_f32_16x16x32_bf16 v[84:87], v[56:59], v[160:163], v[84:87]
    s_waitcnt lgkmcnt(10)
    ds_read_b64_tr_b16 v[56:57], v10 offset:28864
    ds_read_b64_tr_b16 v[58:59], v10 offset:32448
    v_add_f32 v110, v110, v114
    v_mov_b32_dpp v164, v18 row_ror:8 row_mask:0xf bank_mask:0xc
    v_mfma_f32_16x16x32_bf16 v[92:95], v[96:99], v[160:163], v[92:95]
    s_nop 0
    buffer_load_dwordx4 v[196:199], v17, s[32:35], s62 offen offset:1024 sc1
    v_mov_b32_dpp v165, v19 row_ror:8 row_mask:0xf bank_mask:0xc
    v_add_u32 v10, s38, v9
    s_nop 0
    v_mfma_f32_16x16x32_bf16 v[60:63], v[32:35], v[164:167], v[60:63]
    s_waitcnt lgkmcnt(10)
    ds_read_b64_tr_b16 v[32:33], v10 offset:0
    ds_read_b64_tr_b16 v[34:35], v10 offset:3584
    v_add_f32 v111, v111, v115
    v_mfma_f32_16x16x32_bf16 v[64:67], v[36:39], v[164:167], v[64:67]
    s_waitcnt lgkmcnt(10)
    ds_read_b64_tr_b16 v[36:37], v10 offset:32
    ds_read_b64_tr_b16 v[38:39], v10 offset:3616
    v_add_f32 v100, v100, v108
    v_mov_b32 v18, v170
    v_mfma_f32_16x16x32_bf16 v[68:71], v[40:43], v[164:167], v[68:71]
    s_waitcnt lgkmcnt(10)
    ds_read_b64_tr_b16 v[40:41], v10 offset:64
    ds_read_b64_tr_b16 v[42:43], v10 offset:3648
    v_add_f32 v101, v101, v109
    v_mfma_f32_16x16x32_bf16 v[88:91], v[164:167], v[164:167], v[88:91]
    s_nop 0
    buffer_load_dwordx4 v[200:203], v17, s[32:35], s62 offen offset:2048 sc1
    v_mov_b32 v19, v171
    v_mov_b32_dpp v170, v168 row_ror:8 row_mask:0xf bank_mask:0x3
    v_mfma_f32_16x16x32_bf16 v[72:75], v[44:47], v[164:167], v[72:75]
    s_waitcnt lgkmcnt(10)
    ds_read_b64_tr_b16 v[44:45], v10 offset:96
    ds_read_b64_tr_b16 v[46:47], v10 offset:3680
    v_add_f32 v102, v102, v110
    v_mfma_f32_16x16x32_bf16 v[76:79], v[48:51], v[164:167], v[76:79]
    s_waitcnt lgkmcnt(10)
    ds_read_b64_tr_b16 v[48:49], v10 offset:128
    ds_read_b64_tr_b16 v[50:51], v10 offset:3712
    v_add_f32 v103, v103, v111
    v_mov_b32_dpp v171, v169 row_ror:8 row_mask:0xf bank_mask:0x3
    v_mfma_f32_16x16x32_bf16 v[80:83], v[52:55], v[164:167], v[80:83]
    s_waitcnt lgkmcnt(10)
    ds_read_b64_tr_b16 v[52:53], v10 offset:160
    ds_read_b64_tr_b16 v[54:55], v10 offset:3744
    v_lshl_add_u32 v13, v0, 3, s4
    v_mfma_f32_16x16x32_bf16 v[84:87], v[56:59], v[164:167], v[84:87]
    s_waitcnt lgkmcnt(10)
    ds_read_b64_tr_b16 v[56:57], v10 offset:192
    ds_read_b64_tr_b16 v[58:59], v10 offset:3776
    v_mov_b32_dpp v168, v18 row_ror:8 row_mask:0xf bank_mask:0xc
    v_mfma_f32_16x16x32_bf16 v[92:95], v[96:99], v[164:167], v[92:95]
    s_nop 0
    buffer_load_dwordx4 v[204:207], v17, s[32:35], s62 offen offset:3072 sc1
    v_mov_b32_dpp v169, v19 row_ror:8 row_mask:0xf bank_mask:0xc
    s_nop 1
    v_mfma_f32_16x16x32_bf16 v[60:63], v[32:35], v[168:171], v[60:63]
    s_waitcnt lgkmcnt(10)
    ds_read_b64_tr_b16 v[32:33], v10 offset:28672
    ds_read_b64_tr_b16 v[34:35], v10 offset:32256
    v_mfma_f32_16x16x32_bf16 v[64:67], v[36:39], v[168:171], v[64:67]
    s_waitcnt lgkmcnt(10)
    ds_read_b64_tr_b16 v[36:37], v10 offset:28704
    ds_read_b64_tr_b16 v[38:39], v10 offset:32288
    v_mov_b32 v18, v174
    v_mfma_f32_16x16x32_bf16 v[68:71], v[40:43], v[168:171], v[68:71]
    s_waitcnt lgkmcnt(10)
    ds_read_b64_tr_b16 v[40:41], v10 offset:28736
    ds_read_b64_tr_b16 v[42:43], v10 offset:32320
    v_mfma_f32_16x16x32_bf16 v[88:91], v[168:171], v[168:171], v[88:91]
    s_add_u32 s62, s13, 1052672
    buffer_load_dwordx4 v[208:211], v17, s[32:35], s62 offen offset:0 sc1
    ds_write_b128 v27, v[100:103] offset:7168
    ds_write_b64 v13, v[116:117] offset:7616
    v_mov_b32 v19, v175
    v_mov_b32_dpp v174, v172 row_ror:8 row_mask:0xf bank_mask:0x3
    v_mfma_f32_16x16x32_bf16 v[72:75], v[44:47], v[168:171], v[72:75]
    s_waitcnt lgkmcnt(12)
    ds_read_b64_tr_b16 v[44:45], v10 offset:28768
    ds_read_b64_tr_b16 v[46:47], v10 offset:32352
    v_mfma_f32_16x16x32_bf16 v[76:79], v[48:51], v[168:171], v[76:79]
    s_waitcnt lgkmcnt(12)
    ds_read_b64_tr_b16 v[48:49], v10 offset:28800
    ds_read_b64_tr_b16 v[50:51], v10 offset:32384
    v_mov_b32_dpp v175, v173 row_ror:8 row_mask:0xf bank_mask:0x3
    v_mfma_f32_16x16x32_bf16 v[80:83], v[52:55], v[168:171], v[80:83]
    s_waitcnt lgkmcnt(12)
    ds_read_b64_tr_b16 v[52:53], v10 offset:28832
    ds_read_b64_tr_b16 v[54:55], v10 offset:32416
    v_mfma_f32_16x16x32_bf16 v[84:87], v[56:59], v[168:171], v[84:87]
    s_waitcnt lgkmcnt(12)
    ds_read_b64_tr_b16 v[56:57], v10 offset:28864
    ds_read_b64_tr_b16 v[58:59], v10 offset:32448
    v_mov_b32_dpp v172, v18 row_ror:8 row_mask:0xf bank_mask:0xc
    v_mfma_f32_16x16x32_bf16 v[92:95], v[96:99], v[168:171], v[92:95]
    s_nop 0
    buffer_load_dwordx4 v[212:215], v17, s[32:35], s62 offen offset:1024 sc1
    v_mov_b32_dpp v173, v19 row_ror:8 row_mask:0xf bank_mask:0xc
    v_add_u32 v10, s39, v8
    s_nop 0
    v_mfma_f32_16x16x32_bf16 v[60:63], v[32:35], v[172:175], v[60:63]
    s_waitcnt lgkmcnt(12)
    ds_read_b64_tr_b16 v[32:33], v10 offset:0
    ds_read_b64_tr_b16 v[34:35], v10 offset:3584
    s_waitcnt vmcnt(22)
    v_mfma_f32_16x16x32_bf16 v[64:67], v[36:39], v[172:175], v[64:67]
    s_waitcnt lgkmcnt(12)
    ds_read_b64_tr_b16 v[36:37], v10 offset:32
    ds_read_b64_tr_b16 v[38:39], v10 offset:3616
    v_max3_u32 v14, v176, v178, v180
    v_mfma_f32_16x16x32_bf16 v[68:71], v[40:43], v[172:175], v[68:71]
    s_waitcnt lgkmcnt(10)
    ds_read_b64_tr_b16 v[40:41], v10 offset:64
    ds_read_b64_tr_b16 v[42:43], v10 offset:3648
    v_max3_u32 v14, v14, v182, v184
    v_mfma_f32_16x16x32_bf16 v[88:91], v[172:175], v[172:175], v[88:91]
    s_nop 0
    buffer_load_dwordx4 v[216:219], v17, s[32:35], s62 offen offset:2048 sc1
    v_max3_u32 v14, v14, v186, v188
    v_max_u32 v14, v14, v190
    v_cmp_eq_u32 vcc, -1, v14
    s_cbranch_vccnz RTC_21
BKC_22:
    v_mfma_f32_16x16x32_bf16 v[72:75], v[44:47], v[172:175], v[72:75]
    s_waitcnt lgkmcnt(10)
    ds_read_b64_tr_b16 v[44:45], v10 offset:96
    ds_read_b64_tr_b16 v[46:47], v10 offset:3680
    v_mov_b32 v18, v178
    v_mfma_f32_16x16x32_bf16 v[76:79], v[48:51], v[172:175], v[76:79]
    s_waitcnt lgkmcnt(10)
    ds_read_b64_tr_b16 v[48:49], v10 offset:128
    ds_read_b64_tr_b16 v[50:51], v10 offset:3712
    v_mov_b32 v19, v179
    v_mov_b32_dpp v178, v176 row_ror:8 row_mask:0xf bank_mask:0x3
    v_mfma_f32_16x16x32_bf16 v[80:83], v[52:55], v[172:175], v[80:83]
    s_waitcnt lgkmcnt(10)
    ds_read_b64_tr_b16 v[52:53], v10 offset:160
    ds_read_b64_tr_b16 v[54:55], v10 offset:3744
    v_mfma_f32_16x16x32_bf16 v[84:87], v[56:59], v[172:175], v[84:87]
    s_waitcnt lgkmcnt(10)
    ds_read_b64_tr_b16 v[56:57], v10 offset:192
    ds_read_b64_tr_b16 v[58:59], v10 offset:3776
    v_mov_b32_dpp v179, v177 row_ror:8 row_mask:0xf bank_mask:0x3
    v_mov_b32_dpp v176, v18 row_ror:8 row_mask:0xf bank_mask:0xc
    v_mfma_f32_16x16x32_bf16 v[92:95], v[96:99], v[172:175], v[92:95]
    s_nop 0
    buffer_load_dwordx4 v[220:223], v17, s[32:35], s62 offen offset:3072 sc1
    v_mov_b32_dpp v177, v19 row_ror:8 row_mask:0xf bank_mask:0xc
    s_nop 1
    v_mfma_f32_16x16x32_bf16 v[60:63], v[32:35], v[176:179], v[60:63]
    s_waitcnt lgkmcnt(10)
    ds_read_b64_tr_b16 v[32:33], v10 offset:28672
    ds_read_b64_tr_b16 v[34:35], v10 offset:32256
    v_mfma_f32_16x16x32_bf16 v[64:67], v[36:39], v[176:179], v[64:67]
    s_waitcnt lgkmcnt(10)
    ds_read_b64_tr_b16 v[36:37], v10 offset:28704
    ds_read_b64_tr_b16 v[38:39], v10 offset:32288
    v_mov_b32 v18, v182
    v_mfma_f32_16x16x32_bf16 v[68:71], v[40:43], v[176:179], v[68:71]
    s_waitcnt lgkmcnt(10)
    ds_read_b64_tr_b16 v[40:41], v10 offset:28736
    ds_read_b64_tr_b16 v[42:43], v10 offset:32320
    v_mfma_f32_16x16x32_bf16 v[88:91], v[176:179], v[176:179], v[88:91]
    s_add_u32 s62, s13, 1056768
    buffer_load_dwordx4 v[224:227], v17, s[32:35], s62 offen offset:0 sc1
    v_mov_b32 v19, v183
    v_mov_b32_dpp v182, v180 row_ror:8 row_mask:0xf bank_mask:0x3
    v_mfma_f32_16x16x32_bf16 v[72:75], v[44:47], v[176:179], v[72:75]
    s_waitcnt lgkmcnt(10)
    ds_read_b64_tr_b16 v[44:45], v10 offset:28768
    ds_read_b64_tr_b16 v[46:47], v10 offset:32352
    v_mfma_f32_16x16x32_bf16 v[76:79], v[48:51], v[176:179], v[76:79]
    s_waitcnt lgkmcnt(10)
    ds_read_b64_tr_b16 v[48:49], v10 offset:28800
    ds_read_b64_tr_b16 v[50:51], v10 offset:32384
    v_mov_b32_dpp v183, v181 row_ror:8 row_mask:0xf bank_mask:0x3
    v_mfma_f32_16x16x32_bf16 v[80:83], v[52:55], v[176:179], v[80:83]
    s_waitcnt lgkmcnt(10)
    ds_read_b64_tr_b16 v[52:53], v10 offset:28832
    ds_read_b64_tr_b16 v[54:55], v10 offset:32416
    v_mfma_f32_16x16x32_bf16 v[84:87], v[56:59], v[176:179], v[84:87]
    s_waitcnt lgkmcnt(10)
    ds_read_b64_tr_b16 v[56:57], v10 offset:28864
    ds_read_b64_tr_b16 v[58:59], v10 offset:32448
    v_mov_b32_dpp v180, v18 row_ror:8 row_mask:0xf bank_mask:0xc
    v_mfma_f32_16x16x32_bf16 v[92:95], v[96:99], v[176:179], v[92:95]
    s_nop 0
    buffer_load_dwordx4 v[228:231], v17, s[32:35], s62 offen offset:1024 sc1
    v_mov_b32_dpp v181, v19 row_ror:8 row_mask:0xf bank_mask:0xc
    v_add_u32 v10, s39, v9
    s_nop 0
    v_mfma_f32_16x16x32_bf16 v[60:63], v[32:35], v[180:183], v[60:63]
    s_waitcnt lgkmcnt(10)
    ds_read_b64_tr_b16 v[32:33], v10 offset:0
    ds_read_b64_tr_b16 v[34:35], v10 offset:3584
    v_mfma_f32_16x16x32_bf16 v[64:67], v[36:39], v[180:183], v[64:67]
    s_waitcnt lgkmcnt(10)
    ds_read_b64_tr_b16 v[36:37], v10 offset:32
    ds_read_b64_tr_b16 v[38:39], v10 offset:3616
    v_mov_b32 v18, v186
    v_mov_b32 v19, v187
    v_mfma_f32_16x16x32_bf16 v[68:71], v[40:43], v[180:183], v[68:71]
    s_waitcnt lgkmcnt(10)
    ds_read_b64_tr_b16 v[40:41], v10 offset:64
    ds_read_b64_tr_b16 v[42:43], v10 offset:3648
    v_mfma_f32_16x16x32_bf16 v[88:91], v[180:183], v[180:183], v[88:91]
    s_nop 0
    buffer_load_dwordx4 v[232:235], v17, s[32:35], s62 offen offset:2048 sc1
    v_mov_b32_dpp v186, v184 row_ror:8 row_mask:0xf bank_mask:0x3
    v_mov_b32_dpp v187, v185 row_ror:8 row_mask:0xf bank_mask:0x3
    v_mfma_f32_16x16x32_bf16 v[72:75], v[44:47], v[180:183], v[72:75]
    s_waitcnt lgkmcnt(10)
    ds_read_b64_tr_b16 v[44:45], v10 offset:96
    ds_read_b64_tr_b16 v[46:47], v10 offset:3680
    v_mfma_f32_16x16x32_bf16 v[76:79], v[48:51], v[180:183], v[76:79]
    s_waitcnt lgkmcnt(10)
    ds_read_b64_tr_b16 v[48:49], v10 offset:128
    ds_read_b64_tr_b16 v[50:51], v10 offset:3712
    v_mov_b32_dpp v184, v18 row_ror:8 row_mask:0xf bank_mask:0xc
    v_mov_b32_dpp v185, v19 row_ror:8 row_mask:0xf bank_mask:0xc
    v_mfma_f32_16x16x32_bf16 v[80:83], v[52:55], v[180:183], v[80:83]
    s_waitcnt lgkmcnt(10)
    ds_read_b64_tr_b16 v[52:53], v10 offset:160
    ds_read_b64_tr_b16 v[54:55], v10 offset:3744
    v_mfma_f32_16x16x32_bf16 v[84:87], v[56:59], v[180:183], v[84:87]
    s_waitcnt lgkmcnt(10)
    ds_read_b64_tr_b16 v[56:57], v10 offset:192
    ds_read_b64_tr_b16 v[58:59], v10 offset:3776
    v_mov_b32 v18, v190
    v_mov_b32 v19, v191
    v_mfma_f32_16x16x32_bf16 v[92:95], v[96:99], v[180:183], v[92:95]
    s_nop 0
    buffer_load_dwordx4 v[236:239], v17, s[32:35], s62 offen offset:3072 sc1
    v_mov_b32_dpp v190, v188 row_ror:8 row_mask:0xf bank_mask:0x3
    v_mov_b32_dpp v191, v189 row_ror:8 row_mask:0xf bank_mask:0x3
    v_mfma_f32_16x16x32_bf16 v[88:91], v[184:187], v[184:187], v[88:91]
    s_add_u32 s62, s13, 1060864
    buffer_load_dwordx4 v[240:243], v17, s[32:35], s62 offen offset:0 sc1
    v_mov_b32_dpp v188, v18 row_ror:8 row_mask:0xf bank_mask:0xc
    v_mov_b32_dpp v189, v19 row_ror:8 row_mask:0xf bank_mask:0xc
    v_mfma_f32_16x16x32_bf16 v[92:95], v[96:99], v[184:187], v[92:95]
    s_nop 0
    v_mfma_f32_16x16x32_bf16 v[88:91], v[188:191], v[188:191], v[88:91]
    v_mfma_f32_16x16x32_bf16 v[92:95], v[96:99], v[188:191], v[92:95]
    s_nop 0
    buffer_load_dwordx4 v[244:247], v17, s[32:35], s62 offen offset:1024 sc1
    ds_read_b128 v[104:107], v11 offset:7168
    ds_read_b128 v[108:111], v11 offset:7616
    ds_read_b128 v[112:115], v11 offset:7232
    ds_read_b128 v[116:119], v11 offset:7680
    v_mfma_f32_16x16x32_bf16 v[60:63], v[32:35], v[184:187], v[60:63]
    s_waitcnt lgkmcnt(14)
    ds_read_b64_tr_b16 v[32:33], v10 offset:28672
    ds_read_b64_tr_b16 v[34:35], v10 offset:32256
    v_mfma_f32_16x16x32_bf16 v[64:67], v[36:39], v[184:187], v[64:67]
    s_waitcnt lgkmcnt(14)
    ds_read_b64_tr_b16 v[36:37], v10 offset:28704
    ds_read_b64_tr_b16 v[38:39], v10 offset:32288
    s_mov_b32 vcc_lo, 0x22222222
    s_mov_b32 vcc_hi, 0x22222222
    v_cndmask_b32 v102, v88, v89, vcc
    v_mfma_f32_16x16x32_bf16 v[68:71], v[40:43], v[184:187], v[68:71]
    s_waitcnt lgkmcnt(14)
    ds_read_b64_tr_b16 v[40:41], v10 offset:28736
    ds_read_b64_tr_b16 v[42:43], v10 offset:32320
    s_mov_b32 vcc_lo, 0x44444444
    s_mov_b32 vcc_hi, 0x44444444
    v_cndmask_b32 v102, v102, v90, vcc
    v_mfma_f32_16x16x32_bf16 v[72:75], v[44:47], v[184:187], v[72:75]
    s_waitcnt lgkmcnt(14)
    ds_read_b64_tr_b16 v[44:45], v10 offset:28768
    ds_read_b64_tr_b16 v[46:47], v10 offset:32352
    s_mov_b32 vcc_lo, 0x88888888
    s_mov_b32 vcc_hi, 0x88888888
    v_cndmask_b32 v102, v102, v91, vcc
    v_mfma_f32_16x16x32_bf16 v[76:79], v[48:51], v[184:187], v[76:79]
    s_waitcnt lgkmcnt(14)
    ds_read_b64_tr_b16 v[48:49], v10 offset:28800
    ds_read_b64_tr_b16 v[50:51], v10 offset:32384
    ds_bpermute_b32 v101, v12, v102
    v_mfma_f32_16x16x32_bf16 v[80:83], v[52:55], v[184:187], v[80:83]
    s_waitcnt lgkmcnt(14)
    ds_read_b64_tr_b16 v[52:53], v10 offset:28832
    ds_read_b64_tr_b16 v[54:55], v10 offset:32416
    v_mul_f32 v100, 0x3b000000, v92
    v_mfma_f32_16x16x32_bf16 v[84:87], v[56:59], v[184:187], v[84:87]
    s_waitcnt lgkmcnt(11)
    ds_read_b64_tr_b16 v[56:57], v10 offset:28864
    ds_read_b64_tr_b16 v[58:59], v10 offset:32448
    v_mfma_f32_16x16x32_bf16 v[60:63], v[32:35], v[188:191], v[60:63]
    s_waitcnt lgkmcnt(11)
    buffer_load_dwordx4 v[248:251], v17, s[32:35], s62 offen offset:2048 sc1
    v_mfma_f32_16x16x32_bf16 v[64:67], v[36:39], v[188:191], v[64:67]
    s_waitcnt lgkmcnt(9)
    s_waitcnt lgkmcnt(4)
    v_mul_f32 v101, 0x3b000000, v101
    v_fma_f32 v101, -v100, v100, v101
    v_mfma_f32_16x16x32_bf16 v[68:71], v[40:43], v[188:191], v[68:71]
    v_max_f32 v101, 0, v101
    v_cvt_pk_bf16_f32 v102, v101, v101
    v_mfma_f32_16x16x32_bf16 v[72:75], v[44:47], v[188:191], v[72:75]
    s_nop 0
    buffer_load_dwordx4 v[252:255], v17, s[32:35], s62 offen offset:3072 sc1
    v_lshlrev_b32 v102, 16, v102
    v_add_f32 v102, 0x3727c5ac, v102
    v_mfma_f32_16x16x32_bf16 v[76:79], v[48:51], v[188:191], v[76:79]
    s_waitcnt lgkmcnt(2)
    v_cvt_pk_bf16_f32 v102, v102, v102
    v_lshlrev_b32 v102, 16, v102
    v_mfma_f32_16x16x32_bf16 v[80:83], v[52:55], v[188:191], v[80:83]
    s_waitcnt lgkmcnt(0)
    v_sqrt_f32 v102, v102
    s_nop 0
    v_cvt_pk_bf16_f32 v102, v102, v102
    v_mfma_f32_16x16x32_bf16 v[84:87], v[56:59], v[188:191], v[84:87]
    v_lshlrev_b32 v102, 16, v102
    v_rcp_f32 v102, v102
    s_nop 0
    v_mul_f32 v103, v101, v102
    v_mul_f32 v103, v103, v102
    v_cvt_pk_bf16_f32 v103, v103, v103
    v_lshlrev_b32 v103, 16, v103
    v_add_f32 v103, 0x3727c5ac, v103
    v_cvt_pk_bf16_f32 v103, v103, v103
    v_lshlrev_b32 v103, 16, v103
    v_sqrt_f32 v103, v103
    s_nop 0
    v_cvt_pk_bf16_f32 v103, v103, v103
    v_lshlrev_b32 v103, 16, v103
    v_rcp_f32 v103, v103
    s_nop 0
    v_mul_f32 v26, v102, v103
    v_mul_f32 v27, v102, v103
    v_mul_f32 v30, v26, v100
    v_sub_f32 v30, 0, v30
    v_mov_b32 v31, v30
    v_pk_fma_f32 v[120:121], v[104:105], v[30:31], v[108:109]
    v_pk_fma_f32 v[122:123], v[106:107], v[30:31], v[110:111]
    v_pk_fma_f32 v[124:125], v[112:113], v[30:31], v[116:117]
    v_pk_fma_f32 v[126:127], v[114:115], v[30:31], v[118:119]
    ds_read_b128 v[104:107], v11 offset:7296
    ds_read_b128 v[108:111], v11 offset:7744
    ds_read_b128 v[112:115], v11 offset:7360
    ds_read_b128 v[116:119], v11 offset:7808
    s_add_u32 s63, s8, 32768
    buffer_load_dwordx4 a[224:227], v3, s[32:35], s63 offen offset:0 sc1
    v_pk_fma_f32 v[60:61], v[60:61], v[26:27], v[120:121]
    v_pk_fma_f32 v[62:63], v[62:63], v[26:27], v[122:123]
    v_pk_fma_f32 v[64:65], v[64:65], v[26:27], v[124:125]
    v_pk_fma_f32 v[66:67], v[66:67], v[26:27], v[126:127]
    v_pk_mul_f32 v[120:121], v[60:61], v[60:61]
    v_pk_mul_f32 v[122:123], v[62:63], v[62:63]
    v_pk_mul_f32 v[124:125], v[64:65], v[64:65]
    v_pk_mul_f32 v[126:127], v[66:67], v[66:67]
    v_pk_fma_f32 v[120:121], v[120:121], v[22:23], v[20:21]
    v_pk_fma_f32 v[122:123], v[122:123], v[22:23], v[20:21]
    v_pk_fma_f32 v[124:125], v[124:125], v[22:23], v[20:21]
    v_pk_fma_f32 v[126:127], v[126:127], v[22:23], v[20:21]
    v_pk_mul_f32 v[120:121], v[120:121], v[60:61]
    v_pk_mul_f32 v[122:123], v[122:123], v[62:63]
    v_pk_mul_f32 v[124:125], v[124:125], v[64:65]
    v_pk_mul_f32 v[126:127], v[126:127], v[66:67]
    v_exp_f32 v120, v120
    v_exp_f32 v121, v121
    v_exp_f32 v122, v122
    v_exp_f32 v123, v123
    v_exp_f32 v124, v124
    v_exp_f32 v125, v125
    v_exp_f32 v126, v126
    v_exp_f32 v127, v127
    buffer_load_dwordx4 a[228:231], v3, s[32:35], s63 offen offset:1024 sc1
    v_pk_add_f32 v[120:121], v[120:121], v[24:25]
    v_pk_add_f32 v[122:123], v[122:123], v[24:25]
    v_pk_add_f32 v[124:125], v[124:125], v[24:25]
    v_pk_add_f32 v[126:127], v[126:127], v[24:25]
    v_rcp_f32 v120, v120
    v_rcp_f32 v121, v121
    v_rcp_f32 v122, v122
    v_rcp_f32 v123, v123
    v_rcp_f32 v124, v124
    v_rcp_f32 v125, v125
    v_rcp_f32 v126, v126
    v_rcp_f32 v127, v127
    v_pk_mul_f32 v[60:61], v[60:61], v[120:121]
    v_pk_mul_f32 v[62:63], v[62:63], v[122:123]
    v_pk_mul_f32 v[64:65], v[64:65], v[124:125]
    v_pk_mul_f32 v[66:67], v[66:67], v[126:127]
    v_cvt_pk_bf16_f32 v60, v60, v61
    v_cvt_pk_bf16_f32 v61, v62, v63
    v_cvt_pk_bf16_f32 v62, v64, v65
    v_cvt_pk_bf16_f32 v63, v66, v67
    buffer_store_dwordx4 v[60:63], v3, s[32:35], s11 offen offset:0 sc1
    buffer_load_dwordx4 a[232:235], v3, s[32:35], s63 offen offset:2048 sc1
    s_waitcnt lgkmcnt(0)
    v_pk_fma_f32 v[120:121], v[104:105], v[30:31], v[108:109]
    v_pk_fma_f32 v[122:123], v[106:107], v[30:31], v[110:111]
    v_pk_fma_f32 v[124:125], v[112:113], v[30:31], v[116:117]
    v_pk_fma_f32 v[126:127], v[114:115], v[30:31], v[118:119]
    ds_read_b128 v[104:107], v11 offset:7424
    ds_read_b128 v[108:111], v11 offset:7872
    ds_read_b128 v[112:115], v11 offset:7488
    ds_read_b128 v[116:119], v11 offset:7936
    v_pk_fma_f32 v[68:69], v[68:69], v[26:27], v[120:121]
    v_pk_fma_f32 v[70:71], v[70:71], v[26:27], v[122:123]
    v_pk_fma_f32 v[72:73], v[72:73], v[26:27], v[124:125]
    v_pk_fma_f32 v[74:75], v[74:75], v[26:27], v[126:127]
    v_pk_mul_f32 v[120:121], v[68:69], v[68:69]
    v_pk_mul_f32 v[122:123], v[70:71], v[70:71]
    v_pk_mul_f32 v[124:125], v[72:73], v[72:73]
    v_pk_mul_f32 v[126:127], v[74:75], v[74:75]
    buffer_load_dwordx4 a[236:239], v3, s[32:35], s63 offen offset:3072 sc1
    v_pk_fma_f32 v[120:121], v[120:121], v[22:23], v[20:21]
    v_pk_fma_f32 v[122:123], v[122:123], v[22:23], v[20:21]
    v_pk_fma_f32 v[124:125], v[124:125], v[22:23], v[20:21]
    v_pk_fma_f32 v[126:127], v[126:127], v[22:23], v[20:21]
    v_pk_mul_f32 v[120:121], v[120:121], v[68:69]
    v_pk_mul_f32 v[122:123], v[122:123], v[70:71]
    v_pk_mul_f32 v[124:125], v[124:125], v[72:73]
    v_pk_mul_f32 v[126:127], v[126:127], v[74:75]
    v_exp_f32 v120, v120
    v_exp_f32 v121, v121
    v_exp_f32 v122, v122
    v_exp_f32 v123, v123
    v_exp_f32 v124, v124
    v_exp_f32 v125, v125
    v_exp_f32 v126, v126
    v_exp_f32 v127, v127
    v_pk_add_f32 v[120:121], v[120:121], v[24:25]
    v_pk_add_f32 v[122:123], v[122:123], v[24:25]
    v_pk_add_f32 v[124:125], v[124:125], v[24:25]
    v_pk_add_f32 v[126:127], v[126:127], v[24:25]
    s_add_u32 s63, s8, 45056
    buffer_load_dwordx4 a[240:243], v3, s[32:35], s63 offen offset:0 sc1
    v_rcp_f32 v120, v120
    v_rcp_f32 v121, v121
    v_rcp_f32 v122, v122
    v_rcp_f32 v123, v123
    v_rcp_f32 v124, v124
    v_rcp_f32 v125, v125
    v_rcp_f32 v126, v126
    v_rcp_f32 v127, v127
    v_pk_mul_f32 v[68:69], v[68:69], v[120:121]
    v_pk_mul_f32 v[70:71], v[70:71], v[122:123]
    v_pk_mul_f32 v[72:73], v[72:73], v[124:125]
    v_pk_mul_f32 v[74:75], v[74:75], v[126:127]
    v_cvt_pk_bf16_f32 v68, v68, v69
    v_cvt_pk_bf16_f32 v69, v70, v71
    v_cvt_pk_bf16_f32 v70, v72, v73
    v_cvt_pk_bf16_f32 v71, v74, v75
    buffer_store_dwordx4 v[68:71], v3, s[32:35], s11 offen offset:1024 sc1
    buffer_load_dwordx4 a[244:247], v3, s[32:35], s63 offen offset:1024 sc1
    s_waitcnt lgkmcnt(0)
    v_pk_fma_f32 v[120:121], v[104:105], v[30:31], v[108:109]
    v_pk_fma_f32 v[122:123], v[106:107], v[30:31], v[110:111]
    v_pk_fma_f32 v[124:125], v[112:113], v[30:31], v[116:117]
    v_pk_fma_f32 v[126:127], v[114:115], v[30:31], v[118:119]
    ds_read_b128 v[104:107], v11 offset:7552
    ds_read_b128 v[108:111], v11 offset:8000
    v_pk_fma_f32 v[76:77], v[76:77], v[26:27], v[120:121]
    v_pk_fma_f32 v[78:79], v[78:79], v[26:27], v[122:123]
    v_pk_fma_f32 v[80:81], v[80:81], v[26:27], v[124:125]
    v_pk_fma_f32 v[82:83], v[82:83], v[26:27], v[126:127]
    v_pk_mul_f32 v[120:121], v[76:77], v[76:77]
    v_pk_mul_f32 v[122:123], v[78:79], v[78:79]
    v_pk_mul_f32 v[124:125], v[80:81], v[80:81]
    v_pk_mul_f32 v[126:127], v[82:83], v[82:83]
    v_pk_fma_f32 v[120:121], v[120:121], v[22:23], v[20:21]
    v_pk_fma_f32 v[122:123], v[122:123], v[22:23], v[20:21]
    v_pk_fma_f32 v[124:125], v[124:125], v[22:23], v[20:21]
    v_pk_fma_f32 v[126:127], v[126:127], v[22:23], v[20:21]
    v_pk_mul_f32 v[120:121], v[120:121], v[76:77]
    v_pk_mul_f32 v[122:123], v[122:123], v[78:79]
    v_pk_mul_f32 v[124:125], v[124:125], v[80:81]
    v_pk_mul_f32 v[126:127], v[126:127], v[82:83]
    buffer_load_dwordx4 a[248:251], v3, s[32:35], s63 offen offset:2048 sc1
    v_exp_f32 v120, v120
    v_exp_f32 v121, v121
    v_exp_f32 v122, v122
    v_exp_f32 v123, v123
    v_exp_f32 v124, v124
    v_exp_f32 v125, v125
    v_exp_f32 v126, v126
    v_exp_f32 v127, v127
    v_pk_add_f32 v[120:121], v[120:121], v[24:25]
    v_pk_add_f32 v[122:123], v[122:123], v[24:25]
    v_pk_add_f32 v[124:125], v[124:125], v[24:25]
    v_pk_add_f32 v[126:127], v[126:127], v[24:25]
    v_rcp_f32 v120, v120
    v_rcp_f32 v121, v121
    v_rcp_f32 v122, v122
    v_rcp_f32 v123, v123
    v_rcp_f32 v124, v124
    v_rcp_f32 v125, v125
    v_rcp_f32 v126, v126
    v_rcp_f32 v127, v127
    buffer_load_dwordx4 a[252:255], v3, s[32:35], s63 offen offset:3072 sc1
    v_pk_mul_f32 v[76:77], v[76:77], v[120:121]
    v_pk_mul_f32 v[78:79], v[78:79], v[122:123]
    v_pk_mul_f32 v[80:81], v[80:81], v[124:125]
    v_pk_mul_f32 v[82:83], v[82:83], v[126:127]
    v_cvt_pk_bf16_f32 v76, v76, v77
    v_cvt_pk_bf16_f32 v77, v78, v79
    v_cvt_pk_bf16_f32 v78, v80, v81
    v_cvt_pk_bf16_f32 v79, v82, v83
    buffer_store_dwordx4 v[76:79], v3, s[32:35], s11 offen offset:2048 sc1
    s_waitcnt lgkmcnt(0)
    v_pk_fma_f32 v[120:121], v[104:105], v[30:31], v[108:109]
    v_pk_fma_f32 v[122:123], v[106:107], v[30:31], v[110:111]
    ds_read_b128 v[104:107], v11 offset:7168
    ds_read_b128 v[108:111], v11 offset:7616
    ds_read_b128 v[112:115], v11 offset:7232
    ds_read_b128 v[116:119], v11 offset:7680
    s_add_u32 s63, s8, 8192
    buffer_load_dwordx4 a[0:3], v3, s[32:35], s63 offen offset:0 sc1
    v_pk_fma_f32 v[84:85], v[84:85], v[26:27], v[120:121]
    v_pk_fma_f32 v[86:87], v[86:87], v[26:27], v[122:123]
    v_pk_mul_f32 v[120:121], v[84:85], v[84:85]
    v_pk_mul_f32 v[122:123], v[86:87], v[86:87]
    v_pk_fma_f32 v[120:121], v[120:121], v[22:23], v[20:21]
    v_pk_fma_f32 v[122:123], v[122:123], v[22:23], v[20:21]
    v_pk_mul_f32 v[120:121], v[120:121], v[84:85]
    v_pk_mul_f32 v[122:123], v[122:123], v[86:87]
    v_exp_f32 v120, v120
    v_exp_f32 v121, v121
    v_exp_f32 v122, v122
    v_exp_f32 v123, v123
    buffer_load_dwordx4 a[4:7], v3, s[32:35], s63 offen offset:1024 sc1
    v_pk_add_f32 v[120:121], v[120:121], v[24:25]
    v_pk_add_f32 v[122:123], v[122:123], v[24:25]
    v_rcp_f32 v120, v120
    v_rcp_f32 v121, v121
    v_rcp_f32 v122, v122
    v_rcp_f32 v123, v123
    v_pk_mul_f32 v[84:85], v[84:85], v[120:121]
    v_pk_mul_f32 v[86:87], v[86:87], v[122:123]
    v_cvt_pk_bf16_f32 v84, v84, v85
    v_cvt_pk_bf16_f32 v85, v86, v87
    buffer_store_dwordx2 v[84:85], v16, s[32:35], s12 offen sc1
    s_add_u32 s11, s11, 3670016
    s_add_u32 s12, s12, 3670016
    s_waitcnt vmcnt(26)
    v_max3_u32 v14, v192, v194, v196
    v_max3_u32 v14, v14, v198, v200
    v_max3_u32 v14, v14, v202, v204
    v_max_u32 v14, v14, v206
    v_cmp_eq_u32 vcc, -1, v14
    s_cbranch_vccnz RTE_27
BKE_28:
    v_mov_b32 v18, v194
    v_mov_b32 v19, v195
    v_mov_b32_dpp v194, v192 row_ror:8 row_mask:0xf bank_mask:0x3
    v_mov_b32_dpp v195, v193 row_ror:8 row_mask:0xf bank_mask:0x3
    v_mov_b32_dpp v192, v18 row_ror:8 row_mask:0xf bank_mask:0xc
    v_mov_b32_dpp v193, v19 row_ror:8 row_mask:0xf bank_mask:0xc
    v_mov_b32 v18, v198
    v_mov_b32 v19, v199
    v_mov_b32_dpp v198, v196 row_ror:8 row_mask:0xf bank_mask:0x3
    v_mfma_f32_16x16x32_bf16 v[88:91], v[192:195], v[192:195], 0
    s_waitcnt vmcnt(22)
    buffer_load_dwordx4 a[8:11], v3, s[32:35], s63 offen offset:2048 sc1
    v_max3_u32 v14, v208, v210, v212
    v_mov_b32_dpp v199, v197 row_ror:8 row_mask:0xf bank_mask:0x3
    v_mov_b32_dpp v196, v18 row_ror:8 row_mask:0xf bank_mask:0xc
    v_mov_b32_dpp v197, v19 row_ror:8 row_mask:0xf bank_mask:0xc
    v_mfma_f32_16x16x32_bf16 v[92:95], v[96:99], v[192:195], 0
    v_max3_u32 v14, v14, v214, v216
    v_mov_b32 v18, v202
    v_mov_b32 v19, v203
    v_mov_b32_dpp v202, v200 row_ror:8 row_mask:0xf bank_mask:0x3
    v_mfma_f32_16x16x32_bf16 v[88:91], v[196:199], v[196:199], v[88:91]
    v_max3_u32 v14, v14, v218, v220
    v_mov_b32_dpp v203, v201 row_ror:8 row_mask:0xf bank_mask:0x3
    v_mov_b32_dpp v200, v18 row_ror:8 row_mask:0xf bank_mask:0xc
    v_mov_b32_dpp v201, v19 row_ror:8 row_mask:0xf bank_mask:0xc
    v_mfma_f32_16x16x32_bf16 v[92:95], v[96:99], v[196:199], v[92:95]
    v_max_u32 v14, v14, v222
    v_mov_b32 v18, v206
    v_mov_b32 v19, v207
    v_mov_b32_dpp v206, v204 row_ror:8 row_mask:0xf bank_mask:0x3
    v_mfma_f32_16x16x32_bf16 v[88:91], v[200:203], v[200:203], v[88:91]
    v_cmp_eq_u32 vcc, -1, v14
    v_mov_b32_dpp v207, v205 row_ror:8 row_mask:0xf bank_mask:0x3
    v_mov_b32_dpp v204, v18 row_ror:8 row_mask:0xf bank_mask:0xc
    v_mov_b32_dpp v205, v19 row_ror:8 row_mask:0xf bank_mask:0xc
    v_mfma_f32_16x16x32_bf16 v[92:95], v[96:99], v[200:203], v[92:95]
    s_nop 0
    buffer_load_dwordx4 a[12:15], v3, s[32:35], s63 offen offset:3072 sc1
    s_cbranch_vccnz RTE_29
BKE_30:
    v_mov_b32 v18, v210
    v_mov_b32 v19, v211
    v_mov_b32_dpp v210, v208 row_ror:8 row_mask:0xf bank_mask:0x3
    v_mfma_f32_16x16x32_bf16 v[88:91], v[204:207], v[204:207], v[88:91]
    v_mov_b32_dpp v211, v209 row_ror:8 row_mask:0xf bank_mask:0x3
    v_mov_b32_dpp v208, v18 row_ror:8 row_mask:0xf bank_mask:0xc
    v_mov_b32_dpp v209, v19 row_ror:8 row_mask:0xf bank_mask:0xc
    v_mfma_f32_16x16x32_bf16 v[92:95], v[96:99], v[204:207], v[92:95]
    v_mov_b32 v18, v214
    v_mov_b32 v19, v215
    v_mov_b32_dpp v214, v212 row_ror:8 row_mask:0xf bank_mask:0x3
    v_mfma_f32_16x16x32_bf16 v[88:91], v[208:211], v[208:211], v[88:91]
    s_waitcnt vmcnt(20)
    v_max3_u32 v14, v224, v226, v228
    v_mov_b32_dpp v215, v213 row_ror:8 row_mask:0xf bank_mask:0x3
    v_mov_b32_dpp v212, v18 row_ror:8 row_mask:0xf bank_mask:0xc
    v_mov_b32_dpp v213, v19 row_ror:8 row_mask:0xf bank_mask:0xc
    v_mfma_f32_16x16x32_bf16 v[92:95], v[96:99], v[208:211], v[92:95]
    s_add_u32 s63, s8, 20480
    buffer_load_dwordx4 a[16:19], v3, s[32:35], s63 offen offset:0 sc1
    v_max3_u32 v14, v14, v230, v232
    v_mov_b32 v18, v218
    v_mov_b32 v19, v219
    v_mov_b32_dpp v218, v216 row_ror:8 row_mask:0xf bank_mask:0x3
    v_mfma_f32_16x16x32_bf16 v[88:91], v[212:215], v[212:215], v[88:91]
    v_max3_u32 v14, v14, v234, v236
    v_mov_b32_dpp v219, v217 row_ror:8 row_mask:0xf bank_mask:0x3
    v_mov_b32_dpp v216, v18 row_ror:8 row_mask:0xf bank_mask:0xc
    v_mov_b32_dpp v217, v19 row_ror:8 row_mask:0xf bank_mask:0xc
    v_mfma_f32_16x16x32_bf16 v[92:95], v[96:99], v[212:215], v[92:95]
    v_max_u32 v14, v14, v238
    v_mov_b32 v18, v222
    v_mov_b32 v19, v223
    v_mov_b32_dpp v222, v220 row_ror:8 row_mask:0xf bank_mask:0x3
    v_mfma_f32_16x16x32_bf16 v[88:91], v[216:219], v[216:219], v[88:91]
    v_cmp_eq_u32 vcc, -1, v14
    v_mov_b32_dpp v223, v221 row_ror:8 row_mask:0xf bank_mask:0x3
    v_mov_b32_dpp v220, v18 row_ror:8 row_mask:0xf bank_mask:0xc
    v_mov_b32_dpp v221, v19 row_ror:8 row_mask:0xf bank_mask:0xc
    v_mfma_f32_16x16x32_bf16 v[92:95], v[96:99], v[216:219], v[92:95]
    s_cbranch_vccnz RTE_31
BKE_32:
    v_mov_b32 v18, v226
    v_mov_b32 v19, v227
    v_mov_b32_dpp v226, v224 row_ror:8 row_mask:0xf bank_mask:0x3
    v_mfma_f32_16x16x32_bf16 v[88:91], v[220:223], v[220:223], v[88:91]
    s_nop 0
    buffer_load_dwordx4 a[20:23], v3, s[32:35], s63 offen offset:1024 sc1
    v_mov_b32_dpp v227, v225 row_ror:8 row_mask:0xf bank_mask:0x3
    v_mov_b32_dpp v224, v18 row_ror:8 row_mask:0xf bank_mask:0xc
    v_mov_b32_dpp v225, v19 row_ror:8 row_mask:0xf bank_mask:0xc
    v_mfma_f32_16x16x32_bf16 v[92:95], v[96:99], v[220:223], v[92:95]
    v_mov_b32 v18, v230
    v_mov_b32 v19, v231
    v_mov_b32_dpp v230, v228 row_ror:8 row_mask:0xf bank_mask:0x3
    v_mfma_f32_16x16x32_bf16 v[88:91], v[224:227], v[224:227], v[88:91]
    s_waitcnt vmcnt(18)
    v_max3_u32 v14, v240, v242, v244
    v_mov_b32_dpp v231, v229 row_ror:8 row_mask:0xf bank_mask:0x3
    v_mov_b32_dpp v228, v18 row_ror:8 row_mask:0xf bank_mask:0xc
    v_mov_b32_dpp v229, v19 row_ror:8 row_mask:0xf bank_mask:0xc
    v_mfma_f32_16x16x32_bf16 v[92:95], v[96:99], v[224:227], v[92:95]
    v_max3_u32 v14, v14, v246, v248
    v_mov_b32 v18, v234
    v_mov_b32 v19, v235
    v_mov_b32_dpp v234, v232 row_ror:8 row_mask:0xf bank_mask:0x3
    v_mfma_f32_16x16x32_bf16 v[88:91], v[228:231], v[228:231], v[88:91]
    s_nop 0
    buffer_load_dwordx4 a[24:27], v3, s[32:35], s63 offen offset:2048 sc1
    v_max3_u32 v14, v14, v250, v252
    v_mov_b32_dpp v235, v233 row_ror:8 row_mask:0xf bank_mask:0x3
    v_mov_b32_dpp v232, v18 row_ror:8 row_mask:0xf bank_mask:0xc
    v_mov_b32_dpp v233, v19 row_ror:8 row_mask:0xf bank_mask:0xc
    v_mfma_f32_16x16x32_bf16 v[92:95], v[96:99], v[228:231], v[92:95]
    v_max_u32 v14, v14, v254
    v_mov_b32 v18, v238
    v_mov_b32 v19, v239
    v_mov_b32_dpp v238, v236 row_ror:8 row_mask:0xf bank_mask:0x3
    v_mfma_f32_16x16x32_bf16 v[88:91], v[232:235], v[232:235], v[88:91]
    v_cmp_eq_u32 vcc, -1, v14
    v_mov_b32_dpp v239, v237 row_ror:8 row_mask:0xf bank_mask:0x3
    v_mov_b32_dpp v236, v18 row_ror:8 row_mask:0xf bank_mask:0xc
    v_mov_b32_dpp v237, v19 row_ror:8 row_mask:0xf bank_mask:0xc
    v_mfma_f32_16x16x32_bf16 v[92:95], v[96:99], v[232:235], v[92:95]
    s_cbranch_vccnz RTE_33
BKE_34:
    v_mov_b32 v18, v242
    v_mov_b32 v19, v243
    v_mov_b32_dpp v242, v240 row_ror:8 row_mask:0xf bank_mask:0x3
    v_mfma_f32_16x16x32_bf16 v[88:91], v[236:239], v[236:239], v[88:91]
    v_mov_b32_dpp v243, v241 row_ror:8 row_mask:0xf bank_mask:0x3
    v_mov_b32_dpp v240, v18 row_ror:8 row_mask:0xf bank_mask:0xc
    v_mov_b32_dpp v241, v19 row_ror:8 row_mask:0xf bank_mask:0xc
    v_mfma_f32_16x16x32_bf16 v[92:95], v[96:99], v[236:239], v[92:95]
    s_nop 0
    buffer_load_dwordx4 a[28:31], v3, s[32:35], s63 offen offset:3072 sc1
    v_mov_b32 v18, v246
    v_mov_b32 v19, v247
    v_mov_b32_dpp v246, v244 row_ror:8 row_mask:0xf bank_mask:0x3
    v_mfma_f32_16x16x32_bf16 v[88:91], v[240:243], v[240:243], v[88:91]
    v_mov_b32_dpp v247, v245 row_ror:8 row_mask:0xf bank_mask:0x3
    v_mov_b32_dpp v244, v18 row_ror:8 row_mask:0xf bank_mask:0xc
    v_mov_b32_dpp v245, v19 row_ror:8 row_mask:0xf bank_mask:0xc
    v_mfma_f32_16x16x32_bf16 v[92:95], v[96:99], v[240:243], v[92:95]
    s_nop 0
    ds_read_b64_tr_b16 v[32:33], v8 offset:0
    ds_read_b64_tr_b16 v[34:35], v8 offset:3584
    v_mov_b32 v18, v250
    v_mov_b32 v19, v251
    v_mov_b32_dpp v250, v248 row_ror:8 row_mask:0xf bank_mask:0x3
    v_mfma_f32_16x16x32_bf16 v[88:91], v[244:247], v[244:247], v[88:91]
    s_nop 0
    ds_read_b64_tr_b16 v[36:37], v8 offset:32
    ds_read_b64_tr_b16 v[38:39], v8 offset:3616
    v_mov_b32_dpp v251, v249 row_ror:8 row_mask:0xf bank_mask:0x3
    v_mov_b32_dpp v248, v18 row_ror:8 row_mask:0xf bank_mask:0xc
    v_mov_b32_dpp v249, v19 row_ror:8 row_mask:0xf bank_mask:0xc
    v_mfma_f32_16x16x32_bf16 v[92:95], v[96:99], v[244:247], v[92:95]
    s_nop 0
    ds_read_b64_tr_b16 v[40:41], v8 offset:28672
    ds_read_b64_tr_b16 v[42:43], v8 offset:32256
    s_add_u32 s63, s8, 36864
    buffer_load_dwordx4 a[32:35], v3, s[32:35], s63 offen offset:0 sc1
    v_mov_b32 v18, v254
    v_mov_b32 v19, v255
    v_mov_b32_dpp v254, v252 row_ror:8 row_mask:0xf bank_mask:0x3
    v_mfma_f32_16x16x32_bf16 v[88:91], v[248:251], v[248:251], v[88:91]
    s_nop 0
    ds_read_b64_tr_b16 v[44:45], v8 offset:28704
    ds_read_b64_tr_b16 v[46:47], v8 offset:32288
    v_mov_b32_dpp v255, v253 row_ror:8 row_mask:0xf bank_mask:0x3
    v_mov_b32_dpp v252, v18 row_ror:8 row_mask:0xf bank_mask:0xc
    v_mov_b32_dpp v253, v19 row_ror:8 row_mask:0xf bank_mask:0xc
    v_mfma_f32_16x16x32_bf16 v[92:95], v[96:99], v[248:251], v[92:95]
    s_nop 0
    ds_read_b64_tr_b16 v[48:49], v9 offset:0
    ds_read_b64_tr_b16 v[50:51], v9 offset:3584
    v_mfma_f32_16x16x32_bf16 v[88:91], v[252:255], v[252:255], v[88:91]
    s_nop 0
    ds_read_b64_tr_b16 v[52:53], v9 offset:32
    ds_read_b64_tr_b16 v[54:55], v9 offset:3616
    v_mfma_f32_16x16x32_bf16 v[92:95], v[96:99], v[252:255], v[92:95]
    s_nop 0
    ds_read_b64_tr_b16 v[56:57], v9 offset:28672
    ds_read_b64_tr_b16 v[58:59], v9 offset:32256
    s_waitcnt lgkmcnt(12)
    v_mfma_f32_16x16x32_bf16 v[60:63], v[32:35], v[192:195], 0
    s_waitcnt lgkmcnt(10)
    ds_read_b64_tr_b16 v[32:33], v9 offset:28704
    ds_read_b64_tr_b16 v[34:35], v9 offset:32288
    s_waitcnt vmcnt(7)
    s_mov_b64 exec, 1
    buffer_store_dword v24, off, s[32:35], s9 offset:16 sc1
    s_mov_b64 exec, -1
    buffer_load_dwordx4 a[36:39], v3, s[32:35], s63 offen offset:1024 sc1
    v_mfma_f32_16x16x32_bf16 v[64:67], v[36:39], v[192:195], 0
    s_waitcnt lgkmcnt(10)
    ds_read_b64_tr_b16 v[36:37], v8 offset:7168
    ds_read_b64_tr_b16 v[38:39], v8 offset:10752
    s_mov_b32 vcc_lo, 0x22222222
    s_mov_b32 vcc_hi, 0x22222222
    v_cndmask_b32 v102, v88, v89, vcc
    v_mfma_f32_16x16x32_bf16 v[60:63], v[40:43], v[196:199], v[60:63]
    s_waitcnt lgkmcnt(10)
    ds_read_b64_tr_b16 v[40:41], v8 offset:7200
    ds_read_b64_tr_b16 v[42:43], v8 offset:10784
    s_mov_b32 vcc_lo, 0x44444444
    s_mov_b32 vcc_hi, 0x44444444
    v_cndmask_b32 v102, v102, v90, vcc
    v_mfma_f32_16x16x32_bf16 v[64:67], v[44:47], v[196:199], v[64:67]
    s_waitcnt lgkmcnt(10)
    ds_read_b64_tr_b16 v[44:45], v8 offset:35840
    ds_read_b64_tr_b16 v[46:47], v8 offset:39424
    s_mov_b32 vcc_lo, 0x88888888
    s_mov_b32 vcc_hi, 0x88888888
    v_cndmask_b32 v102, v102, v91, vcc
    v_mfma_f32_16x16x32_bf16 v[60:63], v[48:51], v[200:203], v[60:63]
    s_waitcnt lgkmcnt(10)
    ds_read_b64_tr_b16 v[48:49], v8 offset:35872
    ds_read_b64_tr_b16 v[50:51], v8 offset:39456
    buffer_load_dwordx4 a[40:43], v3, s[32:35], s63 offen offset:2048 sc1
    ds_bpermute_b32 v101, v12, v102
    v_mfma_f32_16x16x32_bf16 v[64:67], v[52:55], v[200:203], v[64:67]
    s_waitcnt lgkmcnt(11)
    ds_read_b64_tr_b16 v[52:53], v9 offset:7168
    ds_read_b64_tr_b16 v[54:55], v9 offset:10752
    v_mul_f32 v100, 0x3b000000, v92
    v_mfma_f32_16x16x32_bf16 v[60:63], v[56:59], v[204:207], v[60:63]
    s_waitcnt lgkmcnt(11)
    ds_read_b64_tr_b16 v[56:57], v9 offset:7200
    ds_read_b64_tr_b16 v[58:59], v9 offset:10784
    v_mfma_f32_16x16x32_bf16 v[64:67], v[32:35], v[204:207], v[64:67]
    s_waitcnt lgkmcnt(11)
    ds_read_b64_tr_b16 v[32:33], v9 offset:35840
    ds_read_b64_tr_b16 v[34:35], v9 offset:39424
    v_mfma_f32_16x16x32_bf16 v[60:63], v[36:39], v[208:211], v[60:63]
    s_waitcnt lgkmcnt(11)
    ds_read_b64_tr_b16 v[36:37], v9 offset:35872
    ds_read_b64_tr_b16 v[38:39], v9 offset:39456
    v_mfma_f32_16x16x32_bf16 v[64:67], v[40:43], v[208:211], v[64:67]
    s_waitcnt lgkmcnt(11)
    ds_read_b64_tr_b16 v[40:41], v8 offset:14336
    ds_read_b64_tr_b16 v[42:43], v8 offset:17920
    buffer_load_dwordx4 a[44:47], v3, s[32:35], s63 offen offset:3072 sc1
    s_waitcnt lgkmcnt(10)
    v_mul_f32 v101, 0x3b000000, v101
    v_mfma_f32_16x16x32_bf16 v[60:63], v[44:47], v[212:215], v[60:63]
    s_nop 0
    ds_read_b64_tr_b16 v[44:45], v8 offset:14368
    ds_read_b64_tr_b16 v[46:47], v8 offset:17952
    v_fma_f32 v101, -v100, v100, v101
    v_mfma_f32_16x16x32_bf16 v[64:67], v[48:51], v[212:215], v[64:67]
    s_waitcnt lgkmcnt(10)
    ds_read_b64_tr_b16 v[48:49], v8 offset:43008
    ds_read_b64_tr_b16 v[50:51], v8 offset:46592
    v_max_f32 v101, 0, v101
    v_mfma_f32_16x16x32_bf16 v[60:63], v[52:55], v[216:219], v[60:63]
    s_waitcnt lgkmcnt(10)
    ds_read_b64_tr_b16 v[52:53], v8 offset:43040
    ds_read_b64_tr_b16 v[54:55], v8 offset:46624
    v_cvt_pk_bf16_f32 v102, v101, v101
    v_mfma_f32_16x16x32_bf16 v[64:67], v[56:59], v[216:219], v[64:67]
    s_waitcnt lgkmcnt(10)
    ds_read_b64_tr_b16 v[56:57], v9 offset:14336
    ds_read_b64_tr_b16 v[58:59], v9 offset:17920
    s_add_u32 s63, s8, 49152
    buffer_load_dwordx4 a[48:51], v3, s[32:35], s63 offen offset:0 sc1
    v_lshlrev_b32 v102, 16, v102
    v_mfma_f32_16x16x32_bf16 v[60:63], v[32:35], v[220:223], v[60:63]
    s_waitcnt lgkmcnt(10)
    ds_read_b64_tr_b16 v[32:33], v9 offset:14368
    ds_read_b64_tr_b16 v[34:35], v9 offset:17952
    v_add_f32 v102, 0x3727c5ac, v102
    v_mfma_f32_16x16x32_bf16 v[64:67], v[36:39], v[220:223], v[64:67]
    s_waitcnt lgkmcnt(10)
    ds_read_b64_tr_b16 v[36:37], v9 offset:43008
    ds_read_b64_tr_b16 v[38:39], v9 offset:46592
    v_cvt_pk_bf16_f32 v102, v102, v102
    v_mfma_f32_16x16x32_bf16 v[60:63], v[40:43], v[224:227], v[60:63]
    s_waitcnt lgkmcnt(10)
    ds_read_b64_tr_b16 v[40:41], v9 offset:43040
    ds_read_b64_tr_b16 v[42:43], v9 offset:46624
    v_lshlrev_b32 v102, 16, v102
    v_sqrt_f32 v102, v102
    v_mfma_f32_16x16x32_bf16 v[64:67], v[44:47], v[224:227], v[64:67]
    s_waitcnt lgkmcnt(10)
    ds_read_b64_tr_b16 v[44:45], v8 offset:21504
    ds_read_b64_tr_b16 v[46:47], v8 offset:25088
    v_cvt_pk_bf16_f32 v102, v102, v102
    v_lshlrev_b32 v102, 16, v102
    v_mfma_f32_16x16x32_bf16 v[60:63], v[48:51], v[228:231], v[60:63]
    s_waitcnt lgkmcnt(10)
    ds_read_b64_tr_b16 v[48:49], v8 offset:21536
    ds_read_b64_tr_b16 v[50:51], v8 offset:25120
    buffer_load_dwordx4 a[52:55], v3, s[32:35], s63 offen offset:1024 sc1
    v_rcp_f32 v102, v102
    s_nop 0
    v_mul_f32 v103, v101, v102
    v_mfma_f32_16x16x32_bf16 v[64:67], v[52:55], v[228:231], v[64:67]
    s_waitcnt lgkmcnt(10)
    ds_read_b64_tr_b16 v[52:53], v8 offset:50176
    ds_read_b64_tr_b16 v[54:55], v8 offset:53760
    v_mul_f32 v103, v103, v102
    v_cvt_pk_bf16_f32 v103, v103, v103
    v_mfma_f32_16x16x32_bf16 v[60:63], v[56:59], v[232:235], v[60:63]
    s_waitcnt lgkmcnt(10)
    ds_read_b64_tr_b16 v[56:57], v8 offset:50208
    ds_read_b64_tr_b16 v[58:59], v8 offset:53792
    v_lshlrev_b32 v103, 16, v103
    v_add_f32 v103, 0x3727c5ac, v103
    v_mfma_f32_16x16x32_bf16 v[64:67], v[32:35], v[232:235], v[64:67]
    s_waitcnt lgkmcnt(10)
    ds_read_b64_tr_b16 v[32:33], v9 offset:21504
    ds_read_b64_tr_b16 v[34:35], v9 offset:25088
    v_cvt_pk_bf16_f32 v103, v103, v103
    v_lshlrev_b32 v103, 16, v103
    v_mfma_f32_16x16x32_bf16 v[60:63], v[36:39], v[236:239], v[60:63]
    s_waitcnt lgkmcnt(10)
    ds_read_b64_tr_b16 v[36:37], v9 offset:21536
    ds_read_b64_tr_b16 v[38:39], v9 offset:25120
    buffer_load_dwordx4 a[56:59], v3, s[32:35], s63 offen offset:2048 sc1
    v_sqrt_f32 v103, v103
    s_nop 0
    v_cvt_pk_bf16_f32 v103, v103, v103
    v_mfma_f32_16x16x32_bf16 v[64:67], v[40:43], v[236:239], v[64:67]
    s_waitcnt lgkmcnt(10)
    ds_read_b64_tr_b16 v[40:41], v9 offset:50176
    ds_read_b64_tr_b16 v[42:43], v9 offset:53760
    v_lshlrev_b32 v103, 16, v103
    v_rcp_f32 v103, v103
    v_mfma_f32_16x16x32_bf16 v[60:63], v[44:47], v[240:243], v[60:63]
    s_waitcnt lgkmcnt(10)
    ds_read_b64_tr_b16 v[44:45], v9 offset:50208
    ds_read_b64_tr_b16 v[46:47], v9 offset:53792
    v_mul_f32 v26, v102, v103
    v_mul_f32 v27, v102, v103
    v_mfma_f32_16x16x32_bf16 v[64:67], v[48:51], v[240:243], v[64:67]
    s_waitcnt lgkmcnt(10)
    ds_read_b64_tr_b16 v[48:49], v8 offset:64
    ds_read_b64_tr_b16 v[50:51], v8 offset:3648
    v_mul_f32 v30, v26, v100
    v_sub_f32 v30, 0, v30
    v_mfma_f32_16x16x32_bf16 v[60:63], v[52:55], v[244:247], v[60:63]
    s_waitcnt lgkmcnt(10)
    ds_read_b64_tr_b16 v[52:53], v8 offset:96
    ds_read_b64_tr_b16 v[54:55], v8 offset:3680
    v_mov_b32 v31, v30
    v_mfma_f32_16x16x32_bf16 v[64:67], v[56:59], v[244:247], v[64:67]
    s_waitcnt lgkmcnt(10)
    ds_read_b64_tr_b16 v[56:57], v8 offset:28736
    ds_read_b64_tr_b16 v[58:59], v8 offset:32320
    buffer_load_dwordx4 a[60:63], v3, s[32:35], s63 offen offset:3072 sc1
    v_mfma_f32_16x16x32_bf16 v[60:63], v[32:35], v[248:251], v[60:63]
    s_waitcnt lgkmcnt(10)
    ds_read_b64_tr_b16 v[32:33], v8 offset:28768
    ds_read_b64_tr_b16 v[34:35], v8 offset:32352
    v_mfma_f32_16x16x32_bf16 v[64:67], v[36:39], v[248:251], v[64:67]
    s_waitcnt lgkmcnt(10)
    ds_read_b64_tr_b16 v[36:37], v9 offset:64
    ds_read_b64_tr_b16 v[38:39], v9 offset:3648
    v_mfma_f32_16x16x32_bf16 v[60:63], v[40:43], v[252:255], v[60:63]
    s_waitcnt lgkmcnt(10)
    ds_read_b64_tr_b16 v[40:41], v9 offset:96
    ds_read_b64_tr_b16 v[42:43], v9 offset:3680
    v_mfma_f32_16x16x32_bf16 v[64:67], v[44:47], v[252:255], v[64:67]
    s_waitcnt lgkmcnt(10)
    ds_read_b64_tr_b16 v[44:45], v9 offset:28736
    ds_read_b64_tr_b16 v[46:47], v9 offset:32320
    s_add_u32 s63, s8, 24576
    buffer_load_dwordx4 a[64:67], v3, s[32:35], s63 offen offset:0 sc1
    v_pk_fma_f32 v[120:121], v[104:105], v[30:31], v[108:109]
    v_pk_fma_f32 v[122:123], v[106:107], v[30:31], v[110:111]
    v_pk_fma_f32 v[124:125], v[112:113], v[30:31], v[116:117]
    v_pk_fma_f32 v[126:127], v[114:115], v[30:31], v[118:119]
    ds_read_b128 v[104:107], v11 offset:7296
    ds_read_b128 v[108:111], v11 offset:7744
    ds_read_b128 v[112:115], v11 offset:7360
    ds_read_b128 v[116:119], v11 offset:7808
    v_pk_fma_f32 v[60:61], v[60:61], v[26:27], v[120:121]
    v_pk_fma_f32 v[62:63], v[62:63], v[26:27], v[122:123]
    v_pk_fma_f32 v[64:65], v[64:65], v[26:27], v[124:125]
    v_pk_fma_f32 v[66:67], v[66:67], v[26:27], v[126:127]
    v_pk_mul_f32 v[120:121], v[60:61], v[60:61]
    v_pk_mul_f32 v[122:123], v[62:63], v[62:63]
    v_pk_mul_f32 v[124:125], v[64:65], v[64:65]
    v_pk_mul_f32 v[126:127], v[66:67], v[66:67]
    buffer_load_dwordx4 a[68:71], v3, s[32:35], s63 offen offset:1024 sc1
    v_pk_fma_f32 v[120:121], v[120:121], v[22:23], v[20:21]
    v_pk_fma_f32 v[122:123], v[122:123], v[22:23], v[20:21]
    v_pk_fma_f32 v[124:125], v[124:125], v[22:23], v[20:21]
    v_pk_fma_f32 v[126:127], v[126:127], v[22:23], v[20:21]
    v_pk_mul_f32 v[120:121], v[120:121], v[60:61]
    v_pk_mul_f32 v[122:123], v[122:123], v[62:63]
    v_pk_mul_f32 v[124:125], v[124:125], v[64:65]
    v_pk_mul_f32 v[126:127], v[126:127], v[66:67]
    v_exp_f32 v120, v120
    v_exp_f32 v121, v121
    v_exp_f32 v122, v122
    v_exp_f32 v123, v123
    v_exp_f32 v124, v124
    v_exp_f32 v125, v125
    v_exp_f32 v126, v126
    v_exp_f32 v127, v127
    buffer_load_dwordx4 a[72:75], v3, s[32:35], s63 offen offset:2048 sc1
    v_pk_add_f32 v[120:121], v[120:121], v[24:25]
    v_pk_add_f32 v[122:123], v[122:123], v[24:25]
    v_pk_add_f32 v[124:125], v[124:125], v[24:25]
    v_pk_add_f32 v[126:127], v[126:127], v[24:25]
    v_rcp_f32 v120, v120
    v_rcp_f32 v121, v121
    v_rcp_f32 v122, v122
    v_rcp_f32 v123, v123
    v_rcp_f32 v124, v124
    v_rcp_f32 v125, v125
    v_rcp_f32 v126, v126
    v_rcp_f32 v127, v127
    buffer_load_dwordx4 a[76:79], v3, s[32:35], s63 offen offset:3072 sc1
    v_pk_mul_f32 v[60:61], v[60:61], v[120:121]
    v_pk_mul_f32 v[62:63], v[62:63], v[122:123]
    v_pk_mul_f32 v[64:65], v[64:65], v[124:125]
    v_pk_mul_f32 v[66:67], v[66:67], v[126:127]
    v_cvt_pk_bf16_f32 v60, v60, v61
    v_cvt_pk_bf16_f32 v61, v62, v63
    v_cvt_pk_bf16_f32 v62, v64, v65
    v_cvt_pk_bf16_f32 v63, v66, v67
    buffer_store_dwordx4 v[60:63], v3, s[32:35], s11 offen offset:0 sc1
    s_add_u32 s63, s8, 53248
    buffer_load_dwordx4 a[80:83], v3, s[32:35], s63 offen offset:0 sc1
    v_mfma_f32_16x16x32_bf16 v[68:71], v[48:51], v[192:195], 0
    s_waitcnt lgkmcnt(14)
    ds_read_b64_tr_b16 v[48:49], v9 offset:28768
    ds_read_b64_tr_b16 v[50:51], v9 offset:32352
    v_mfma_f32_16x16x32_bf16 v[72:75], v[52:55], v[192:195], 0
    s_waitcnt lgkmcnt(14)
    ds_read_b64_tr_b16 v[52:53], v8 offset:7232
    ds_read_b64_tr_b16 v[54:55], v8 offset:10816
    v_mfma_f32_16x16x32_bf16 v[68:71], v[56:59], v[196:199], v[68:71]
    s_waitcnt lgkmcnt(14)
    ds_read_b64_tr_b16 v[56:57], v8 offset:7264
    ds_read_b64_tr_b16 v[58:59], v8 offset:10848
    buffer_load_dwordx4 a[84:87], v3, s[32:35], s63 offen offset:1024 sc1
    v_mfma_f32_16x16x32_bf16 v[72:75], v[32:35], v[196:199], v[72:75]
    s_waitcnt lgkmcnt(14)
    ds_read_b64_tr_b16 v[32:33], v8 offset:35904
    ds_read_b64_tr_b16 v[34:35], v8 offset:39488
    v_mfma_f32_16x16x32_bf16 v[68:71], v[36:39], v[200:203], v[68:71]
    s_waitcnt lgkmcnt(14)
    ds_read_b64_tr_b16 v[36:37], v8 offset:35936
    ds_read_b64_tr_b16 v[38:39], v8 offset:39520
    v_mfma_f32_16x16x32_bf16 v[72:75], v[40:43], v[200:203], v[72:75]
    s_waitcnt lgkmcnt(14)
    ds_read_b64_tr_b16 v[40:41], v9 offset:7232
    ds_read_b64_tr_b16 v[42:43], v9 offset:10816
    v_mfma_f32_16x16x32_bf16 v[68:71], v[44:47], v[204:207], v[68:71]
    s_waitcnt lgkmcnt(10)
    ds_read_b64_tr_b16 v[44:45], v9 offset:7264
    ds_read_b64_tr_b16 v[46:47], v9 offset:10848
    buffer_load_dwordx4 a[88:91], v3, s[32:35], s63 offen offset:2048 sc1
    v_mfma_f32_16x16x32_bf16 v[72:75], v[48:51], v[204:207], v[72:75]
    s_waitcnt lgkmcnt(10)
    ds_read_b64_tr_b16 v[48:49], v9 offset:35904
    ds_read_b64_tr_b16 v[50:51], v9 offset:39488
    v_mfma_f32_16x16x32_bf16 v[68:71], v[52:55], v[208:211], v[68:71]
    s_waitcnt lgkmcnt(10)
    ds_read_b64_tr_b16 v[52:53], v9 offset:35936
    ds_read_b64_tr_b16 v[54:55], v9 offset:39520
    v_mfma_f32_16x16x32_bf16 v[72:75], v[56:59], v[208:211], v[72:75]
    s_waitcnt lgkmcnt(10)
    ds_read_b64_tr_b16 v[56:57], v8 offset:14400
    ds_read_b64_tr_b16 v[58:59], v8 offset:17984
    v_mfma_f32_16x16x32_bf16 v[68:71], v[32:35], v[212:215], v[68:71]
    s_waitcnt lgkmcnt(10)
    ds_read_b64_tr_b16 v[32:33], v8 offset:14432
    ds_read_b64_tr_b16 v[34:35], v8 offset:18016
    v_mfma_f32_16x16x32_bf16 v[72:75], v[36:39], v[212:215], v[72:75]
    s_waitcnt lgkmcnt(10)
    ds_read_b64_tr_b16 v[36:37], v8 offset:43072
    ds_read_b64_tr_b16 v[38:39], v8 offset:46656
    buffer_load_dwordx4 a[92:95], v3, s[32:35], s63 offen offset:3072 sc1
    v_mfma_f32_16x16x32_bf16 v[68:71], v[40:43], v[216:219], v[68:71]
    s_waitcnt lgkmcnt(10)
    ds_read_b64_tr_b16 v[40:41], v8 offset:43104
    ds_read_b64_tr_b16 v[42:43], v8 offset:46688
    buffer_load_dwordx2 v[96:97], v15, s[32:35], s7 offen sc1
    v_mfma_f32_16x16x32_bf16 v[72:75], v[44:47], v[216:219], v[72:75]
    s_waitcnt lgkmcnt(10)
    ds_read_b64_tr_b16 v[44:45], v9 offset:14400
    ds_read_b64_tr_b16 v[46:47], v9 offset:17984
    v_mfma_f32_16x16x32_bf16 v[68:71], v[48:51], v[220:223], v[68:71]
    s_waitcnt lgkmcnt(10)
    ds_read_b64_tr_b16 v[48:49], v9 offset:14432
    ds_read_b64_tr_b16 v[50:51], v9 offset:18016
    v_mfma_f32_16x16x32_bf16 v[72:75], v[52:55], v[220:223], v[72:75]
    s_waitcnt lgkmcnt(10)
    ds_read_b64_tr_b16 v[52:53], v9 offset:43072
    ds_read_b64_tr_b16 v[54:55], v9 offset:46656
    v_mfma_f32_16x16x32_bf16 v[68:71], v[56:59], v[224:227], v[68:71]
    s_waitcnt lgkmcnt(10)
    ds_read_b64_tr_b16 v[56:57], v9 offset:43104
    ds_read_b64_tr_b16 v[58:59], v9 offset:46688
    v_mfma_f32_16x16x32_bf16 v[72:75], v[32:35], v[224:227], v[72:75]
    s_waitcnt lgkmcnt(10)
    ds_read_b64_tr_b16 v[32:33], v8 offset:21568
    ds_read_b64_tr_b16 v[34:35], v8 offset:25152
    v_mfma_f32_16x16x32_bf16 v[68:71], v[36:39], v[228:231], v[68:71]
    s_waitcnt lgkmcnt(10)
    ds_read_b64_tr_b16 v[36:37], v8 offset:21600
    ds_read_b64_tr_b16 v[38:39], v8 offset:25184
    v_mfma_f32_16x16x32_bf16 v[72:75], v[40:43], v[228:231], v[72:75]
    s_waitcnt lgkmcnt(10)
    ds_read_b64_tr_b16 v[40:41], v8 offset:50240
    ds_read_b64_tr_b16 v[42:43], v8 offset:53824
    v_mfma_f32_16x16x32_bf16 v[68:71], v[44:47], v[232:235], v[68:71]
    s_waitcnt lgkmcnt(10)
    ds_read_b64_tr_b16 v[44:45], v8 offset:50272
    ds_read_b64_tr_b16 v[46:47], v8 offset:53856
    v_mfma_f32_16x16x32_bf16 v[72:75], v[48:51], v[232:235], v[72:75]
    s_waitcnt lgkmcnt(10)
    ds_read_b64_tr_b16 v[48:49], v9 offset:21568
    ds_read_b64_tr_b16 v[50:51], v9 offset:25152
    v_mfma_f32_16x16x32_bf16 v[68:71], v[52:55], v[236:239], v[68:71]
    s_waitcnt lgkmcnt(10)
    ds_read_b64_tr_b16 v[52:53], v9 offset:21600
    ds_read_b64_tr_b16 v[54:55], v9 offset:25184
    v_mfma_f32_16x16x32_bf16 v[72:75], v[56:59], v[236:239], v[72:75]
    s_waitcnt lgkmcnt(10)
    ds_read_b64_tr_b16 v[56:57], v9 offset:50240
    ds_read_b64_tr_b16 v[58:59], v9 offset:53824
    v_mfma_f32_16x16x32_bf16 v[68:71], v[32:35], v[240:243], v[68:71]
    s_waitcnt lgkmcnt(10)
    ds_read_b64_tr_b16 v[32:33], v9 offset:50272
    ds_read_b64_tr_b16 v[34:35], v9 offset:53856
    v_mfma_f32_16x16x32_bf16 v[72:75], v[36:39], v[240:243], v[72:75]
    s_waitcnt lgkmcnt(10)
    ds_read_b64_tr_b16 v[36:37], v8 offset:128
    ds_read_b64_tr_b16 v[38:39], v8 offset:3712
    v_mfma_f32_16x16x32_bf16 v[68:71], v[40:43], v[244:247], v[68:71]
    s_waitcnt lgkmcnt(10)
    ds_read_b64_tr_b16 v[40:41], v8 offset:160
    ds_read_b64_tr_b16 v[42:43], v8 offset:3744
    v_mfma_f32_16x16x32_bf16 v[72:75], v[44:47], v[244:247], v[72:75]
    s_waitcnt lgkmcnt(10)
    ds_read_b64_tr_b16 v[44:45], v8 offset:28800
    ds_read_b64_tr_b16 v[46:47], v8 offset:32384
    v_mfma_f32_16x16x32_bf16 v[68:71], v[48:51], v[248:251], v[68:71]
    s_waitcnt lgkmcnt(10)
    ds_read_b64_tr_b16 v[48:49], v8 offset:28832
    ds_read_b64_tr_b16 v[50:51], v8 offset:32416
    v_mfma_f32_16x16x32_bf16 v[72:75], v[52:55], v[248:251], v[72:75]
    s_waitcnt lgkmcnt(10)
    ds_read_b64_tr_b16 v[52:53], v9 offset:128
    ds_read_b64_tr_b16 v[54:55], v9 offset:3712
    v_mfma_f32_16x16x32_bf16 v[68:71], v[56:59], v[252:255], v[68:71]
    s_waitcnt lgkmcnt(10)
    ds_read_b64_tr_b16 v[56:57], v9 offset:160
    ds_read_b64_tr_b16 v[58:59], v9 offset:3744
    v_mfma_f32_16x16x32_bf16 v[72:75], v[32:35], v[252:255], v[72:75]
    s_waitcnt lgkmcnt(10)
    ds_read_b64_tr_b16 v[32:33], v9 offset:28800
    ds_read_b64_tr_b16 v[34:35], v9 offset:32384
    v_pk_fma_f32 v[120:121], v[104:105], v[30:31], v[108:109]
    v_pk_fma_f32 v[122:123], v[106:107], v[30:31], v[110:111]
    v_pk_fma_f32 v[124:125], v[112:113], v[30:31], v[116:117]
    v_pk_fma_f32 v[126:127], v[114:115], v[30:31], v[118:119]
    ds_read_b128 v[104:107], v11 offset:7424
    ds_read_b128 v[108:111], v11 offset:7872
    ds_read_b128 v[112:115], v11 offset:7488
    ds_read_b128 v[116:119], v11 offset:7936
    v_pk_fma_f32 v[68:69], v[68:69], v[26:27], v[120:121]
    v_pk_fma_f32 v[70:71], v[70:71], v[26:27], v[122:123]
    v_pk_fma_f32 v[72:73], v[72:73], v[26:27], v[124:125]
    v_pk_fma_f32 v[74:75], v[74:75], v[26:27], v[126:127]
    v_pk_mul_f32 v[120:121], v[68:69], v[68:69]
    v_pk_mul_f32 v[122:123], v[70:71], v[70:71]
    v_pk_mul_f32 v[124:125], v[72:73], v[72:73]
    v_pk_mul_f32 v[126:127], v[74:75], v[74:75]
    v_pk_fma_f32 v[120:121], v[120:121], v[22:23], v[20:21]
    v_pk_fma_f32 v[122:123], v[122:123], v[22:23], v[20:21]
    v_pk_fma_f32 v[124:125], v[124:125], v[22:23], v[20:21]
    v_pk_fma_f32 v[126:127], v[126:127], v[22:23], v[20:21]
    v_pk_mul_f32 v[120:121], v[120:121], v[68:69]
    v_pk_mul_f32 v[122:123], v[122:123], v[70:71]
    v_pk_mul_f32 v[124:125], v[124:125], v[72:73]
    v_pk_mul_f32 v[126:127], v[126:127], v[74:75]
    v_exp_f32 v120, v120
    v_exp_f32 v121, v121
    v_exp_f32 v122, v122
    v_exp_f32 v123, v123
    v_exp_f32 v124, v124
    v_exp_f32 v125, v125
    v_exp_f32 v126, v126
    v_exp_f32 v127, v127
    v_pk_add_f32 v[120:121], v[120:121], v[24:25]
    v_pk_add_f32 v[122:123], v[122:123], v[24:25]
    v_pk_add_f32 v[124:125], v[124:125], v[24:25]
    v_pk_add_f32 v[126:127], v[126:127], v[24:25]
    v_rcp_f32 v120, v120
    v_rcp_f32 v121, v121
    v_rcp_f32 v122, v122
    v_rcp_f32 v123, v123
    v_rcp_f32 v124, v124
    v_rcp_f32 v125, v125
    v_rcp_f32 v126, v126
    v_rcp_f32 v127, v127
    v_pk_mul_f32 v[68:69], v[68:69], v[120:121]
    v_pk_mul_f32 v[70:71], v[70:71], v[122:123]
    v_pk_mul_f32 v[72:73], v[72:73], v[124:125]
    v_pk_mul_f32 v[74:75], v[74:75], v[126:127]
    v_cvt_pk_bf16_f32 v68, v68, v69
    v_cvt_pk_bf16_f32 v69, v70, v71
    v_cvt_pk_bf16_f32 v70, v72, v73
    v_cvt_pk_bf16_f32 v71, v74, v75
    buffer_store_dwordx4 v[68:71], v3, s[32:35], s11 offen offset:1024 sc1
    v_mfma_f32_16x16x32_bf16 v[76:79], v[36:39], v[192:195], 0
    s_waitcnt lgkmcnt(14)
    ds_read_b64_tr_b16 v[36:37], v9 offset:28832
    ds_read_b64_tr_b16 v[38:39], v9 offset:32416
    v_mfma_f32_16x16x32_bf16 v[80:83], v[40:43], v[192:195], 0
    s_waitcnt lgkmcnt(14)
    ds_read_b64_tr_b16 v[40:41], v8 offset:7296
    ds_read_b64_tr_b16 v[42:43], v8 offset:10880
    v_mfma_f32_16x16x32_bf16 v[76:79], v[44:47], v[196:199], v[76:79]
    s_waitcnt lgkmcnt(14)
    ds_read_b64_tr_b16 v[44:45], v8 offset:7328
    ds_read_b64_tr_b16 v[46:47], v8 offset:10912
    v_mfma_f32_16x16x32_bf16 v[80:83], v[48:51], v[196:199], v[80:83]
    s_waitcnt lgkmcnt(14)
    ds_read_b64_tr_b16 v[48:49], v8 offset:35968
    ds_read_b64_tr_b16 v[50:51], v8 offset:39552
    v_mfma_f32_16x16x32_bf16 v[76:79], v[52:55], v[200:203], v[76:79]
    s_waitcnt lgkmcnt(14)
    ds_read_b64_tr_b16 v[52:53], v8 offset:36000
    ds_read_b64_tr_b16 v[54:55], v8 offset:39584
    v_mfma_f32_16x16x32_bf16 v[80:83], v[56:59], v[200:203], v[80:83]
    s_waitcnt lgkmcnt(14)
    ds_read_b64_tr_b16 v[56:57], v9 offset:7296
    ds_read_b64_tr_b16 v[58:59], v9 offset:10880
    v_mfma_f32_16x16x32_bf16 v[76:79], v[32:35], v[204:207], v[76:79]
    s_waitcnt lgkmcnt(10)
    ds_read_b64_tr_b16 v[32:33], v9 offset:7328
    ds_read_b64_tr_b16 v[34:35], v9 offset:10912
    v_mfma_f32_16x16x32_bf16 v[80:83], v[36:39], v[204:207], v[80:83]
    s_waitcnt lgkmcnt(10)
    ds_read_b64_tr_b16 v[36:37], v9 offset:35968
    ds_read_b64_tr_b16 v[38:39], v9 offset:39552
    v_mfma_f32_16x16x32_bf16 v[76:79], v[40:43], v[208:211], v[76:79]
    s_waitcnt lgkmcnt(10)
    ds_read_b64_tr_b16 v[40:41], v9 offset:36000
    ds_read_b64_tr_b16 v[42:43], v9 offset:39584
    v_mfma_f32_16x16x32_bf16 v[80:83], v[44:47], v[208:211], v[80:83]
    s_waitcnt lgkmcnt(10)
    ds_read_b64_tr_b16 v[44:45], v8 offset:14464
    ds_read_b64_tr_b16 v[46:47], v8 offset:18048
    v_mfma_f32_16x16x32_bf16 v[76:79], v[48:51], v[212:215], v[76:79]
    s_waitcnt lgkmcnt(10)
    ds_read_b64_tr_b16 v[48:49], v8 offset:14496
    ds_read_b64_tr_b16 v[50:51], v8 offset:18080
    s_waitcnt vmcnt(1)
    v_and_b32 v96, v96, v97
    v_cmp_ne_u32 vcc, 1.0, v96
    s_cbranch_vccnz FP_25
FD_26:
    v_mfma_f32_16x16x32_bf16 v[80:83], v[52:55], v[212:215], v[80:83]
    s_waitcnt lgkmcnt(10)
    ds_read_b64_tr_b16 v[52:53], v8 offset:43136
    ds_read_b64_tr_b16 v[54:55], v8 offset:46720
    s_add_u32 s60, s95, 0
    buffer_load_dwordx4 v[128:131], v3, s[32:35], s60 offen sc1
    v_mfma_f32_16x16x32_bf16 v[76:79], v[56:59], v[216:219], v[76:79]
    s_waitcnt lgkmcnt(10)
    ds_read_b64_tr_b16 v[56:57], v8 offset:43168
    ds_read_b64_tr_b16 v[58:59], v8 offset:46752
    s_add_u32 s60, s95, 57344
    buffer_load_dwordx4 v[132:135], v3, s[32:35], s60 offen sc1
    v_mfma_f32_16x16x32_bf16 v[80:83], v[32:35], v[216:219], v[80:83]
    s_waitcnt lgkmcnt(10)
    ds_read_b64_tr_b16 v[32:33], v9 offset:14464
    ds_read_b64_tr_b16 v[34:35], v9 offset:18048
    v_mfma_f32_16x16x32_bf16 v[76:79], v[36:39], v[220:223], v[76:79]
    s_waitcnt lgkmcnt(10)
    ds_read_b64_tr_b16 v[36:37], v9 offset:14496
    ds_read_b64_tr_b16 v[38:39], v9 offset:18080
    v_mfma_f32_16x16x32_bf16 v[80:83], v[40:43], v[220:223], v[80:83]
    s_waitcnt lgkmcnt(10)
    ds_read_b64_tr_b16 v[40:41], v9 offset:43136
    ds_read_b64_tr_b16 v[42:43], v9 offset:46720
    s_add_u32 s60, s95, 3072
    buffer_load_dwordx4 v[136:139], v3, s[32:35], s60 offen sc1
    v_mfma_f32_16x16x32_bf16 v[76:79], v[44:47], v[224:227], v[76:79]
    s_waitcnt lgkmcnt(10)
    ds_read_b64_tr_b16 v[44:45], v9 offset:43168
    ds_read_b64_tr_b16 v[46:47], v9 offset:46752
    v_mfma_f32_16x16x32_bf16 v[80:83], v[48:51], v[224:227], v[80:83]
    s_waitcnt lgkmcnt(10)
    ds_read_b64_tr_b16 v[48:49], v8 offset:21632
    ds_read_b64_tr_b16 v[50:51], v8 offset:25216
    v_mfma_f32_16x16x32_bf16 v[76:79], v[52:55], v[228:231], v[76:79]
    s_waitcnt lgkmcnt(10)
    ds_read_b64_tr_b16 v[52:53], v8 offset:21664
    ds_read_b64_tr_b16 v[54:55], v8 offset:25248
    v_mfma_f32_16x16x32_bf16 v[80:83], v[56:59], v[228:231], v[80:83]
    s_waitcnt lgkmcnt(10)
    ds_read_b64_tr_b16 v[56:57], v8 offset:50304
    ds_read_b64_tr_b16 v[58:59], v8 offset:53888
    s_add_u32 s60, s95, 60416
    buffer_load_dwordx4 v[140:143], v3, s[32:35], s60 offen sc1
    v_mfma_f32_16x16x32_bf16 v[76:79], v[32:35], v[232:235], v[76:79]
    s_waitcnt lgkmcnt(10)
    ds_read_b64_tr_b16 v[32:33], v8 offset:50336
    ds_read_b64_tr_b16 v[34:35], v8 offset:53920
    v_mfma_f32_16x16x32_bf16 v[80:83], v[36:39], v[232:235], v[80:83]
    s_waitcnt lgkmcnt(10)
    ds_read_b64_tr_b16 v[36:37], v9 offset:21632
    ds_read_b64_tr_b16 v[38:39], v9 offset:25216
    v_mfma_f32_16x16x32_bf16 v[76:79], v[40:43], v[236:239], v[76:79]
    s_waitcnt lgkmcnt(10)
    ds_read_b64_tr_b16 v[40:41], v9 offset:21664
    ds_read_b64_tr_b16 v[42:43], v9 offset:25248
    v_mfma_f32_16x16x32_bf16 v[80:83], v[44:47], v[236:239], v[80:83]
    s_waitcnt lgkmcnt(10)
    ds_read_b64_tr_b16 v[44:45], v9 offset:50304
    ds_read_b64_tr_b16 v[46:47], v9 offset:53888
    s_add_u32 s60, s95, 7168
    buffer_load_dwordx4 v[144:147], v3, s[32:35], s60 offen sc1
    v_mfma_f32_16x16x32_bf16 v[76:79], v[48:51], v[240:243], v[76:79]
    s_waitcnt lgkmcnt(10)
    ds_read_b64_tr_b16 v[48:49], v9 offset:50336
    ds_read_b64_tr_b16 v[50:51], v9 offset:53920
    v_mfma_f32_16x16x32_bf16 v[80:83], v[52:55], v[240:243], v[80:83]
    s_waitcnt lgkmcnt(10)
    ds_read_b64_tr_b16 v[52:53], v8 offset:192
    ds_read_b64_tr_b16 v[54:55], v8 offset:3776
    v_mfma_f32_16x16x32_bf16 v[76:79], v[56:59], v[244:247], v[76:79]
    s_waitcnt lgkmcnt(10)
    ds_read_b64_tr_b16 v[56:57], v8 offset:28864
    ds_read_b64_tr_b16 v[58:59], v8 offset:32448
    v_mfma_f32_16x16x32_bf16 v[80:83], v[32:35], v[244:247], v[80:83]
    s_waitcnt lgkmcnt(10)
    ds_read_b64_tr_b16 v[32:33], v9 offset:192
    ds_read_b64_tr_b16 v[34:35], v9 offset:3776
    s_add_u32 s60, s95, 64512
    buffer_load_dwordx4 v[148:151], v3, s[32:35], s60 offen sc1
    v_mfma_f32_16x16x32_bf16 v[76:79], v[36:39], v[248:251], v[76:79]
    s_waitcnt lgkmcnt(10)
    ds_read_b64_tr_b16 v[36:37], v9 offset:28864
    ds_read_b64_tr_b16 v[38:39], v9 offset:32448
    v_mfma_f32_16x16x32_bf16 v[80:83], v[40:43], v[248:251], v[80:83]
    s_waitcnt lgkmcnt(10)
    ds_read_b64_tr_b16 v[40:41], v8 offset:7360
    ds_read_b64_tr_b16 v[42:43], v8 offset:10944
    v_mfma_f32_16x16x32_bf16 v[76:79], v[44:47], v[252:255], v[76:79]
    s_waitcnt lgkmcnt(10)
    ds_read_b64_tr_b16 v[44:45], v8 offset:36032
    ds_read_b64_tr_b16 v[46:47], v8 offset:39616
    v_mfma_f32_16x16x32_bf16 v[80:83], v[48:51], v[252:255], v[80:83]
    s_waitcnt lgkmcnt(10)
    ds_read_b64_tr_b16 v[48:49], v9 offset:7360
    ds_read_b64_tr_b16 v[50:51], v9 offset:10944
    s_add_u32 s60, s95, 10240
    buffer_load_dwordx4 v[152:155], v3, s[32:35], s60 offen sc1
    v_pk_fma_f32 v[120:121], v[104:105], v[30:31], v[108:109]
    v_pk_fma_f32 v[122:123], v[106:107], v[30:31], v[110:111]
    v_pk_fma_f32 v[124:125], v[112:113], v[30:31], v[116:117]
    v_pk_fma_f32 v[126:127], v[114:115], v[30:31], v[118:119]
    ds_read_b128 v[104:107], v11 offset:7552
    ds_read_b128 v[108:111], v11 offset:8000
    v_pk_fma_f32 v[76:77], v[76:77], v[26:27], v[120:121]
    v_pk_fma_f32 v[78:79], v[78:79], v[26:27], v[122:123]
    v_pk_fma_f32 v[80:81], v[80:81], v[26:27], v[124:125]
    v_pk_fma_f32 v[82:83], v[82:83], v[26:27], v[126:127]
    v_pk_mul_f32 v[120:121], v[76:77], v[76:77]
    v_pk_mul_f32 v[122:123], v[78:79], v[78:79]
    v_pk_mul_f32 v[124:125], v[80:81], v[80:81]
    v_pk_mul_f32 v[126:127], v[82:83], v[82:83]
    s_add_u32 s60, s95, 67584
    buffer_load_dwordx4 v[156:159], v3, s[32:35], s60 offen sc1
    v_pk_fma_f32 v[120:121], v[120:121], v[22:23], v[20:21]
    v_pk_fma_f32 v[122:123], v[122:123], v[22:23], v[20:21]
    v_pk_fma_f32 v[124:125], v[124:125], v[22:23], v[20:21]
    v_pk_fma_f32 v[126:127], v[126:127], v[22:23], v[20:21]
    v_pk_mul_f32 v[120:121], v[120:121], v[76:77]
    v_pk_mul_f32 v[122:123], v[122:123], v[78:79]
    v_pk_mul_f32 v[124:125], v[124:125], v[80:81]
    v_pk_mul_f32 v[126:127], v[126:127], v[82:83]
    v_exp_f32 v120, v120
    v_exp_f32 v121, v121
    v_exp_f32 v122, v122
    v_exp_f32 v123, v123
    v_exp_f32 v124, v124
    v_exp_f32 v125, v125
    v_exp_f32 v126, v126
    v_exp_f32 v127, v127
    s_add_u32 s60, s95, 1024
    buffer_load_dwordx4 v[160:163], v3, s[32:35], s60 offen sc1
    v_pk_add_f32 v[120:121], v[120:121], v[24:25]
    v_pk_add_f32 v[122:123], v[122:123], v[24:25]
    v_pk_add_f32 v[124:125], v[124:125], v[24:25]
    v_pk_add_f32 v[126:127], v[126:127], v[24:25]
    s_add_u32 s60, s95, 58368
    buffer_load_dwordx4 v[164:167], v3, s[32:35], s60 offen sc1
    v_rcp_f32 v120, v120
    v_rcp_f32 v121, v121
    v_rcp_f32 v122, v122
    v_rcp_f32 v123, v123
    v_rcp_f32 v124, v124
    v_rcp_f32 v125, v125
    v_rcp_f32 v126, v126
    v_rcp_f32 v127, v127
    v_pk_mul_f32 v[76:77], v[76:77], v[120:121]
    v_pk_mul_f32 v[78:79], v[78:79], v[122:123]
    v_pk_mul_f32 v[80:81], v[80:81], v[124:125]
    v_pk_mul_f32 v[82:83], v[82:83], v[126:127]
    v_cvt_pk_bf16_f32 v76, v76, v77
    v_cvt_pk_bf16_f32 v77, v78, v79
    v_cvt_pk_bf16_f32 v78, v80, v81
    v_cvt_pk_bf16_f32 v79, v82, v83
    buffer_store_dwordx4 v[76:79], v3, s[32:35], s11 offen offset:2048 sc1
    s_add_u32 s60, s95, 4096
    buffer_load_dwordx4 v[168:171], v3, s[32:35], s60 offen sc1
    s_add_u32 s60, s95, 61440
    buffer_load_dwordx4 v[172:175], v3, s[32:35], s60 offen sc1
    v_mfma_f32_16x16x32_bf16 v[84:87], v[52:55], v[192:195], 0
    s_waitcnt lgkmcnt(12)
    ds_read_b64_tr_b16 v[52:53], v9 offset:36032
    ds_read_b64_tr_b16 v[54:55], v9 offset:39616
    v_mfma_f32_16x16x32_bf16 v[88:91], v[56:59], v[196:199], 0
    s_waitcnt lgkmcnt(12)
    ds_read_b64_tr_b16 v[56:57], v8 offset:14528
    ds_read_b64_tr_b16 v[58:59], v8 offset:18112
    v_mfma_f32_16x16x32_bf16 v[84:87], v[32:35], v[200:203], v[84:87]
    s_waitcnt lgkmcnt(12)
    ds_read_b64_tr_b16 v[32:33], v8 offset:43200
    ds_read_b64_tr_b16 v[34:35], v8 offset:46784
    v_mfma_f32_16x16x32_bf16 v[88:91], v[36:39], v[204:207], v[88:91]
    s_waitcnt lgkmcnt(12)
    ds_read_b64_tr_b16 v[36:37], v9 offset:14528
    ds_read_b64_tr_b16 v[38:39], v9 offset:18112
    s_add_u32 s60, s95, 8192
    buffer_load_dwordx4 v[176:179], v3, s[32:35], s60 offen sc1
    v_mfma_f32_16x16x32_bf16 v[84:87], v[40:43], v[208:211], v[84:87]
    s_waitcnt lgkmcnt(12)
    ds_read_b64_tr_b16 v[40:41], v9 offset:43200
    ds_read_b64_tr_b16 v[42:43], v9 offset:46784
    v_mfma_f32_16x16x32_bf16 v[88:91], v[44:47], v[212:215], v[88:91]
    s_waitcnt lgkmcnt(12)
    ds_read_b64_tr_b16 v[44:45], v8 offset:21696
    ds_read_b64_tr_b16 v[46:47], v8 offset:25280
    v_mfma_f32_16x16x32_bf16 v[84:87], v[48:51], v[216:219], v[84:87]
    s_waitcnt lgkmcnt(10)
    ds_read_b64_tr_b16 v[48:49], v8 offset:50368
    ds_read_b64_tr_b16 v[50:51], v8 offset:53952
    v_mfma_f32_16x16x32_bf16 v[88:91], v[52:55], v[220:223], v[88:91]
    s_waitcnt lgkmcnt(10)
    ds_read_b64_tr_b16 v[52:53], v9 offset:21696
    ds_read_b64_tr_b16 v[54:55], v9 offset:25280
    s_add_u32 s60, s95, 65536
    buffer_load_dwordx4 v[180:183], v3, s[32:35], s60 offen sc1
    v_mfma_f32_16x16x32_bf16 v[84:87], v[56:59], v[224:227], v[84:87]
    s_waitcnt lgkmcnt(10)
    ds_read_b64_tr_b16 v[56:57], v9 offset:50368
    ds_read_b64_tr_b16 v[58:59], v9 offset:53952
    v_mfma_f32_16x16x32_bf16 v[88:91], v[32:35], v[228:231], v[88:91]
    s_waitcnt lgkmcnt(10)
    v_mfma_f32_16x16x32_bf16 v[84:87], v[36:39], v[232:235], v[84:87]
    s_waitcnt lgkmcnt(8)
    v_mfma_f32_16x16x32_bf16 v[88:91], v[40:43], v[236:239], v[88:91]
    s_waitcnt lgkmcnt(6)
    s_add_u32 s60, s95, 11264
    buffer_load_dwordx4 v[184:187], v3, s[32:35], s60 offen sc1
    v_mfma_f32_16x16x32_bf16 v[84:87], v[44:47], v[240:243], v[84:87]
    s_waitcnt lgkmcnt(4)
    v_mfma_f32_16x16x32_bf16 v[88:91], v[48:51], v[244:247], v[88:91]
    s_waitcnt lgkmcnt(2)
    v_mfma_f32_16x16x32_bf16 v[84:87], v[52:55], v[248:251], v[84:87]
    s_waitcnt lgkmcnt(0)
    v_mfma_f32_16x16x32_bf16 v[88:91], v[56:59], v[252:255], v[88:91]
    s_add_u32 s60, s95, 68608
    buffer_load_dwordx4 v[188:191], v3, s[32:35], s60 offen sc1
    v_pk_fma_f32 v[120:121], v[104:105], v[30:31], v[108:109]
    v_pk_fma_f32 v[122:123], v[106:107], v[30:31], v[110:111]
    s_nop 3
    v_pk_add_f32 v[84:85], v[84:85], v[88:89]
    v_pk_add_f32 v[86:87], v[86:87], v[90:91]
    v_pk_fma_f32 v[84:85], v[84:85], v[26:27], v[120:121]
    v_pk_fma_f32 v[86:87], v[86:87], v[26:27], v[122:123]
    v_pk_mul_f32 v[120:121], v[84:85], v[84:85]
    v_pk_mul_f32 v[122:123], v[86:87], v[86:87]
    v_pk_fma_f32 v[120:121], v[120:121], v[22:23], v[20:21]
    v_pk_fma_f32 v[122:123], v[122:123], v[22:23], v[20:21]
    v_pk_mul_f32 v[120:121], v[120:121], v[84:85]
    v_pk_mul_f32 v[122:123], v[122:123], v[86:87]
    v_exp_f32 v120, v120
    v_exp_f32 v121, v121
    v_exp_f32 v122, v122
    v_exp_f32 v123, v123
    v_pk_add_f32 v[120:121], v[120:121], v[24:25]
    v_pk_add_f32 v[122:123], v[122:123], v[24:25]
    v_rcp_f32 v120, v120
    v_rcp_f32 v121, v121
    v_rcp_f32 v122, v122
    v_rcp_f32 v123, v123
    v_pk_mul_f32 v[84:85], v[84:85], v[120:121]
    v_pk_mul_f32 v[86:87], v[86:87], v[122:123]
    v_cvt_pk_bf16_f32 v84, v84, v85
    v_cvt_pk_bf16_f32 v85, v86, v87
    buffer_store_dwordx2 v[84:85], v16, s[32:35], s12 offen sc1
    s_add_u32 s60, s95, 2048
    buffer_load_dwordx4 a[96:99], v3, s[32:35], s60 offen sc1
    s_add_u32 s60, s95, 59392
    buffer_load_dwordx4 a[100:103], v3, s[32:35], s60 offen sc1
    v_add_u32 v8, s4, v3
    s_and_b32 s62, s3, 1
    s_lshr_b32 s63, s3, 1
    s_lshl_b32 s59, s62, 12
    s_lshl_b32 s61, s63, 11
    s_add_u32 s59, s59, s61
    s_add_u32 s59, s59, 114688
    v_add_u32 v9, s59, v3
    s_lshl_b32 s59, s54, 1
    s_add_u32 s59, s59, s56
    s_lshl_b32 s59, s59, 1
    s_add_u32 s59, s59, s62
    s_lshl_b32 s61, s55, 1
    s_add_u32 s61, s61, s63
    s_lshl_b32 s59, s59, 14
    s_lshl_b32 s63, s61, 10
    s_add_u32 s62, s59, s63
    s_add_u32 s13, s62, 6291456
    s_lshl_b32 s61, s61, 6
    s_add_u32 s5, s59, s61
    s_mov_b32 s40, s26
    s_mov_b32 s41, s27
    s_mov_b32 s42, 2097152
    s_mov_b32 s43, 0x00020000
    s_mov_b32 s44, s24
    s_mov_b32 s45, s25
    s_mov_b32 s46, 1024
    s_mov_b32 s47, 0x00020000
    v_lshlrev_b32 v10, 3, v2
    buffer_load_dwordx2 v[100:101], v10, s[44:47], s61 offen offset:0
    buffer_load_dwordx2 v[102:103], v10, s[44:47], s61 offen offset:32
    v_and_b32 v18, 8, v1
    v_and_b32 v19, 7, v1
    v_lshl_add_u32 v18, v19, 4, v18
    v_lshl_add_u32 v17, v2, 7, v18
    v_and_b32 v11, 1, v2
    v_lshlrev_b32 v11, 5, v11
    v_lshrrev_b32 v12, 1, v2
    v_lshl_add_u32 v11, v12, 4, v11
    v_lshl_add_u32 v11, v1, 10, v11
    s_waitcnt vmcnt(20)
    v_mfma_f32_16x16x32_bf16 v[32:35], a[128:131], v[128:131], 0
    s_add_u32 s60, s95, 5120
    buffer_load_dwordx4 a[104:107], v3, s[32:35], s60 offen sc1
    v_mfma_f32_16x16x32_bf16 v[48:51], a[128:131], v[132:135], 0
    v_mfma_f32_16x16x32_bf16 v[36:39], a[132:135], v[128:131], 0
    v_mfma_f32_16x16x32_bf16 v[52:55], a[132:135], v[132:135], 0
    v_mfma_f32_16x16x32_bf16 v[40:43], a[136:139], v[128:131], 0
    s_add_u32 s60, s95, 62464
    buffer_load_dwordx4 a[108:111], v3, s[32:35], s60 offen sc1
    v_mfma_f32_16x16x32_bf16 v[56:59], a[136:139], v[132:135], 0
    v_mfma_f32_16x16x32_bf16 v[44:47], a[140:143], v[128:131], 0
    v_mfma_f32_16x16x32_bf16 v[60:63], a[140:143], v[132:135], 0
    s_waitcnt vmcnt(20)
    v_mfma_f32_16x16x32_bf16 v[32:35], a[144:147], v[136:139], v[32:35]
    s_add_u32 s60, s95, 9216
    buffer_load_dwordx4 a[112:115], v3, s[32:35], s60 offen sc1
    v_mfma_f32_16x16x32_bf16 v[48:51], a[144:147], v[140:143], v[48:51]
    v_mfma_f32_16x16x32_bf16 v[36:39], a[148:151], v[136:139], v[36:39]
    v_mfma_f32_16x16x32_bf16 v[52:55], a[148:151], v[140:143], v[52:55]
    v_mfma_f32_16x16x32_bf16 v[40:43], a[152:155], v[136:139], v[40:43]
    s_add_u32 s60, s95, 66560
    buffer_load_dwordx4 a[116:119], v3, s[32:35], s60 offen sc1
    v_mfma_f32_16x16x32_bf16 v[56:59], a[152:155], v[140:143], v[56:59]
    v_mfma_f32_16x16x32_bf16 v[44:47], a[156:159], v[136:139], v[44:47]
    v_mfma_f32_16x16x32_bf16 v[60:63], a[156:159], v[140:143], v[60:63]
    s_waitcnt vmcnt(20)
    v_mfma_f32_16x16x32_bf16 v[32:35], a[160:163], v[144:147], v[32:35]
    s_add_u32 s60, s95, 12288
    buffer_load_dwordx4 a[120:123], v3, s[32:35], s60 offen sc1
    v_mfma_f32_16x16x32_bf16 v[48:51], a[160:163], v[148:151], v[48:51]
    v_mfma_f32_16x16x32_bf16 v[36:39], a[164:167], v[144:147], v[36:39]
    v_mfma_f32_16x16x32_bf16 v[52:55], a[164:167], v[148:151], v[52:55]
    v_mfma_f32_16x16x32_bf16 v[40:43], a[168:171], v[144:147], v[40:43]
    s_add_u32 s60, s95, 69632
    buffer_load_dwordx4 a[124:127], v3, s[32:35], s60 offen sc1
    v_mfma_f32_16x16x32_bf16 v[56:59], a[168:171], v[148:151], v[56:59]
    v_mfma_f32_16x16x32_bf16 v[44:47], a[172:175], v[144:147], v[44:47]
    v_mfma_f32_16x16x32_bf16 v[60:63], a[172:175], v[148:151], v[60:63]
    s_waitcnt vmcnt(20)
    v_mfma_f32_16x16x32_bf16 v[32:35], a[176:179], v[152:155], v[32:35]
    s_add_u32 s60, s95, 6144
    buffer_load_dwordx2 v[192:193], v16, s[32:35], s60 offen offset:0 sc1
    buffer_load_dwordx2 v[194:195], v16, s[32:35], s60 offen offset:512 sc1
    v_mfma_f32_16x16x32_bf16 v[48:51], a[176:179], v[156:159], v[48:51]
    v_mfma_f32_16x16x32_bf16 v[36:39], a[180:183], v[152:155], v[36:39]
    v_mfma_f32_16x16x32_bf16 v[52:55], a[180:183], v[156:159], v[52:55]
    v_mfma_f32_16x16x32_bf16 v[40:43], a[184:187], v[152:155], v[40:43]
    s_add_u32 s60, s95, 63488
    buffer_load_dwordx2 v[196:197], v16, s[32:35], s60 offen offset:0 sc1
    buffer_load_dwordx2 v[198:199], v16, s[32:35], s60 offen offset:512 sc1
    v_mfma_f32_16x16x32_bf16 v[56:59], a[184:187], v[156:159], v[56:59]
    v_mfma_f32_16x16x32_bf16 v[44:47], a[188:191], v[152:155], v[44:47]
    v_mfma_f32_16x16x32_bf16 v[60:63], a[188:191], v[156:159], v[60:63]
    s_waitcnt vmcnt(22)
    v_mfma_f32_16x16x32_bf16 v[32:35], a[192:195], v[160:163], v[32:35]
    s_add_u32 s60, s95, 13312
    buffer_load_dwordx2 v[200:201], v16, s[32:35], s60 offen offset:0 sc1
    buffer_load_dwordx2 v[202:203], v16, s[32:35], s60 offen offset:512 sc1
    v_mfma_f32_16x16x32_bf16 v[48:51], a[192:195], v[164:167], v[48:51]
    v_mfma_f32_16x16x32_bf16 v[36:39], a[196:199], v[160:163], v[36:39]
    v_mfma_f32_16x16x32_bf16 v[52:55], a[196:199], v[164:167], v[52:55]
    v_mfma_f32_16x16x32_bf16 v[40:43], a[200:203], v[160:163], v[40:43]
    s_add_u32 s60, s95, 70656
    buffer_load_dwordx2 v[204:205], v16, s[32:35], s60 offen offset:0 sc1
    buffer_load_dwordx2 v[206:207], v16, s[32:35], s60 offen offset:512 sc1
    v_mfma_f32_16x16x32_bf16 v[56:59], a[200:203], v[164:167], v[56:59]
    v_mfma_f32_16x16x32_bf16 v[44:47], a[204:207], v[160:163], v[44:47]
    v_mfma_f32_16x16x32_bf16 v[60:63], a[204:207], v[164:167], v[60:63]
    s_waitcnt vmcnt(23)
    v_mfma_f32_16x16x32_bf16 v[32:35], a[208:211], v[168:171], v[32:35]
    s_nop 0
    buffer_load_dwordx2 v[96:97], v17, s[32:35], s13 offen offset:0 sc1
    buffer_load_dwordx2 v[98:99], v17, s[32:35], s13 offen offset:512 sc1
    v_mfma_f32_16x16x32_bf16 v[48:51], a[208:211], v[172:175], v[48:51]
    v_mfma_f32_16x16x32_bf16 v[36:39], a[212:215], v[168:171], v[36:39]
    v_mfma_f32_16x16x32_bf16 v[52:55], a[212:215], v[172:175], v[52:55]
    v_mfma_f32_16x16x32_bf16 v[40:43], a[216:219], v[168:171], v[40:43]
    s_add_u32 s60, s95, 3670016
    buffer_load_dwordx4 v[208:211], v3, s[32:35], s60 offen sc1
    v_mfma_f32_16x16x32_bf16 v[56:59], a[216:219], v[172:175], v[56:59]
    v_mfma_f32_16x16x32_bf16 v[44:47], a[220:223], v[168:171], v[44:47]
    v_mfma_f32_16x16x32_bf16 v[60:63], a[220:223], v[172:175], v[60:63]
    s_waitcnt vmcnt(24)
    v_mfma_f32_16x16x32_bf16 v[32:35], a[224:227], v[176:179], v[32:35]
    s_add_u32 s60, s95, 3727360
    buffer_load_dwordx4 v[212:215], v3, s[32:35], s60 offen sc1
    v_mfma_f32_16x16x32_bf16 v[48:51], a[224:227], v[180:183], v[48:51]
    v_mfma_f32_16x16x32_bf16 v[36:39], a[228:231], v[176:179], v[36:39]
    v_mfma_f32_16x16x32_bf16 v[52:55], a[228:231], v[180:183], v[52:55]
    v_mfma_f32_16x16x32_bf16 v[40:43], a[232:235], v[176:179], v[40:43]
    s_add_u32 s60, s95, 3673088
    buffer_load_dwordx4 v[216:219], v3, s[32:35], s60 offen sc1
    v_mfma_f32_16x16x32_bf16 v[56:59], a[232:235], v[180:183], v[56:59]
    v_mfma_f32_16x16x32_bf16 v[44:47], a[236:239], v[176:179], v[44:47]
    v_mfma_f32_16x16x32_bf16 v[60:63], a[236:239], v[180:183], v[60:63]
    s_waitcnt vmcnt(24)
    v_mfma_f32_16x16x32_bf16 v[32:35], a[240:243], v[184:187], v[32:35]
    s_add_u32 s60, s95, 3730432
    buffer_load_dwordx4 v[220:223], v3, s[32:35], s60 offen sc1
    v_mfma_f32_16x16x32_bf16 v[48:51], a[240:243], v[188:191], v[48:51]
    v_mfma_f32_16x16x32_bf16 v[36:39], a[244:247], v[184:187], v[36:39]
    v_mfma_f32_16x16x32_bf16 v[52:55], a[244:247], v[188:191], v[52:55]
    v_mfma_f32_16x16x32_bf16 v[40:43], a[248:251], v[184:187], v[40:43]
    s_add_u32 s60, s95, 3677184
    buffer_load_dwordx4 v[224:227], v3, s[32:35], s60 offen sc1
    v_mfma_f32_16x16x32_bf16 v[56:59], a[248:251], v[188:191], v[56:59]
    v_mfma_f32_16x16x32_bf16 v[44:47], a[252:255], v[184:187], v[44:47]
    v_mfma_f32_16x16x32_bf16 v[60:63], a[252:255], v[188:191], v[60:63]
    s_waitcnt vmcnt(23)
    v_mfma_f32_16x16x32_bf16 v[32:35], a[0:3], a[96:99], v[32:35]
    s_add_u32 s60, s95, 3734528
    buffer_load_dwordx4 v[228:231], v3, s[32:35], s60 offen sc1
    v_mfma_f32_16x16x32_bf16 v[48:51], a[0:3], a[100:103], v[48:51]
    v_mfma_f32_16x16x32_bf16 v[36:39], a[4:7], a[96:99], v[36:39]
    v_mfma_f32_16x16x32_bf16 v[52:55], a[4:7], a[100:103], v[52:55]
    v_mfma_f32_16x16x32_bf16 v[40:43], a[8:11], a[96:99], v[40:43]
    s_add_u32 s60, s95, 3680256
    buffer_load_dwordx4 v[232:235], v3, s[32:35], s60 offen sc1
    v_mfma_f32_16x16x32_bf16 v[56:59], a[8:11], a[100:103], v[56:59]
    v_mfma_f32_16x16x32_bf16 v[44:47], a[12:15], a[96:99], v[44:47]
    v_mfma_f32_16x16x32_bf16 v[60:63], a[12:15], a[100:103], v[60:63]
    s_waitcnt vmcnt(21)
    v_mfma_f32_16x16x32_bf16 v[32:35], a[16:19], a[104:107], v[32:35]
    s_add_u32 s60, s95, 3737600
    buffer_load_dwordx4 v[236:239], v3, s[32:35], s60 offen sc1
    v_mfma_f32_16x16x32_bf16 v[48:51], a[16:19], a[108:111], v[48:51]
    v_mfma_f32_16x16x32_bf16 v[36:39], a[20:23], a[104:107], v[36:39]
    v_mfma_f32_16x16x32_bf16 v[52:55], a[20:23], a[108:111], v[52:55]
    v_mfma_f32_16x16x32_bf16 v[40:43], a[24:27], a[104:107], v[40:43]
    s_add_u32 s60, s95, 3671040
    buffer_load_dwordx4 v[128:131], v3, s[32:35], s60 offen sc1
    v_mfma_f32_16x16x32_bf16 v[56:59], a[24:27], a[108:111], v[56:59]
    v_mfma_f32_16x16x32_bf16 v[44:47], a[28:31], a[104:107], v[44:47]
    v_mfma_f32_16x16x32_bf16 v[60:63], a[28:31], a[108:111], v[60:63]
    s_waitcnt vmcnt(21)
    v_mfma_f32_16x16x32_bf16 v[32:35], a[32:35], a[112:115], v[32:35]
    s_add_u32 s60, s95, 3728384
    buffer_load_dwordx4 v[132:135], v3, s[32:35], s60 offen sc1
    v_mfma_f32_16x16x32_bf16 v[48:51], a[32:35], a[116:119], v[48:51]
    v_mfma_f32_16x16x32_bf16 v[36:39], a[36:39], a[112:115], v[36:39]
    v_mfma_f32_16x16x32_bf16 v[52:55], a[36:39], a[116:119], v[52:55]
    v_mfma_f32_16x16x32_bf16 v[40:43], a[40:43], a[112:115], v[40:43]
    s_add_u32 s60, s95, 3674112
    buffer_load_dwordx4 v[136:139], v3, s[32:35], s60 offen sc1
    v_mfma_f32_16x16x32_bf16 v[56:59], a[40:43], a[116:119], v[56:59]
    v_mfma_f32_16x16x32_bf16 v[44:47], a[44:47], a[112:115], v[44:47]
    v_mfma_f32_16x16x32_bf16 v[60:63], a[44:47], a[116:119], v[60:63]
    s_waitcnt vmcnt(21)
    v_mfma_f32_16x16x32_bf16 v[32:35], a[48:51], a[120:123], v[32:35]
    s_add_u32 s60, s95, 3731456
    buffer_load_dwordx4 v[140:143], v3, s[32:35], s60 offen sc1
    v_mfma_f32_16x16x32_bf16 v[48:51], a[48:51], a[124:127], v[48:51]
    v_mfma_f32_16x16x32_bf16 v[36:39], a[52:55], a[120:123], v[36:39]
    v_mfma_f32_16x16x32_bf16 v[52:55], a[52:55], a[124:127], v[52:55]
    v_mfma_f32_16x16x32_bf16 v[40:43], a[56:59], a[120:123], v[40:43]
    s_add_u32 s60, s95, 3678208
    buffer_load_dwordx4 v[144:147], v3, s[32:35], s60 offen sc1
    v_mfma_f32_16x16x32_bf16 v[56:59], a[56:59], a[124:127], v[56:59]
    v_mfma_f32_16x16x32_bf16 v[44:47], a[60:63], a[120:123], v[44:47]
    v_mfma_f32_16x16x32_bf16 v[60:63], a[60:63], a[124:127], v[60:63]
    s_waitcnt vmcnt(19)
    v_mfma_f32_16x16x32_bf16 v[32:35], a[64:67], v[192:195], v[32:35]
    s_add_u32 s60, s95, 3735552
    buffer_load_dwordx4 v[148:151], v3, s[32:35], s60 offen sc1
    v_mfma_f32_16x16x32_bf16 v[48:51], a[64:67], v[196:199], v[48:51]
    v_mfma_f32_16x16x32_bf16 v[36:39], a[68:71], v[192:195], v[36:39]
    v_mfma_f32_16x16x32_bf16 v[52:55], a[68:71], v[196:199], v[52:55]
    v_mfma_f32_16x16x32_bf16 v[40:43], a[72:75], v[192:195], v[40:43]
    s_add_u32 s60, s95, 3681280
    buffer_load_dwordx4 v[152:155], v3, s[32:35], s60 offen sc1
    v_mfma_f32_16x16x32_bf16 v[56:59], a[72:75], v[196:199], v[56:59]
    v_lshlrev_b32 v104, 16, v100
    v_mfma_f32_16x16x32_bf16 v[44:47], a[76:79], v[192:195], v[44:47]
    v_and_b32 v105, s65, v100
    v_mfma_f32_16x16x32_bf16 v[60:63], a[76:79], v[196:199], v[60:63]
    s_waitcnt vmcnt(17)
    v_lshlrev_b32 v106, 16, v101
    v_mfma_f32_16x16x32_bf16 v[32:35], a[80:83], v[200:203], v[32:35]
    s_add_u32 s60, s95, 3738624
    buffer_load_dwordx4 v[156:159], v3, s[32:35], s60 offen sc1
    v_and_b32 v107, s65, v101
    v_mfma_f32_16x16x32_bf16 v[48:51], a[80:83], v[204:207], v[48:51]
    v_lshlrev_b32 v108, 16, v102
    v_mfma_f32_16x16x32_bf16 v[36:39], a[84:87], v[200:203], v[36:39]
    v_and_b32 v109, s65, v102
    v_mfma_f32_16x16x32_bf16 v[52:55], a[84:87], v[204:207], v[52:55]
    v_lshlrev_b32 v110, 16, v103
    v_mfma_f32_16x16x32_bf16 v[40:43], a[88:91], v[200:203], v[40:43]
    s_add_u32 s60, s95, 3672064
    buffer_load_dwordx4 v[160:163], v3, s[32:35], s60 offen sc1
    v_and_b32 v111, s65, v103
    v_mfma_f32_16x16x32_bf16 v[56:59], a[88:91], v[204:207], v[56:59]
    s_add_u32 s13, s13, 0x100000
    buffer_load_dwordx2 v[100:101], v17, s[32:35], s13 offen offset:0 sc1
    buffer_load_dwordx2 v[102:103], v17, s[32:35], s13 offen offset:512 sc1
    v_mfma_f32_16x16x32_bf16 v[44:47], a[92:95], v[200:203], v[44:47]
    v_mfma_f32_16x16x32_bf16 v[60:63], a[92:95], v[204:207], v[60:63]
    s_nop 0
    ds_write_b128 v8, v[32:35] offset:0
    ds_write_b128 v8, v[36:39] offset:1024
    ds_write_b128 v8, v[40:43] offset:2048
    s_nop 2
    ds_write_b128 v8, v[44:47] offset:3072
    ds_write_b128 v8, v[48:51] offset:4096
    ds_write_b128 v8, v[52:55] offset:5120
    ds_write_b128 v8, v[56:59] offset:6144
    ds_write_b128 v8, v[60:63] offset:7168
    s_waitcnt vmcnt(11)
    v_max3_u32 v14, v208, v212, v216
    v_max3_u32 v14, v14, v220, v224
    v_max3_u32 v14, v14, v228, v232
    v_max_u32 v14, v14, v236
    v_cmp_eq_u32 vcc, -1, v14
    s_cbranch_vccnz RTD_35
BKD_36:
    v_mfma_f32_16x16x32_bf16 v[64:67], a[128:131], v[208:211], 0
    s_add_u32 s60, s95, 3729408
    buffer_load_dwordx4 v[164:167], v3, s[32:35], s60 offen sc1
    v_lshlrev_b32 v112, 16, v96
    v_mfma_f32_16x16x32_bf16 v[80:83], a[128:131], v[212:215], 0
    v_and_b32 v113, s65, v96
    v_lshlrev_b32 v114, 16, v97
    v_mfma_f32_16x16x32_bf16 v[68:71], a[132:135], v[208:211], 0
    v_and_b32 v115, s65, v97
    v_lshlrev_b32 v116, 16, v98
    v_mfma_f32_16x16x32_bf16 v[84:87], a[132:135], v[212:215], 0
    v_and_b32 v117, s65, v98
    v_lshlrev_b32 v118, 16, v99
    v_mfma_f32_16x16x32_bf16 v[72:75], a[136:139], v[208:211], 0
    s_add_u32 s60, s95, 3675136
    buffer_load_dwordx4 v[168:171], v3, s[32:35], s60 offen sc1
    v_and_b32 v119, s65, v99
    v_add_f32 v112, v112, v104
    v_mfma_f32_16x16x32_bf16 v[88:91], a[136:139], v[212:215], 0
    v_add_f32 v113, v113, v105
    v_add_f32 v114, v114, v106
    v_mfma_f32_16x16x32_bf16 v[76:79], a[140:143], v[208:211], 0
    v_add_f32 v115, v115, v107
    v_add_f32 v116, v116, v108
    v_mfma_f32_16x16x32_bf16 v[92:95], a[140:143], v[212:215], 0
    v_add_f32 v117, v117, v109
    v_add_f32 v118, v118, v110
    v_mfma_f32_16x16x32_bf16 v[64:67], a[144:147], v[216:219], v[64:67]
    s_add_u32 s60, s95, 3732480
    buffer_load_dwordx4 v[172:175], v3, s[32:35], s60 offen sc1
    v_add_f32 v119, v119, v111
    s_waitcnt lgkmcnt(0)
    s_barrier
    v_mfma_f32_16x16x32_bf16 v[80:83], a[144:147], v[220:223], v[80:83]
    s_nop 0
    ds_read_b128 v[32:35], v9 offset:0
    ds_read_b128 v[36:39], v9 offset:1024
    v_mfma_f32_16x16x32_bf16 v[68:71], a[148:151], v[216:219], v[68:71]
    s_nop 0
    ds_read_b128 v[40:43], v9 offset:8448
    ds_read_b128 v[44:47], v9 offset:9472
    v_mfma_f32_16x16x32_bf16 v[84:87], a[148:151], v[220:223], v[84:87]
    s_nop 0
    ds_read_b128 v[48:51], v9 offset:16896
    ds_read_b128 v[52:55], v9 offset:17920
    v_mfma_f32_16x16x32_bf16 v[72:75], a[152:155], v[216:219], v[72:75]
    s_add_u32 s60, s95, 3679232
    buffer_load_dwordx4 v[176:179], v3, s[32:35], s60 offen sc1
    ds_read_b128 v[56:59], v9 offset:25344
    ds_read_b128 v[60:63], v9 offset:26368
    v_mfma_f32_16x16x32_bf16 v[88:91], a[152:155], v[220:223], v[88:91]
    v_mfma_f32_16x16x32_bf16 v[76:79], a[156:159], v[216:219], v[76:79]
    v_mfma_f32_16x16x32_bf16 v[92:95], a[156:159], v[220:223], v[92:95]
    v_mfma_f32_16x16x32_bf16 v[64:67], a[160:163], v[224:227], v[64:67]
    s_add_u32 s60, s95, 3736576
    buffer_load_dwordx4 v[180:183], v3, s[32:35], s60 offen sc1
    v_mfma_f32_16x16x32_bf16 v[80:83], a[160:163], v[228:231], v[80:83]
    s_waitcnt lgkmcnt(6)
    v_add_f32 v112, v112, v32
    v_mfma_f32_16x16x32_bf16 v[68:71], a[164:167], v[224:227], v[68:71]
    v_add_f32 v113, v113, v33
    v_add_f32 v114, v114, v34
    v_mfma_f32_16x16x32_bf16 v[84:87], a[164:167], v[228:231], v[84:87]
    v_add_f32 v115, v115, v35
    v_add_f32 v116, v116, v36
    v_mfma_f32_16x16x32_bf16 v[72:75], a[168:171], v[224:227], v[72:75]
    s_add_u32 s60, s95, 3682304
    buffer_load_dwordx4 v[184:187], v3, s[32:35], s60 offen sc1
    v_add_f32 v117, v117, v37
    v_add_f32 v118, v118, v38
    v_mfma_f32_16x16x32_bf16 v[88:91], a[168:171], v[228:231], v[88:91]
    v_add_f32 v119, v119, v39
    s_waitcnt lgkmcnt(4)
    v_mfma_f32_16x16x32_bf16 v[76:79], a[172:175], v[224:227], v[76:79]
    v_add_f32 v112, v112, v40
    v_add_f32 v113, v113, v41
    v_mfma_f32_16x16x32_bf16 v[92:95], a[172:175], v[228:231], v[92:95]
    v_add_f32 v114, v114, v42
    v_add_f32 v115, v115, v43
    v_mfma_f32_16x16x32_bf16 v[64:67], a[176:179], v[232:235], v[64:67]
    s_add_u32 s60, s95, 3739648
    buffer_load_dwordx4 v[188:191], v3, s[32:35], s60 offen sc1
    v_mfma_f32_16x16x32_bf16 v[80:83], a[176:179], v[236:239], v[80:83]
    v_mfma_f32_16x16x32_bf16 v[68:71], a[180:183], v[232:235], v[68:71]
    v_mfma_f32_16x16x32_bf16 v[84:87], a[180:183], v[236:239], v[84:87]
    v_mfma_f32_16x16x32_bf16 v[72:75], a[184:187], v[232:235], v[72:75]
    s_add_u32 s60, s95, 3676160
    buffer_load_dwordx2 v[240:241], v16, s[32:35], s60 offen offset:0 sc1
    buffer_load_dwordx2 v[242:243], v16, s[32:35], s60 offen offset:512 sc1
    s_waitcnt vmcnt(12)
    v_mfma_f32_16x16x32_bf16 v[88:91], a[184:187], v[236:239], v[88:91]
    v_max3_u32 v14, v128, v132, v136
    v_max3_u32 v14, v14, v140, v144
    v_mfma_f32_16x16x32_bf16 v[76:79], a[188:191], v[232:235], v[76:79]
    v_max3_u32 v14, v14, v148, v152
    v_max_u32 v14, v14, v156
    v_mfma_f32_16x16x32_bf16 v[92:95], a[188:191], v[236:239], v[92:95]
    v_cmp_eq_u32 vcc, -1, v14
    s_cbranch_vccnz RTD_37
BKD_38:
    v_mfma_f32_16x16x32_bf16 v[64:67], a[192:195], v[128:131], v[64:67]
    s_add_u32 s60, s95, 3733504
    buffer_load_dwordx2 v[244:245], v16, s[32:35], s60 offen offset:0 sc1
    buffer_load_dwordx2 v[246:247], v16, s[32:35], s60 offen offset:512 sc1
    v_add_f32 v116, v116, v44
    v_add_f32 v117, v117, v45
    v_mfma_f32_16x16x32_bf16 v[80:83], a[192:195], v[132:135], v[80:83]
    v_add_f32 v118, v118, v46
    v_add_f32 v119, v119, v47
    v_mfma_f32_16x16x32_bf16 v[68:71], a[196:199], v[128:131], v[68:71]
    s_waitcnt lgkmcnt(2)
    v_add_f32 v112, v112, v48
    v_mfma_f32_16x16x32_bf16 v[84:87], a[196:199], v[132:135], v[84:87]
    v_add_f32 v113, v113, v49
    v_add_f32 v114, v114, v50
    v_mfma_f32_16x16x32_bf16 v[72:75], a[200:203], v[128:131], v[72:75]
    s_add_u32 s60, s95, 3683328
    buffer_load_dwordx2 v[248:249], v16, s[32:35], s60 offen offset:0 sc1
    buffer_load_dwordx2 v[250:251], v16, s[32:35], s60 offen offset:512 sc1
    v_add_f32 v115, v115, v51
    v_add_f32 v116, v116, v52
    v_mfma_f32_16x16x32_bf16 v[88:91], a[200:203], v[132:135], v[88:91]
    v_add_f32 v117, v117, v53
    v_add_f32 v118, v118, v54
    v_mfma_f32_16x16x32_bf16 v[76:79], a[204:207], v[128:131], v[76:79]
    v_add_f32 v119, v119, v55
    s_waitcnt lgkmcnt(0)
    v_mfma_f32_16x16x32_bf16 v[92:95], a[204:207], v[132:135], v[92:95]
    v_add_f32 v112, v112, v56
    v_add_f32 v113, v113, v57
    v_mfma_f32_16x16x32_bf16 v[64:67], a[208:211], v[136:139], v[64:67]
    s_add_u32 s60, s95, 3740672
    buffer_load_dwordx2 v[252:253], v16, s[32:35], s60 offen offset:0 sc1
    buffer_load_dwordx2 v[254:255], v16, s[32:35], s60 offen offset:512 sc1
    v_add_f32 v114, v114, v58
    v_add_f32 v115, v115, v59
    v_mfma_f32_16x16x32_bf16 v[80:83], a[208:211], v[140:143], v[80:83]
    v_add_f32 v116, v116, v60
    v_add_f32 v117, v117, v61
    v_mfma_f32_16x16x32_bf16 v[68:71], a[212:215], v[136:139], v[68:71]
    v_add_f32 v118, v118, v62
    v_add_f32 v119, v119, v63
    v_mfma_f32_16x16x32_bf16 v[84:87], a[212:215], v[140:143], v[84:87]
    v_cvt_pk_bf16_f32 v120, v112, v113
    v_cvt_pk_bf16_f32 v121, v114, v115
    v_mfma_f32_16x16x32_bf16 v[72:75], a[216:219], v[136:139], v[72:75]
    v_cvt_pk_bf16_f32 v122, v116, v117
    v_cvt_pk_bf16_f32 v123, v118, v119
    v_mfma_f32_16x16x32_bf16 v[88:91], a[216:219], v[140:143], v[88:91]
    v_mfma_f32_16x16x32_bf16 v[76:79], a[220:223], v[136:139], v[76:79]
    v_permlane16_swap_b32 v120, v122
    v_permlane16_swap_b32 v121, v123
    v_mfma_f32_16x16x32_bf16 v[92:95], a[220:223], v[140:143], v[92:95]
    v_mfma_f32_16x16x32_bf16 v[64:67], a[224:227], v[144:147], v[64:67]
    s_nop 0
    buffer_store_dwordx4 v[120:123], v11, s[40:43], s5 offen sc1
    v_mfma_f32_16x16x32_bf16 v[80:83], a[224:227], v[148:151], v[80:83]
    s_add_u32 s5, s5, 0x100000
    v_subrev_u32 v8, 114688, v8
    v_mfma_f32_16x16x32_bf16 v[68:71], a[228:231], v[144:147], v[68:71]
    v_subrev_u32 v9, 114688, v9
    v_mfma_f32_16x16x32_bf16 v[84:87], a[228:231], v[148:151], v[84:87]
    v_mfma_f32_16x16x32_bf16 v[72:75], a[232:235], v[144:147], v[72:75]
    v_mfma_f32_16x16x32_bf16 v[88:91], a[232:235], v[148:151], v[88:91]
    v_mfma_f32_16x16x32_bf16 v[76:79], a[236:239], v[144:147], v[76:79]
    v_mfma_f32_16x16x32_bf16 v[92:95], a[236:239], v[148:151], v[92:95]
    v_mfma_f32_16x16x32_bf16 v[64:67], a[240:243], v[152:155], v[64:67]
    v_mfma_f32_16x16x32_bf16 v[80:83], a[240:243], v[156:159], v[80:83]
    v_mfma_f32_16x16x32_bf16 v[68:71], a[244:247], v[152:155], v[68:71]
    v_mfma_f32_16x16x32_bf16 v[84:87], a[244:247], v[156:159], v[84:87]
    v_mfma_f32_16x16x32_bf16 v[72:75], a[248:251], v[152:155], v[72:75]
    s_waitcnt vmcnt(9)
    v_mfma_f32_16x16x32_bf16 v[88:91], a[248:251], v[156:159], v[88:91]
    v_max3_u32 v14, v160, v164, v168
    v_max3_u32 v14, v14, v172, v176
    v_mfma_f32_16x16x32_bf16 v[76:79], a[252:255], v[152:155], v[76:79]
    v_max3_u32 v14, v14, v180, v184
    v_max_u32 v14, v14, v188
    v_mfma_f32_16x16x32_bf16 v[92:95], a[252:255], v[156:159], v[92:95]
    v_cmp_eq_u32 vcc, -1, v14
    s_cbranch_vccnz RTD_39
BKD_40:
    v_mfma_f32_16x16x32_bf16 v[64:67], a[0:3], v[160:163], v[64:67]
    v_mfma_f32_16x16x32_bf16 v[80:83], a[0:3], v[164:167], v[80:83]
    v_mfma_f32_16x16x32_bf16 v[68:71], a[4:7], v[160:163], v[68:71]
    v_mfma_f32_16x16x32_bf16 v[84:87], a[4:7], v[164:167], v[84:87]
    v_mfma_f32_16x16x32_bf16 v[72:75], a[8:11], v[160:163], v[72:75]
    v_mfma_f32_16x16x32_bf16 v[88:91], a[8:11], v[164:167], v[88:91]
    v_mfma_f32_16x16x32_bf16 v[76:79], a[12:15], v[160:163], v[76:79]
    v_mfma_f32_16x16x32_bf16 v[92:95], a[12:15], v[164:167], v[92:95]
    v_mfma_f32_16x16x32_bf16 v[64:67], a[16:19], v[168:171], v[64:67]
    v_mfma_f32_16x16x32_bf16 v[80:83], a[16:19], v[172:175], v[80:83]
    v_mfma_f32_16x16x32_bf16 v[68:71], a[20:23], v[168:171], v[68:71]
    v_mfma_f32_16x16x32_bf16 v[84:87], a[20:23], v[172:175], v[84:87]
    v_mfma_f32_16x16x32_bf16 v[72:75], a[24:27], v[168:171], v[72:75]
    v_mfma_f32_16x16x32_bf16 v[88:91], a[24:27], v[172:175], v[88:91]
    v_mfma_f32_16x16x32_bf16 v[76:79], a[28:31], v[168:171], v[76:79]
    v_mfma_f32_16x16x32_bf16 v[92:95], a[28:31], v[172:175], v[92:95]
    v_mfma_f32_16x16x32_bf16 v[64:67], a[32:35], v[176:179], v[64:67]
    v_mfma_f32_16x16x32_bf16 v[80:83], a[32:35], v[180:183], v[80:83]
    v_mfma_f32_16x16x32_bf16 v[68:71], a[36:39], v[176:179], v[68:71]
    v_mfma_f32_16x16x32_bf16 v[84:87], a[36:39], v[180:183], v[84:87]
    v_mfma_f32_16x16x32_bf16 v[72:75], a[40:43], v[176:179], v[72:75]
    v_mfma_f32_16x16x32_bf16 v[88:91], a[40:43], v[180:183], v[88:91]
    v_mfma_f32_16x16x32_bf16 v[76:79], a[44:47], v[176:179], v[76:79]
    v_mfma_f32_16x16x32_bf16 v[92:95], a[44:47], v[180:183], v[92:95]
    v_mfma_f32_16x16x32_bf16 v[64:67], a[48:51], v[184:187], v[64:67]
    v_mfma_f32_16x16x32_bf16 v[80:83], a[48:51], v[188:191], v[80:83]
    v_mfma_f32_16x16x32_bf16 v[68:71], a[52:55], v[184:187], v[68:71]
    v_mfma_f32_16x16x32_bf16 v[84:87], a[52:55], v[188:191], v[84:87]
    v_mfma_f32_16x16x32_bf16 v[72:75], a[56:59], v[184:187], v[72:75]
    s_waitcnt vmcnt(1)
    v_mfma_f32_16x16x32_bf16 v[88:91], a[56:59], v[188:191], v[88:91]
    v_max3_u32 v14, v240, v242, v244
    v_max3_u32 v14, v14, v246, v248
    v_mfma_f32_16x16x32_bf16 v[76:79], a[60:63], v[184:187], v[76:79]
    v_max3_u32 v14, v14, v250, v252
    v_max_u32 v14, v14, v254
    v_mfma_f32_16x16x32_bf16 v[92:95], a[60:63], v[188:191], v[92:95]
    v_cmp_eq_u32 vcc, -1, v14
    s_cbranch_vccnz RTD_41
BKD_42:
    v_mfma_f32_16x16x32_bf16 v[64:67], a[64:67], v[240:243], v[64:67]
    v_lshlrev_b32 v112, 16, v100
    v_mfma_f32_16x16x32_bf16 v[80:83], a[64:67], v[244:247], v[80:83]
    v_and_b32 v113, s65, v100
    v_lshlrev_b32 v114, 16, v101
    v_mfma_f32_16x16x32_bf16 v[68:71], a[68:71], v[240:243], v[68:71]
    v_and_b32 v115, s65, v101
    v_lshlrev_b32 v116, 16, v102
    v_mfma_f32_16x16x32_bf16 v[84:87], a[68:71], v[244:247], v[84:87]
    v_and_b32 v117, s65, v102
    v_lshlrev_b32 v118, 16, v103
    v_mfma_f32_16x16x32_bf16 v[72:75], a[72:75], v[240:243], v[72:75]
    v_and_b32 v119, s65, v103
    v_add_f32 v112, v112, v104
    v_mfma_f32_16x16x32_bf16 v[88:91], a[72:75], v[244:247], v[88:91]
    v_add_f32 v113, v113, v105
    v_add_f32 v114, v114, v106
    v_mfma_f32_16x16x32_bf16 v[76:79], a[76:79], v[240:243], v[76:79]
    v_add_f32 v115, v115, v107
    v_add_f32 v116, v116, v108
    v_mfma_f32_16x16x32_bf16 v[92:95], a[76:79], v[244:247], v[92:95]
    v_add_f32 v117, v117, v109
    v_add_f32 v118, v118, v110
    v_mfma_f32_16x16x32_bf16 v[64:67], a[80:83], v[248:251], v[64:67]
    v_add_f32 v119, v119, v111
    v_mfma_f32_16x16x32_bf16 v[80:83], a[80:83], v[252:255], v[80:83]
    v_mfma_f32_16x16x32_bf16 v[68:71], a[84:87], v[248:251], v[68:71]
    v_mfma_f32_16x16x32_bf16 v[84:87], a[84:87], v[252:255], v[84:87]
    s_nop 3
    ds_write_b128 v8, v[64:67] offset:0
    v_mfma_f32_16x16x32_bf16 v[72:75], a[88:91], v[248:251], v[72:75]
    s_nop 0
    ds_write_b128 v8, v[80:83] offset:4096
    v_mfma_f32_16x16x32_bf16 v[88:91], a[88:91], v[252:255], v[88:91]
    s_nop 0
    ds_write_b128 v8, v[68:71] offset:1024
    v_mfma_f32_16x16x32_bf16 v[76:79], a[92:95], v[248:251], v[76:79]
    s_nop 0
    ds_write_b128 v8, v[84:87] offset:5120
    v_mfma_f32_16x16x32_bf16 v[92:95], a[92:95], v[252:255], v[92:95]
    s_nop 0
    ds_write_b128 v8, v[72:75] offset:2048
    ds_write_b128 v8, v[88:91] offset:6144
    s_nop 1
    ds_write_b128 v8, v[76:79] offset:3072
    s_nop 1
    ds_write_b128 v8, v[92:95] offset:7168
    s_waitcnt lgkmcnt(0)
    s_barrier
    ds_read_b128 v[64:67], v9 offset:0
    ds_read_b128 v[68:71], v9 offset:1024
    ds_read_b128 v[72:75], v9 offset:8448
    ds_read_b128 v[76:79], v9 offset:9472
    ds_read_b128 v[80:83], v9 offset:16896
    ds_read_b128 v[84:87], v9 offset:17920
    ds_read_b128 v[88:91], v9 offset:25344
    ds_read_b128 v[92:95], v9 offset:26368
    s_waitcnt lgkmcnt(6)
    v_pk_add_f32 v[112:113], v[112:113], v[64:65]
    v_pk_add_f32 v[114:115], v[114:115], v[66:67]
    v_pk_add_f32 v[116:117], v[116:117], v[68:69]
    v_pk_add_f32 v[118:119], v[118:119], v[70:71]
    s_waitcnt lgkmcnt(4)
    v_pk_add_f32 v[112:113], v[112:113], v[72:73]
    v_pk_add_f32 v[114:115], v[114:115], v[74:75]
    v_pk_add_f32 v[116:117], v[116:117], v[76:77]
    v_pk_add_f32 v[118:119], v[118:119], v[78:79]
    s_waitcnt lgkmcnt(2)
    v_pk_add_f32 v[112:113], v[112:113], v[80:81]
    v_pk_add_f32 v[114:115], v[114:115], v[82:83]
    v_pk_add_f32 v[116:117], v[116:117], v[84:85]
    v_pk_add_f32 v[118:119], v[118:119], v[86:87]
    s_waitcnt lgkmcnt(0)
    v_pk_add_f32 v[112:113], v[112:113], v[88:89]
    v_pk_add_f32 v[114:115], v[114:115], v[90:91]
    v_pk_add_f32 v[116:117], v[116:117], v[92:93]
    v_pk_add_f32 v[118:119], v[118:119], v[94:95]
    v_cvt_pk_bf16_f32 v120, v112, v113
    v_cvt_pk_bf16_f32 v121, v114, v115
    v_cvt_pk_bf16_f32 v122, v116, v117
    v_cvt_pk_bf16_f32 v123, v118, v119
    s_nop 0
    v_permlane16_swap_b32 v120, v122
    v_permlane16_swap_b32 v121, v123
    buffer_store_dwordx4 v[120:123], v11, s[40:43], s5 offen sc1
KEND:
    s_endpgm
RTU_3:
    s_nop 7
    buffer_load_dwordx4 v[96:99], v3, s[32:35], s101 offen offset:0 sc1
    buffer_load_dwordx4 v[100:103], v3, s[32:35], s101 offen offset:1024 sc1
    buffer_load_dwordx4 v[104:107], v3, s[32:35], s101 offen offset:2048 sc1
    buffer_load_dwordx4 v[108:111], v3, s[32:35], s101 offen offset:3072 sc1
    s_sub_u32 s64, s64, 1
    s_cmp_lt_i32 s64, 0
    s_cbranch_scc1 BKU_4
    s_waitcnt vmcnt(0)
    v_max3_u32 v29, v96, v100, v104
    v_max_u32 v29, v29, v108
    v_cmp_eq_u32 vcc, -1, v29
    s_cbranch_vccnz RTU_3
    s_branch BKU_4
RTS_5:
    s_nop 7
    s_add_u32 s61, s100, 0
    buffer_load_dwordx2 v[40:41], v5, s[32:35], s61 offen sc1
    s_add_u32 s61, s100, 6144
    buffer_load_dwordx2 v[42:43], v5, s[32:35], s61 offen sc1
    s_add_u32 s61, s100, 8192
    buffer_load_dwordx2 v[44:45], v5, s[32:35], s61 offen sc1
    s_add_u32 s61, s100, 14336
    buffer_load_dwordx2 v[46:47], v5, s[32:35], s61 offen sc1
    s_sub_u32 s64, s64, 1
    s_cmp_lt_i32 s64, 0
    s_cbranch_scc1 BKS_6
    s_waitcnt vmcnt(0)
    v_max3_u32 v29, v40, v42, v44
    v_max_u32 v29, v29, v46
    v_cmp_eq_u32 vcc, -1, v29
    s_cbranch_vccnz RTS_5
    s_branch BKS_6
FP_7:
    buffer_load_dwordx2 v[126:127], v4, s[32:35], s15 offen sc1
    s_sub_u32 s64, s64, 1
    s_cmp_lt_i32 s64, 0
    s_cbranch_scc1 FD_8
    s_waitcnt vmcnt(0)
    v_and_b32 v126, v126, v127
    v_cmp_ne_u32 vcc, 1, v126
    s_cbranch_vccnz FP_7
    s_branch FD_8
RTU_9:
    s_nop 7
    buffer_load_dwordx4 v[96:99], v3, s[32:35], s101 offen offset:0 sc1
    buffer_load_dwordx4 v[100:103], v3, s[32:35], s101 offen offset:1024 sc1
    buffer_load_dwordx4 v[104:107], v3, s[32:35], s101 offen offset:2048 sc1
    buffer_load_dwordx4 v[108:111], v3, s[32:35], s101 offen offset:3072 sc1
    s_sub_u32 s64, s64, 1
    s_cmp_lt_i32 s64, 0
    s_cbranch_scc1 BKU_10
    s_waitcnt vmcnt(0)
    v_max3_u32 v29, v96, v100, v104
    v_max_u32 v29, v29, v108
    v_cmp_eq_u32 vcc, -1, v29
    s_cbranch_vccnz RTU_9
    s_branch BKU_10
RTS_11:
    s_nop 7
    s_add_u32 s61, s100, 2048
    buffer_load_dwordx2 v[40:41], v5, s[32:35], s61 offen sc1
    s_add_u32 s61, s100, 4096
    buffer_load_dwordx2 v[42:43], v5, s[32:35], s61 offen sc1
    s_add_u32 s61, s100, 10240
    buffer_load_dwordx2 v[44:45], v5, s[32:35], s61 offen sc1
    s_add_u32 s61, s100, 12288
    buffer_load_dwordx2 v[46:47], v5, s[32:35], s61 offen sc1
    s_sub_u32 s64, s64, 1
    s_cmp_lt_i32 s64, 0
    s_cbranch_scc1 BKS_12
    s_waitcnt vmcnt(0)
    v_max3_u32 v29, v40, v42, v44
    v_max_u32 v29, v29, v46
    v_cmp_eq_u32 vcc, -1, v29
    s_cbranch_vccnz RTS_11
    s_branch BKS_12
FP_13:
    buffer_load_dwordx2 v[126:127], v4, s[32:35], s15 offen sc1
    s_sub_u32 s64, s64, 1
    s_cmp_lt_i32 s64, 0
    s_cbranch_scc1 FD_14
    s_waitcnt vmcnt(0)
    v_and_b32 v126, v126, v127
    v_cmp_ne_u32 vcc, 1, v126
    s_cbranch_vccnz FP_13
    s_branch FD_14
RTC_15:
    s_nop 7
    buffer_load_dwordx4 v[136:139], v17, s[32:35], s40 offen offset:2048 sc1
    buffer_load_dwordx4 v[140:143], v17, s[32:35], s40 offen offset:3072 sc1
    buffer_load_dwordx4 v[144:147], v17, s[32:35], s41 offen offset:0 sc1
    buffer_load_dwordx4 v[148:151], v17, s[32:35], s41 offen offset:1024 sc1
    buffer_load_dwordx4 v[152:155], v17, s[32:35], s41 offen offset:2048 sc1
    buffer_load_dwordx4 v[156:159], v17, s[32:35], s41 offen offset:3072 sc1
    buffer_load_dwordx4 v[160:163], v17, s[32:35], s42 offen offset:0 sc1
    buffer_load_dwordx4 v[164:167], v17, s[32:35], s42 offen offset:1024 sc1
    buffer_load_dwordx4 v[168:171], v17, s[32:35], s42 offen offset:2048 sc1
    buffer_load_dwordx4 v[172:175], v17, s[32:35], s42 offen offset:3072 sc1
    buffer_load_dwordx4 v[176:179], v17, s[32:35], s43 offen offset:0 sc1
    buffer_load_dwordx4 v[180:183], v17, s[32:35], s43 offen offset:1024 sc1
    buffer_load_dwordx4 v[184:187], v17, s[32:35], s43 offen offset:2048 sc1
    buffer_load_dwordx4 v[188:191], v17, s[32:35], s43 offen offset:3072 sc1
    s_sub_u32 s64, s64, 1
    s_cmp_lt_i32 s64, 0
    s_cbranch_scc1 BKC_16
    s_waitcnt vmcnt(0)
    v_max3_u32 v14, v136, v138, v140
    v_max_u32 v14, v14, v142
    v_cmp_eq_u32 vcc, -1, v14
    s_cbranch_vccnz RTC_15
    s_branch BKC_16
RTC_17:
    s_nop 7
    buffer_load_dwordx4 v[144:147], v17, s[32:35], s41 offen offset:0 sc1
    buffer_load_dwordx4 v[148:151], v17, s[32:35], s41 offen offset:1024 sc1
    buffer_load_dwordx4 v[152:155], v17, s[32:35], s41 offen offset:2048 sc1
    buffer_load_dwordx4 v[156:159], v17, s[32:35], s41 offen offset:3072 sc1
    buffer_load_dwordx4 v[160:163], v17, s[32:35], s42 offen offset:0 sc1
    buffer_load_dwordx4 v[164:167], v17, s[32:35], s42 offen offset:1024 sc1
    buffer_load_dwordx4 v[168:171], v17, s[32:35], s42 offen offset:2048 sc1
    buffer_load_dwordx4 v[172:175], v17, s[32:35], s42 offen offset:3072 sc1
    buffer_load_dwordx4 v[176:179], v17, s[32:35], s43 offen offset:0 sc1
    buffer_load_dwordx4 v[180:183], v17, s[32:35], s43 offen offset:1024 sc1
    buffer_load_dwordx4 v[184:187], v17, s[32:35], s43 offen offset:2048 sc1
    buffer_load_dwordx4 v[188:191], v17, s[32:35], s43 offen offset:3072 sc1
    s_sub_u32 s64, s64, 1
    s_cmp_lt_i32 s64, 0
    s_cbranch_scc1 BKC_18
    s_waitcnt vmcnt(0)
    v_max3_u32 v14, v144, v146, v148
    v_max3_u32 v14, v14, v150, v152
    v_max3_u32 v14, v14, v154, v156
    v_max_u32 v14, v14, v158
    v_cmp_eq_u32 vcc, -1, v14
    s_cbranch_vccnz RTC_17
    s_branch BKC_18
RTC_19:
    s_nop 7
    buffer_load_dwordx4 v[160:163], v17, s[32:35], s42 offen offset:0 sc1
    buffer_load_dwordx4 v[164:167], v17, s[32:35], s42 offen offset:1024 sc1
    buffer_load_dwordx4 v[168:171], v17, s[32:35], s42 offen offset:2048 sc1
    buffer_load_dwordx4 v[172:175], v17, s[32:35], s42 offen offset:3072 sc1
    buffer_load_dwordx4 v[176:179], v17, s[32:35], s43 offen offset:0 sc1
    buffer_load_dwordx4 v[180:183], v17, s[32:35], s43 offen offset:1024 sc1
    buffer_load_dwordx4 v[184:187], v17, s[32:35], s43 offen offset:2048 sc1
    buffer_load_dwordx4 v[188:191], v17, s[32:35], s43 offen offset:3072 sc1
    s_sub_u32 s64, s64, 1
    s_cmp_lt_i32 s64, 0
    s_cbranch_scc1 BKC_20
    s_waitcnt vmcnt(0)
    v_max3_u32 v14, v160, v162, v164
    v_max3_u32 v14, v14, v166, v168
    v_max3_u32 v14, v14, v170, v172
    v_max_u32 v14, v14, v174
    v_cmp_eq_u32 vcc, -1, v14
    s_cbranch_vccnz RTC_19
    s_branch BKC_20
RTC_21:
    s_nop 7
    buffer_load_dwordx4 v[176:179], v17, s[32:35], s43 offen offset:0 sc1
    buffer_load_dwordx4 v[180:183], v17, s[32:35], s43 offen offset:1024 sc1
    buffer_load_dwordx4 v[184:187], v17, s[32:35], s43 offen offset:2048 sc1
    buffer_load_dwordx4 v[188:191], v17, s[32:35], s43 offen offset:3072 sc1
    s_sub_u32 s64, s64, 1
    s_cmp_lt_i32 s64, 0
    s_cbranch_scc1 BKC_22
    s_waitcnt vmcnt(0)
    v_max3_u32 v14, v176, v178, v180
    v_max3_u32 v14, v14, v182, v184
    v_max3_u32 v14, v14, v186, v188
    v_max_u32 v14, v14, v190
    v_cmp_eq_u32 vcc, -1, v14
    s_cbranch_vccnz RTC_21
    s_branch BKC_22
RTC_23:
    s_nop 7
    buffer_load_dwordx4 v[128:131], v17, s[32:35], s40 offen offset:0 sc1
    buffer_load_dwordx4 v[132:135], v17, s[32:35], s40 offen offset:1024 sc1
    buffer_load_dwordx4 v[136:139], v17, s[32:35], s40 offen offset:2048 sc1
    buffer_load_dwordx4 v[140:143], v17, s[32:35], s40 offen offset:3072 sc1
    buffer_load_dwordx4 v[144:147], v17, s[32:35], s41 offen offset:0 sc1
    buffer_load_dwordx4 v[148:151], v17, s[32:35], s41 offen offset:1024 sc1
    buffer_load_dwordx4 v[152:155], v17, s[32:35], s41 offen offset:2048 sc1
    buffer_load_dwordx4 v[156:159], v17, s[32:35], s41 offen offset:3072 sc1
    buffer_load_dwordx4 v[160:163], v17, s[32:35], s42 offen offset:0 sc1
    buffer_load_dwordx4 v[164:167], v17, s[32:35], s42 offen offset:1024 sc1
    buffer_load_dwordx4 v[168:171], v17, s[32:35], s42 offen offset:2048 sc1
    buffer_load_dwordx4 v[172:175], v17, s[32:35], s42 offen offset:3072 sc1
    buffer_load_dwordx4 v[176:179], v17, s[32:35], s43 offen offset:0 sc1
    buffer_load_dwordx4 v[180:183], v17, s[32:35], s43 offen offset:1024 sc1
    buffer_load_dwordx4 v[184:187], v17, s[32:35], s43 offen offset:2048 sc1
    buffer_load_dwordx4 v[188:191], v17, s[32:35], s43 offen offset:3072 sc1
    s_sub_u32 s64, s64, 1
    s_cmp_lt_i32 s64, 0
    s_cbranch_scc1 BKC_24
    s_waitcnt vmcnt(0)
    v_max3_u32 v14, v128, v130, v132
    v_max_u32 v14, v14, v134
    v_cmp_eq_u32 vcc, -1, v14
    s_cbranch_vccnz RTC_23
    s_branch BKC_24
FP_25:
    buffer_load_dwordx2 v[96:97], v15, s[32:35], s7 offen sc1
    s_sub_u32 s64, s64, 1
    s_cmp_lt_i32 s64, 0
    s_cbranch_scc1 FD_26
    s_waitcnt vmcnt(0)
    v_and_b32 v96, v96, v97
    v_cmp_ne_u32 vcc, 1.0, v96
    s_cbranch_vccnz FP_25
    s_branch FD_26
RTE_27:
    s_nop 7
    s_add_u32 s60, s13, 1048576
    buffer_load_dwordx4 v[192:195], v17, s[32:35], s60 offen offset:0 sc1
    s_add_u32 s60, s13, 1048576
    buffer_load_dwordx4 v[196:199], v17, s[32:35], s60 offen offset:1024 sc1
    s_add_u32 s60, s13, 1048576
    buffer_load_dwordx4 v[200:203], v17, s[32:35], s60 offen offset:2048 sc1
    s_add_u32 s60, s13, 1048576
    buffer_load_dwordx4 v[204:207], v17, s[32:35], s60 offen offset:3072 sc1
    s_add_u32 s60, s13, 1052672
    buffer_load_dwordx4 v[208:211], v17, s[32:35], s60 offen offset:0 sc1
    s_add_u32 s60, s13, 1052672
    buffer_load_dwordx4 v[212:215], v17, s[32:35], s60 offen offset:1024 sc1
    s_add_u32 s60, s13, 1052672
    buffer_load_dwordx4 v[216:219], v17, s[32:35], s60 offen offset:2048 sc1
    s_add_u32 s60, s13, 1052672
    buffer_load_dwordx4 v[220:223], v17, s[32:35], s60 offen offset:3072 sc1
    s_add_u32 s60, s13, 1056768
    buffer_load_dwordx4 v[224:227], v17, s[32:35], s60 offen offset:0 sc1
    s_add_u32 s60, s13, 1056768
    buffer_load_dwordx4 v[228:231], v17, s[32:35], s60 offen offset:1024 sc1
    s_add_u32 s60, s13, 1056768
    buffer_load_dwordx4 v[232:235], v17, s[32:35], s60 offen offset:2048 sc1
    s_add_u32 s60, s13, 1056768
    buffer_load_dwordx4 v[236:239], v17, s[32:35], s60 offen offset:3072 sc1
    s_add_u32 s60, s13, 1060864
    buffer_load_dwordx4 v[240:243], v17, s[32:35], s60 offen offset:0 sc1
    s_add_u32 s60, s13, 1060864
    buffer_load_dwordx4 v[244:247], v17, s[32:35], s60 offen offset:1024 sc1
    s_add_u32 s60, s13, 1060864
    buffer_load_dwordx4 v[248:251], v17, s[32:35], s60 offen offset:2048 sc1
    s_add_u32 s60, s13, 1060864
    buffer_load_dwordx4 v[252:255], v17, s[32:35], s60 offen offset:3072 sc1
    s_sub_u32 s64, s64, 1
    s_cmp_lt_i32 s64, 0
    s_cbranch_scc1 BKE_28
    s_waitcnt vmcnt(0)
    v_max3_u32 v14, v192, v194, v196
    v_max3_u32 v14, v14, v198, v200
    v_max3_u32 v14, v14, v202, v204
    v_max_u32 v14, v14, v206
    v_cmp_eq_u32 vcc, -1, v14
    s_cbranch_vccnz RTE_27
    s_branch BKE_28
RTE_29:
    s_nop 7
    s_add_u32 s60, s13, 1052672
    buffer_load_dwordx4 v[208:211], v17, s[32:35], s60 offen offset:0 sc1
    s_add_u32 s60, s13, 1052672
    buffer_load_dwordx4 v[212:215], v17, s[32:35], s60 offen offset:1024 sc1
    s_add_u32 s60, s13, 1052672
    buffer_load_dwordx4 v[216:219], v17, s[32:35], s60 offen offset:2048 sc1
    s_add_u32 s60, s13, 1052672
    buffer_load_dwordx4 v[220:223], v17, s[32:35], s60 offen offset:3072 sc1
    s_add_u32 s60, s13, 1056768
    buffer_load_dwordx4 v[224:227], v17, s[32:35], s60 offen offset:0 sc1
    s_add_u32 s60, s13, 1056768
    buffer_load_dwordx4 v[228:231], v17, s[32:35], s60 offen offset:1024 sc1
    s_add_u32 s60, s13, 1056768
    buffer_load_dwordx4 v[232:235], v17, s[32:35], s60 offen offset:2048 sc1
    s_add_u32 s60, s13, 1056768
    buffer_load_dwordx4 v[236:239], v17, s[32:35], s60 offen offset:3072 sc1
    s_add_u32 s60, s13, 1060864
    buffer_load_dwordx4 v[240:243], v17, s[32:35], s60 offen offset:0 sc1
    s_add_u32 s60, s13, 1060864
    buffer_load_dwordx4 v[244:247], v17, s[32:35], s60 offen offset:1024 sc1
    s_add_u32 s60, s13, 1060864
    buffer_load_dwordx4 v[248:251], v17, s[32:35], s60 offen offset:2048 sc1
    s_add_u32 s60, s13, 1060864
    buffer_load_dwordx4 v[252:255], v17, s[32:35], s60 offen offset:3072 sc1
    s_sub_u32 s64, s64, 1
    s_cmp_lt_i32 s64, 0
    s_cbranch_scc1 BKE_30
    s_waitcnt vmcnt(0)
    v_max3_u32 v14, v208, v210, v212
    v_max3_u32 v14, v14, v214, v216
    v_max3_u32 v14, v14, v218, v220
    v_max_u32 v14, v14, v222
    v_cmp_eq_u32 vcc, -1, v14
    s_cbranch_vccnz RTE_29
    s_branch BKE_30
RTE_31:
    s_nop 7
    s_add_u32 s60, s13, 1056768
    buffer_load_dwordx4 v[224:227], v17, s[32:35], s60 offen offset:0 sc1
    s_add_u32 s60, s13, 1056768
    buffer_load_dwordx4 v[228:231], v17, s[32:35], s60 offen offset:1024 sc1
    s_add_u32 s60, s13, 1056768
    buffer_load_dwordx4 v[232:235], v17, s[32:35], s60 offen offset:2048 sc1
    s_add_u32 s60, s13, 1056768
    buffer_load_dwordx4 v[236:239], v17, s[32:35], s60 offen offset:3072 sc1
    s_add_u32 s60, s13, 1060864
    buffer_load_dwordx4 v[240:243], v17, s[32:35], s60 offen offset:0 sc1
    s_add_u32 s60, s13, 1060864
    buffer_load_dwordx4 v[244:247], v17, s[32:35], s60 offen offset:1024 sc1
    s_add_u32 s60, s13, 1060864
    buffer_load_dwordx4 v[248:251], v17, s[32:35], s60 offen offset:2048 sc1
    s_add_u32 s60, s13, 1060864
    buffer_load_dwordx4 v[252:255], v17, s[32:35], s60 offen offset:3072 sc1
    s_sub_u32 s64, s64, 1
    s_cmp_lt_i32 s64, 0
    s_cbranch_scc1 BKE_32
    s_waitcnt vmcnt(0)
    v_max3_u32 v14, v224, v226, v228
    v_max3_u32 v14, v14, v230, v232
    v_max3_u32 v14, v14, v234, v236
    v_max_u32 v14, v14, v238
    v_cmp_eq_u32 vcc, -1, v14
    s_cbranch_vccnz RTE_31
    s_branch BKE_32
RTE_33:
    s_nop 7
    s_add_u32 s60, s13, 1060864
    buffer_load_dwordx4 v[240:243], v17, s[32:35], s60 offen offset:0 sc1
    s_add_u32 s60, s13, 1060864
    buffer_load_dwordx4 v[244:247], v17, s[32:35], s60 offen offset:1024 sc1
    s_add_u32 s60, s13, 1060864
    buffer_load_dwordx4 v[248:251], v17, s[32:35], s60 offen offset:2048 sc1
    s_add_u32 s60, s13, 1060864
    buffer_load_dwordx4 v[252:255], v17, s[32:35], s60 offen offset:3072 sc1
    s_sub_u32 s64, s64, 1
    s_cmp_lt_i32 s64, 0
    s_cbranch_scc1 BKE_34
    s_waitcnt vmcnt(0)
    v_max3_u32 v14, v240, v242, v244
    v_max3_u32 v14, v14, v246, v248
    v_max3_u32 v14, v14, v250, v252
    v_max_u32 v14, v14, v254
    v_cmp_eq_u32 vcc, -1, v14
    s_cbranch_vccnz RTE_33
    s_branch BKE_34
RTD_35:
    s_nop 7
    s_add_u32 s60, s95, 3670016
    buffer_load_dwordx4 v[208:211], v3, s[32:35], s60 offen sc1
    s_add_u32 s60, s95, 3727360
    buffer_load_dwordx4 v[212:215], v3, s[32:35], s60 offen sc1
    s_add_u32 s60, s95, 3673088
    buffer_load_dwordx4 v[216:219], v3, s[32:35], s60 offen sc1
    s_add_u32 s60, s95, 3730432
    buffer_load_dwordx4 v[220:223], v3, s[32:35], s60 offen sc1
    s_add_u32 s60, s95, 3677184
    buffer_load_dwordx4 v[224:227], v3, s[32:35], s60 offen sc1
    s_add_u32 s60, s95, 3734528
    buffer_load_dwordx4 v[228:231], v3, s[32:35], s60 offen sc1
    s_add_u32 s60, s95, 3680256
    buffer_load_dwordx4 v[232:235], v3, s[32:35], s60 offen sc1
    s_add_u32 s60, s95, 3737600
    buffer_load_dwordx4 v[236:239], v3, s[32:35], s60 offen sc1
    s_sub_u32 s64, s64, 1
    s_cmp_lt_i32 s64, 0
    s_cbranch_scc1 BKD_36
    s_waitcnt vmcnt(0)
    v_max3_u32 v14, v208, v212, v216
    v_max3_u32 v14, v14, v220, v224
    v_max3_u32 v14, v14, v228, v232
    v_max_u32 v14, v14, v236
    v_cmp_eq_u32 vcc, -1, v14
    s_cbranch_vccnz RTD_35
    s_branch BKD_36
RTD_37:
    s_nop 7
    s_add_u32 s60, s95, 3671040
    buffer_load_dwordx4 v[128:131], v3, s[32:35], s60 offen sc1
    s_add_u32 s60, s95, 3728384
    buffer_load_dwordx4 v[132:135], v3, s[32:35], s60 offen sc1
    s_add_u32 s60, s95, 3674112
    buffer_load_dwordx4 v[136:139], v3, s[32:35], s60 offen sc1
    s_add_u32 s60, s95, 3731456
    buffer_load_dwordx4 v[140:143], v3, s[32:35], s60 offen sc1
    s_add_u32 s60, s95, 3678208
    buffer_load_dwordx4 v[144:147], v3, s[32:35], s60 offen sc1
    s_add_u32 s60, s95, 3735552
    buffer_load_dwordx4 v[148:151], v3, s[32:35], s60 offen sc1
    s_add_u32 s60, s95, 3681280
    buffer_load_dwordx4 v[152:155], v3, s[32:35], s60 offen sc1
    s_add_u32 s60, s95, 3738624
    buffer_load_dwordx4 v[156:159], v3, s[32:35], s60 offen sc1
    s_sub_u32 s64, s64, 1
    s_cmp_lt_i32 s64, 0
    s_cbranch_scc1 BKD_38
    s_waitcnt vmcnt(0)
    v_max3_u32 v14, v128, v132, v136
    v_max3_u32 v14, v14, v140, v144
    v_max3_u32 v14, v14, v148, v152
    v_max_u32 v14, v14, v156
    v_cmp_eq_u32 vcc, -1, v14
    s_cbranch_vccnz RTD_37
    s_branch BKD_38
RTD_39:
    s_nop 7
    s_add_u32 s60, s95, 3672064
    buffer_load_dwordx4 v[160:163], v3, s[32:35], s60 offen sc1
    s_add_u32 s60, s95, 3729408
    buffer_load_dwordx4 v[164:167], v3, s[32:35], s60 offen sc1
    s_add_u32 s60, s95, 3675136
    buffer_load_dwordx4 v[168:171], v3, s[32:35], s60 offen sc1
    s_add_u32 s60, s95, 3732480
    buffer_load_dwordx4 v[172:175], v3, s[32:35], s60 offen sc1
    s_add_u32 s60, s95, 3679232
    buffer_load_dwordx4 v[176:179], v3, s[32:35], s60 offen sc1
    s_add_u32 s60, s95, 3736576
    buffer_load_dwordx4 v[180:183], v3, s[32:35], s60 offen sc1
    s_add_u32 s60, s95, 3682304
    buffer_load_dwordx4 v[184:187], v3, s[32:35], s60 offen sc1
    s_add_u32 s60, s95, 3739648
    buffer_load_dwordx4 v[188:191], v3, s[32:35], s60 offen sc1
    s_sub_u32 s64, s64, 1
    s_cmp_lt_i32 s64, 0
    s_cbranch_scc1 BKD_40
    s_waitcnt vmcnt(0)
    v_max3_u32 v14, v160, v164, v168
    v_max3_u32 v14, v14, v172, v176
    v_max3_u32 v14, v14, v180, v184
    v_max_u32 v14, v14, v188
    v_cmp_eq_u32 vcc, -1, v14
    s_cbranch_vccnz RTD_39
    s_branch BKD_40
RTD_41:
    s_nop 7
    s_add_u32 s60, s95, 3676160
    buffer_load_dwordx2 v[240:241], v16, s[32:35], s60 offen offset:0 sc1
    buffer_load_dwordx2 v[242:243], v16, s[32:35], s60 offen offset:512 sc1
    s_add_u32 s60, s95, 3733504
    buffer_load_dwordx2 v[244:245], v16, s[32:35], s60 offen offset:0 sc1
    buffer_load_dwordx2 v[246:247], v16, s[32:35], s60 offen offset:512 sc1
    s_add_u32 s60, s95, 3683328
    buffer_load_dwordx2 v[248:249], v16, s[32:35], s60 offen offset:0 sc1
    buffer_load_dwordx2 v[250:251], v16, s[32:35], s60 offen offset:512 sc1
    s_add_u32 s60, s95, 3740672
    buffer_load_dwordx2 v[252:253], v16, s[32:35], s60 offen offset:0 sc1
    buffer_load_dwordx2 v[254:255], v16, s[32:35], s60 offen offset:512 sc1
    s_sub_u32 s64, s64, 1
    s_cmp_lt_i32 s64, 0
    s_cbranch_scc1 BKD_42
    s_waitcnt vmcnt(0)
    v_max3_u32 v14, v240, v242, v244
    v_max3_u32 v14, v14, v246, v248
    v_max3_u32 v14, v14, v250, v252
    v_max_u32 v14, v14, v254
    v_cmp_eq_u32 vcc, -1, v14
    s_cbranch_vccnz RTD_41
    s_branch BKD_42
.section .rodata,"a"
.p2align 6
.amdhsa_kernel sequential_preLN__ssm_conv_h3__mixer_channel_mlp__prompt_kernel
  .amdhsa_next_free_vgpr 512
  .amdhsa_next_free_sgpr 102
  .amdhsa_accum_offset 256
  .amdhsa_group_segment_fixed_size 0
  .amdhsa_kernarg_size 112
  .amdhsa_user_sgpr_count 2
  .amdhsa_user_sgpr_kernarg_segment_ptr 1
  .amdhsa_system_sgpr_workgroup_id_x 1
.end_amdhsa_kernel
```
